```python
import torch

def _softmax(x, axis=-1):
    return torch.softmax(x, dim=axis)
def _gelu(x):
    return torch.nn.functional.gelu(x, approximate="tanh")
def _silu(x):
    return torch.nn.functional.silu(x)
def _sigmoid(x):
    return torch.sigmoid(x)
def _layernorm(x, axis=-1, eps=1e-5):
    m = x.mean(dim=axis, keepdim=True)
    v = x.var(dim=axis, keepdim=True, unbiased=False)
    return (x - m) / torch.sqrt(v + eps)
def _scatter_add(tgt, idx, src, axis=0):
    return tgt.clone().index_add_(axis, idx, src)
def _segment_sum(src, seg, n):
    out = torch.zeros((n,) + src.shape[1:], dtype=src.dtype)
    return out.index_add_(0, seg, src)
def _pad(x, pw):
    flat = tuple(v for pair in reversed(pw) for v in pair)
    return torch.nn.functional.pad(x, flat)

kernel_name = 'recurrent_scan__ssm_conv_h3__mixer_s_mlp__prompt'

def setup_inputs():

    _w = (lambda a: (lambda t: t.to(torch.bfloat16) if t.is_floating_point() else t)(torch.as_tensor(a)))
    def _A_setup():
        B, S, D = 1, 2048, 640
        ks = 4
        return {
            "q": _w((lambda *s: torch.randn(*s, dtype=torch.bfloat16) * 0.05)(B, S, D)),
            "k": _w((lambda *s: torch.randn(*s, dtype=torch.bfloat16) * 0.2)(B, S, D)),
            "v": _w((lambda *s: torch.randn(*s, dtype=torch.bfloat16) * 0.2)(B, S, D)),
            "shift_k": _w((lambda *s: torch.randn(*s, dtype=torch.bfloat16) * 0.2)(D, ks) * 0.5),
            "ssm_k": _w((lambda *s: torch.randn(*s, dtype=torch.bfloat16) * 0.2)(D, S) * (1.0 / S ** 0.5)),
            "ssm_D": _w((lambda *s: torch.randn(*s, dtype=torch.bfloat16) * 0.2)(D)),
        }
    _A_in = _A_setup()

    def _B_setup():
        B, S, D, F = 1, 2048, 640, 1728
        return {
            "x":  _w((lambda *s: torch.randn(*s, dtype=torch.bfloat16) * 0.05)(B, S, D)),
            "w1": _w((lambda *s: torch.randn(*s, dtype=torch.bfloat16) * 3.2)(D, D) * (D ** -0.5)),
            "w2": _w((lambda *s: torch.randn(*s, dtype=torch.bfloat16) * 3.2)(D, D) * (D ** -0.5)),
            "w3": _w((lambda *s: torch.randn(*s, dtype=torch.bfloat16) * 3.2)(D, F) * (D ** -0.5)),
            "w4": _w((lambda *s: torch.randn(*s, dtype=torch.bfloat16) * 3.2)(F, D) * (F ** -0.5)),
        }
    _B_in = _B_setup()

    return {
        "A_q": _A_in["q"],
        "A_k": _A_in["k"],
        "A_v": _A_in["v"],
        "A_shift_k": _A_in["shift_k"],
        "A_ssm_k": _A_in["ssm_k"],
        "A_ssm_D": _A_in["ssm_D"],
        "B_x": _B_in["x"],
        "B_w1": _B_in["w1"],
        "B_w2": _B_in["w2"],
        "B_w3": _B_in["w3"],
        "B_w4": _B_in["w4"],
    }

def reference(A_q, A_k, A_v, A_shift_k, A_ssm_k, A_ssm_D, B_x, B_w1, B_w2, B_w3, B_w4):
    def _A_ref(q, k, v, shift_k, ssm_k, ssm_D):
        B, S, D = q.shape
        ks = shift_k.shape[-1]
        k_pad = _pad(k, ((0, 0), (ks - 1, 0), (0, 0)))
        k_shift = torch.zeros_like(k)
        for t in range(ks):
            k_shift = k_shift + k_pad[:, t:t + S, :] * shift_k[:, ks - 1 - t][None, None, :]
        kv = k_shift * v
        L = 2 * S
        kv_pad = _pad(kv, ((0, 0), (0, S), (0, 0)))
        kf_pad = _pad(ssm_k, ((0, 0), (0, S)))
        kv_f = (lambda x, axes=(-2,-1): torch.fft.rfft2(x.float(), dim=axes))(kv_pad[:, None, :, :], axes=(1, 2))
        kf_f = (lambda x, axes=(-2,-1): torch.fft.rfft2(x.float(), dim=axes))(kf_pad[:, None, :], axes=(1, 2))
        kf_f = (lambda x, *d: x.permute(*d))(kf_f, 1, 2, 0)
        y_f = kv_f * kf_f[None, :, :, :]
        y = (lambda x, s, axes=(-2,-1): torch.fft.irfft2(x, s=s, dim=axes).to(torch.bfloat16))(y_f, (1, L), axes=(1, 2))[:, 0, :S, :]
        y = y + kv * ssm_D[None, None, :]
        return q * y

    def _B_ref(x, w1, w2, w3, w4):
        B, S, D = x.shape
        h = _gelu(_layernorm(x, axis=-1) @ w1)
        c = D // 4
        g0 = _pad(h[:, :, 0*c:1*c], ((0, 0), (1, 0), (0, 0)))[:, :S, :]
        g1 = _pad(h[:, :, 1*c:2*c], ((0, 0), (0, 1), (0, 0)))[:, 1:, :]
        g2 = _pad(h[:, :, 2*c:3*c], ((0, 0), (2, 0), (0, 0)))[:, :S, :]
        g3 = _pad(h[:, :, 3*c:   ], ((0, 0), (0, 2), (0, 0)))[:, 2:, :]
        hs = torch.concatenate([g0, g1, g2, g3], axis=-1) @ w2
        x1 = x + hs
        h2 = _gelu(_layernorm(x1, axis=-1) @ w3) @ w4
        return x1 + h2

    x = A_q
    xn = _layernorm(x, axis=-1)
    s = _A_ref(xn, A_k, A_v, A_shift_k, A_ssm_k, A_ssm_D)
    g = _silu(_B_ref(xn, B_w1, B_w2, B_w3, B_w4))
    return x + s * g
```

```asm
; @launch grid=(256,1,1) block=(256,1,1) lds=163840
.amdgcn_target "amdgcn-amd-amdhsa--gfx950"
.text
.globl recurrent_scan__ssm_conv_h3__mixer_s_mlp__prompt_kernel
.p2align 8
.type recurrent_scan__ssm_conv_h3__mixer_s_mlp__prompt_kernel,@function
recurrent_scan__ssm_conv_h3__mixer_s_mlp__prompt_kernel:
    s_cmp_ge_u32 s2, 256
    s_cbranch_scc1 L_end
    s_load_dwordx16 s[36:51], s[0:1], 0
    s_load_dwordx8 s[52:59], s[0:1], 64
    s_load_dwordx4 s[60:63], s[0:1], 96
    v_lshrrev_b32 v190, 6, v0
    v_and_b32 v0, 63, v0
    v_readfirstlane_b32 s64, v190
    s_getpc_b64 s[82:83]
L_pc:
    s_lshr_b32 s77, s2, 3
    s_mul_i32 s76, s77, 11
    s_mul_i32 s78, s64, 3
    s_add_u32 s76, s76, s78
    v_add_u32 v190, s76, v0
    v_lshlrev_b32 v190, 7, v190
    s_mov_b64 exec, 7
    global_load_dword v191, v190, s[82:83]
    s_mov_b64 exec, -1
    s_and_b32 s76, s2, 7
    s_and_b32 s66, s77, 7
    s_lshr_b32 s77, s77, 3
    s_lshl_b32 s76, s76, 2
    s_add_u32 s65, s76, s77
    s_lshl_b32 s76, s65, 3
    s_add_u32 s76, s76, s66
    s_lshl_b32 s77, s76, 2
    s_add_u32 s77, s77, s64
    s_lshl_b32 s76, s76, 5
    s_add_u32 s76, s76, 32768
    s_lshl_b32 s77, s77, 5
    s_add_u32 s82, s82, pp_table-L_pc
    s_addc_u32 s83, s83, 0
    s_load_dwordx8 s[92:99], s[82:83], s76
    s_load_dwordx8 s[84:91], s[82:83], s77
    v_and_b32 v2, 15, v0
    v_lshrrev_b32 v37, 4, v0
    s_lshr_b32 s76, s66, 2
    s_add_u32 s76, s76, 1
    s_sub_u32 s77, 0, s76
    s_bitcmp1_b32 s66, 1
    s_cselect_b32 s76, s76, s77
    s_lshl_b32 s67, s65, 6
    s_lshl_b32 s77, s64, 4
    s_add_u32 s67, s67, s77
    s_add_u32 s76, s76, s67
    v_add_u32 v164, s76, v37
    v_mul_i32_i24 v164, 1280, v164
    v_xor_b32 v165, v2, v37
    v_lshlrev_b32 v165, 4, v165
    v_add_u32 v160, v164, v165
    v_xor_b32 v161, 64, v160
    v_add_u32 v161, 5120, v161
    v_xor_b32 v162, 128, v160
    v_add_u32 v162, 10240, v162
    v_xor_b32 v163, 192, v160
    v_add_u32 v163, 15360, v163
    s_mul_i32 s75, s66, 160
    s_add_u32 s76, s65, s66
    s_mul_i32 s77, s76, 52429
    s_lshr_b32 s77, s77, 18
    s_mul_i32 s77, s77, 5
    s_sub_u32 s80, s76, s77
    s_and_b32 s76, s65, 3
    s_lshl_b32 s76, s76, 1
    s_sub_u32 s76, s66, s76
    s_and_b32 s78, s76, 7
    s_mul_i32 s77, s65, 5
    s_add_u32 s77, s77, s78
    s_sub_u32 s77, s77, 3
    s_mul_i32 s76, s65, 3
    s_add_u32 s76, s76, s78
    s_add_u32 s76, s76, 160
    s_cmp_ge_u32 s78, 3
    s_cselect_b32 s76, s77, s76
    s_lshl_b32 s76, s76, 2
    s_add_u32 s81, s76, s64
    v_lshlrev_b32 v1, 4, v0
    s_cmp_eq_u32 s64, 3
    s_cselect_b32 s3, s2, 16
    s_waitcnt lgkmcnt(0)
    s_mul_i32 s101, s64, 12288
    s_add_u32 s101, s101, 102400
    s_mov_b64 s[4:5], s[36:37]
    s_mov_b32 s6, 2621440
    s_mov_b32 s7, 0x20000
    s_mov_b64 s[12:13], s[62:63]
    s_mov_b32 s14, 24117248
    s_mov_b32 s15, 0x20000
    s_mul_i32 s83, s64, 5120
    s_lshl_b32 s36, s80, 8
    s_cmp_lg_u32 s64, 3
    s_cbranch_scc1 L_nop3_1
    s_and_b32 s76, s92, 3
    s_andn2_b32 s92, s92, 3
    s_cmp_eq_u32 s76, 0
    s_cselect_b64 s[24:25], s[52:53], s[56:57]
    s_cmp_eq_u32 s76, 1
    s_cselect_b64 s[24:25], s[54:55], s[24:25]
    s_mov_b32 s77, 1280
    s_cselect_b32 s77, 3456, s77
    s_cmp_eq_u32 s76, 0
    s_mov_b32 s76, 2211840
    s_cselect_b32 s26, 819200, s76
    s_mov_b32 s27, 0x20000
    v_lshrrev_b32 v173, 3, v0
    v_mul_u32_u24 v173, s77, v173
    v_and_b32 v174, 7, v0
    v_lshl_add_u32 v173, v174, 4, v173
    s_lshl_b32 s77, s77, 3
    s_add_u32 m0, s83, 81920
    s_nop 0
    buffer_load_dwordx4 v173, s[24:27], s92 offen lds
    s_add_u32 s92, s92, s77
    s_add_u32 m0, s83, 82944
    s_nop 0
    buffer_load_dwordx4 v173, s[24:27], s92 offen lds
    s_add_u32 m0, s83, 83968
    s_nop 0
    buffer_load_dwordx4 v173, s[24:27], s93 offen lds
    s_add_u32 s93, s93, s77
    s_add_u32 m0, s83, 84992
    s_nop 0
    buffer_load_dwordx4 v173, s[24:27], s93 offen lds
    v_lshrrev_b32 v173, 2, v0
    v_lshlrev_b32 v173, 7, v173
    v_and_b32 v174, 3, v0
    v_lshl_add_u32 v173, v174, 3, v173
    s_add_u32 s76, s83, 81920
    v_add_u32 v173, s76, v173
    v_mov_b32 v174, s98
    v_writelane_b32 v174, s99, 2
    v_writelane_b32 v174, s99, 3
    v_and_b32 v175, 1, v0
    v_lshlrev_b32 v175, 4, v175
    v_lshrrev_b32 v174, v175, v174
    v_and_b32 v174, 0xffff, v174
    v_lshlrev_b32 v174, 7, v174
    v_mov_b32 v175, 0x7ffffff0
    v_cmp_lt_u32 vcc, 0x10000, v174
    s_nop 1
    v_cndmask_b32 v174, v174, v175, vcc
L_nop3_1:
    s_add_u32 m0, s101, 0
    s_nop 0
    buffer_load_dwordx4 v160, s[4:7], s36 offen lds
    s_add_u32 m0, s101, 1024
    s_nop 0
    buffer_load_dwordx4 v161, s[4:7], s36 offen lds
    s_add_u32 m0, s101, 2048
    s_nop 0
    buffer_load_dwordx4 v162, s[4:7], s36 offen lds
    s_add_u32 m0, s101, 3072
    s_nop 0
    buffer_load_dwordx4 v163, s[4:7], s36 offen lds
    s_mov_b64 s[8:9], s[50:51]
    s_mov_b32 s10, 819200
    s_mov_b32 s11, 0x20000
    s_mov_b64 s[16:17], s[38:39]
    s_mov_b32 s18, 2621440
    s_mov_b32 s19, 0x20000
    s_mov_b64 s[20:21], s[40:41]
    s_mov_b32 s22, 2621440
    s_mov_b32 s23, 0x20000
    s_add_u32 s76, s80, 0
    s_cmp_ge_u32 s76, 5
    s_cselect_b32 s77, 5, 0
    s_sub_u32 s76, s76, s77
    s_lshl_b32 s76, s76, 2
    s_add_u32 s76, s76, s64
    s_mul_i32 s76, s76, 40960
    s_add_u32 s41, s76, s75
    v_add_u32 v180, 0, v0
    v_mul_u32_u24 v181, 6554, v180
    v_lshrrev_b32 v181, 16, v181
    v_mul_u32_u24 v182, 10, v181
    v_sub_u32 v180, v180, v182
    v_lshlrev_b32 v180, 4, v180
    v_mul_u32_u24 v182, 1280, v181
    v_add_u32 v4, v182, v180
    v_bfe_u32 v182, v181, 2, 2
    v_lshlrev_b32 v182, 3, v182
    v_and_b32 v168, 3, v181
    v_add_u32 v182, v182, v168
    v_lshrrev_b32 v181, 4, v181
    v_lshl_add_u32 v182, v181, 2, v182
    v_mul_u32_u24 v182, 1280, v182
    v_add_u32 v168, v182, v180
    s_add_u32 m0, s83, 0
    s_nop 0
    buffer_load_dwordx4 v168, s[8:11], s41 offen lds
    v_add_u32 v180, 64, v0
    v_mul_u32_u24 v181, 6554, v180
    v_lshrrev_b32 v181, 16, v181
    v_mul_u32_u24 v182, 10, v181
    v_sub_u32 v180, v180, v182
    v_lshlrev_b32 v180, 4, v180
    v_mul_u32_u24 v182, 1280, v181
    v_add_u32 v5, v182, v180
    v_bfe_u32 v182, v181, 2, 2
    v_lshlrev_b32 v182, 3, v182
    v_and_b32 v169, 3, v181
    v_add_u32 v182, v182, v169
    v_lshrrev_b32 v181, 4, v181
    v_lshl_add_u32 v182, v181, 2, v182
    v_mul_u32_u24 v182, 1280, v182
    v_add_u32 v169, v182, v180
    s_add_u32 m0, s83, 1024
    s_nop 0
    buffer_load_dwordx4 v169, s[8:11], s41 offen lds
    v_add_u32 v180, 128, v0
    v_mul_u32_u24 v181, 6554, v180
    v_lshrrev_b32 v181, 16, v181
    v_mul_u32_u24 v182, 10, v181
    v_sub_u32 v180, v180, v182
    v_lshlrev_b32 v180, 4, v180
    v_mul_u32_u24 v182, 1280, v181
    v_add_u32 v6, v182, v180
    v_bfe_u32 v182, v181, 2, 2
    v_lshlrev_b32 v182, 3, v182
    v_and_b32 v170, 3, v181
    v_add_u32 v182, v182, v170
    v_lshrrev_b32 v181, 4, v181
    v_lshl_add_u32 v182, v181, 2, v182
    v_mul_u32_u24 v182, 1280, v182
    v_add_u32 v170, v182, v180
    s_add_u32 m0, s83, 2048
    s_nop 0
    buffer_load_dwordx4 v170, s[8:11], s41 offen lds
    v_add_u32 v180, 192, v0
    v_mul_u32_u24 v181, 6554, v180
    v_lshrrev_b32 v181, 16, v181
    v_mul_u32_u24 v182, 10, v181
    v_sub_u32 v180, v180, v182
    v_lshlrev_b32 v180, 4, v180
    v_mul_u32_u24 v182, 1280, v181
    v_add_u32 v7, v182, v180
    v_bfe_u32 v182, v181, 2, 2
    v_lshlrev_b32 v182, 3, v182
    v_and_b32 v171, 3, v181
    v_add_u32 v182, v182, v171
    v_lshrrev_b32 v181, 4, v181
    v_lshl_add_u32 v182, v181, 2, v182
    v_mul_u32_u24 v182, 1280, v182
    v_add_u32 v171, v182, v180
    s_add_u32 m0, s83, 3072
    s_nop 0
    buffer_load_dwordx4 v171, s[8:11], s41 offen lds
    v_add_u32 v180, 256, v0
    v_mul_u32_u24 v181, 6554, v180
    v_lshrrev_b32 v181, 16, v181
    v_mul_u32_u24 v182, 10, v181
    v_sub_u32 v180, v180, v182
    v_lshlrev_b32 v180, 4, v180
    v_mul_u32_u24 v182, 1280, v181
    v_add_u32 v8, v182, v180
    v_bfe_u32 v182, v181, 2, 2
    v_lshlrev_b32 v182, 3, v182
    v_and_b32 v172, 3, v181
    v_add_u32 v182, v182, v172
    v_lshrrev_b32 v181, 4, v181
    v_lshl_add_u32 v182, v181, 2, v182
    v_mul_u32_u24 v182, 1280, v182
    v_add_u32 v172, v182, v180
    s_add_u32 m0, s83, 4096
    s_nop 0
    buffer_load_dwordx4 v172, s[8:11], s41 offen lds
    s_add_u32 s76, s80, 1
    s_cmp_ge_u32 s76, 5
    s_cselect_b32 s77, 5, 0
    s_sub_u32 s76, s76, s77
    s_lshl_b32 s37, s76, 8
    s_lshl_b32 s76, s76, 2
    s_add_u32 s76, s76, s64
    s_mul_i32 s76, s76, 40960
    s_add_u32 s48, s76, s75
    s_add_u32 s76, s80, 2
    s_cmp_ge_u32 s76, 5
    s_cselect_b32 s77, 5, 0
    s_sub_u32 s76, s76, s77
    s_lshl_b32 s38, s76, 8
    s_lshl_b32 s76, s76, 2
    s_add_u32 s76, s76, s64
    s_mul_i32 s76, s76, 40960
    s_add_u32 s49, s76, s75
    s_add_u32 s76, s80, 3
    s_cmp_ge_u32 s76, 5
    s_cselect_b32 s77, 5, 0
    s_sub_u32 s76, s76, s77
    s_lshl_b32 s39, s76, 8
    s_lshl_b32 s76, s76, 2
    s_add_u32 s76, s76, s64
    s_mul_i32 s76, s76, 40960
    s_add_u32 s50, s76, s75
    s_add_u32 s76, s80, 4
    s_cmp_ge_u32 s76, 5
    s_cselect_b32 s77, 5, 0
    s_sub_u32 s76, s76, s77
    s_lshl_b32 s40, s76, 8
    s_lshl_b32 s76, s76, 2
    s_add_u32 s76, s76, s64
    s_mul_i32 s76, s76, 40960
    s_add_u32 s51, s76, s75
    s_mov_b64 s[32:33], s[60:61]
    s_mov_b32 s34, 256
    s_mov_b32 s35, 0x20000
    s_cmp_ge_u32 s3, 16
    s_cbranch_scc1 L_noinit_2
    v_mov_b32 v212, 0
    v_mov_b32 v213, 0
    v_mov_b32 v214, 0
    v_mov_b32 v215, 0
    s_lshl_b32 s77, s3, 12
    buffer_store_dwordx4 v[212:215], v1, s[12:15], s77 offen offset:0 sc1
    buffer_store_dwordx4 v[212:215], v1, s[12:15], s77 offen offset:1024 sc1
    buffer_store_dwordx4 v[212:215], v1, s[12:15], s77 offen offset:2048 sc1
    buffer_store_dwordx4 v[212:215], v1, s[12:15], s77 offen offset:3072 sc1
L_noinit_2:
    v_lshlrev_b32 v196, 7, v0
    v_lshlrev_b32 v3, 3, v0
    v_add_u32 v3, 2048, v3
    v_lshrrev_b32 v180, 2, v0
    v_mul_u32_u24 v180, 160, v180
    v_and_b32 v181, 3, v0
    v_lshl_add_u32 v9, v181, 3, v180
    v_add_u32 v10, 0x10000, v9
    v_add_u32 v11, 0x20000, v9
    v_lshrrev_b32 v180, 2, v2
    v_lshlrev_b32 v180, 10, v180
    v_and_b32 v181, 3, v2
    v_lshl_add_u32 v180, v181, 8, v180
    v_add_u32 v180, s101, v180
    v_xor_b32 v181, v2, v37
    v_lshl_add_u32 v164, v181, 4, v180
    v_xor_b32 v165, 64, v164
    v_xor_b32 v166, 128, v164
    v_xor_b32 v167, 192, v164
    s_mov_b32 s68, 0xbdd2d3e8
    s_mov_b32 s69, 0xc0135761
    s_mov_b32 s70, 0xbfb8aa3b
    s_mov_b32 s71, 0x3acccccd
    s_mov_b32 s72, 0x3727c5ac
    s_mov_b32 s73, 0xffff0000
    s_mov_b32 s74, 0x3f803f80
    v_mov_b32 v34, 1
    v_mov_b32 v38, 0
    v_mov_b32 v176, s74
    v_mov_b32 v177, s74
    v_mov_b32 v178, s74
    v_mov_b32 v179, s74
    v_mov_b32 v180, 0
    v_mov_b32 v181, 0
    v_mov_b32 v182, 0
    v_mov_b32 v183, 0
    v_mov_b32 v184, 0
    v_mov_b32 v185, 0
    v_mov_b32 v186, 0
    v_mov_b32 v187, 0
    v_mov_b32 v140, 0
    v_mov_b32 v141, 0
    v_mov_b32 v142, 0
    v_mov_b32 v143, 0
    v_mov_b32 v144, 0
    v_mov_b32 v145, 0
    v_mov_b32 v146, 0
    v_mov_b32 v147, 0
    v_mov_b32 v148, 0
    v_mov_b32 v149, 0
    v_mov_b32 v150, 0
    v_mov_b32 v151, 0
    v_mov_b32 v152, 0
    v_mov_b32 v153, 0
    v_mov_b32 v154, 0
    v_mov_b32 v155, 0
    v_mov_b32 v156, 0
    v_mov_b32 v157, 0
    v_mov_b32 v158, 0
    v_mov_b32 v159, 0
    s_mov_b64 s[28:29], s[58:59]
    s_mov_b32 s30, 2621440
    s_mov_b32 s31, 0x20000
    s_add_u32 m0, s101, 4096
    s_nop 0
    buffer_load_dwordx4 v160, s[4:7], s37 offen lds
    s_add_u32 m0, s101, 5120
    s_nop 0
    buffer_load_dwordx4 v161, s[4:7], s37 offen lds
    s_add_u32 m0, s101, 6144
    s_nop 0
    buffer_load_dwordx4 v162, s[4:7], s37 offen lds
    s_add_u32 m0, s101, 7168
    s_nop 0
    buffer_load_dwordx4 v163, s[4:7], s37 offen lds
    s_add_u32 m0, s83, 20480
    s_nop 0
    buffer_load_dwordx4 v168, s[8:11], s48 offen lds
    s_add_u32 m0, s83, 21504
    s_nop 0
    buffer_load_dwordx4 v169, s[8:11], s48 offen lds
    s_add_u32 m0, s83, 22528
    s_nop 0
    buffer_load_dwordx4 v170, s[8:11], s48 offen lds
    s_add_u32 m0, s83, 23552
    s_nop 0
    buffer_load_dwordx4 v171, s[8:11], s48 offen lds
    s_add_u32 m0, s83, 24576
    s_nop 0
    buffer_load_dwordx4 v172, s[8:11], s48 offen lds
    s_mul_i32 s76, s64, 13824
    v_and_b32 v188, 1, v2
    v_cmp_eq_u32 vcc, 1, v188
    v_lshlrev_b32 v254, 2, v2
    v_lshl_add_u32 v254, v37, 4, v254
    v_add3_u32 v254, v254, 4, s76
    v_mov_b32 v188, 9440
    v_mov_b32 v189, 4800
    v_cndmask_b32 v188, v188, v189, vcc
    v_lshrrev_b32 v189, 1, v2
    v_lshlrev_b32 v189, 6, v189
    v_sub_u32 v188, v188, v189
    v_lshlrev_b32 v189, 4, v37
    v_add3_u32 v255, v188, v189, s76
    s_cmp_ge_u32 s3, 16
    s_cbranch_scc1 L_noinit2_3
    s_waitcnt vmcnt(9)
    s_mov_b64 exec, 1
    buffer_atomic_add v34, v38, s[32:35], 0 offen sc1
    s_mov_b64 exec, -1
L_noinit2_3:
    s_cmp_lg_u32 s64, 3
    s_cbranch_scc1 L_nop3b_4
    s_waitcnt vmcnt(18)
    ds_read_b64_tr_b16 a[216:217], v173 offset:0
    ds_read_b64_tr_b16 a[218:219], v173 offset:2048
    ds_read_b64_tr_b16 a[220:221], v173 offset:32
    ds_read_b64_tr_b16 a[222:223], v173 offset:2080
    ds_read_b64_tr_b16 a[224:225], v173 offset:64
    ds_read_b64_tr_b16 a[226:227], v173 offset:2112
    ds_read_b64_tr_b16 a[228:229], v173 offset:96
    ds_read_b64_tr_b16 a[230:231], v173 offset:2144
    s_waitcnt lgkmcnt(6)
    buffer_store_dwordx4 a[216:219], v1, s[12:15], s94 offen sc1
    s_waitcnt lgkmcnt(4)
    buffer_store_dwordx4 a[220:223], v1, s[12:15], s95 offen sc1
    s_waitcnt lgkmcnt(2)
    buffer_store_dwordx4 a[224:227], v1, s[12:15], s96 offen sc1
    s_waitcnt lgkmcnt(0)
    buffer_store_dwordx4 a[228:231], v1, s[12:15], s97 offen sc1
L_nop3b_4:
    s_waitcnt vmcnt(14)
    ds_read_b128 v[40:43], v164 offset:0
    ds_read_b128 v[44:47], v165 offset:0
    ds_read_b128 v[48:51], v166 offset:0
    ds_read_b128 v[52:55], v167 offset:0
    s_waitcnt vmcnt(9)
    s_barrier
    ds_read_b64_tr_b16 a[0:1], v9 offset:0
    ds_read_b64_tr_b16 a[2:3], v9 offset:2560
    ds_read_b64_tr_b16 a[4:5], v9 offset:32
    ds_read_b64_tr_b16 a[6:7], v9 offset:2592
    ds_read_b64_tr_b16 a[8:9], v9 offset:64
    ds_read_b64_tr_b16 a[10:11], v9 offset:2624
    ds_read_b64_tr_b16 a[12:13], v9 offset:96
    ds_read_b64_tr_b16 a[14:15], v9 offset:2656
    ds_read_b64_tr_b16 a[16:17], v9 offset:128
    ds_read_b64_tr_b16 a[18:19], v9 offset:2688
    s_waitcnt lgkmcnt(12)
    v_dot2c_f32_bf16 v180, s74, v40
    v_dot2c_f32_bf16 v181, s74, v41
    s_add_u32 m0, s101, 8192
    v_dot2c_f32_bf16 v182, s74, v42
    buffer_load_dwordx4 v160, s[4:7], s38 offen lds
    v_dot2c_f32_bf16 v183, s74, v43
    v_dot2c_f32_bf16 v184, v40, v40
    v_dot2c_f32_bf16 v185, v41, v41
    v_dot2c_f32_bf16 v186, v42, v42
    v_dot2c_f32_bf16 v187, v43, v43
    v_dot2c_f32_bf16 v180, s74, v44
    v_dot2c_f32_bf16 v181, s74, v45
    v_dot2c_f32_bf16 v182, s74, v46
    v_dot2c_f32_bf16 v183, s74, v47
    v_dot2c_f32_bf16 v184, v44, v44
    v_dot2c_f32_bf16 v185, v45, v45
    v_dot2c_f32_bf16 v186, v46, v46
    v_dot2c_f32_bf16 v187, v47, v47
    s_waitcnt lgkmcnt(10)
    v_dot2c_f32_bf16 v180, s74, v48
    v_dot2c_f32_bf16 v181, s74, v49
    s_add_u32 m0, s101, 9216
    v_dot2c_f32_bf16 v182, s74, v50
    buffer_load_dwordx4 v161, s[4:7], s38 offen lds
    v_dot2c_f32_bf16 v183, s74, v51
    v_dot2c_f32_bf16 v184, v48, v48
    v_dot2c_f32_bf16 v185, v49, v49
    v_dot2c_f32_bf16 v186, v50, v50
    v_dot2c_f32_bf16 v187, v51, v51
    v_dot2c_f32_bf16 v180, s74, v52
    v_dot2c_f32_bf16 v181, s74, v53
    v_dot2c_f32_bf16 v182, s74, v54
    v_dot2c_f32_bf16 v183, s74, v55
    v_dot2c_f32_bf16 v184, v52, v52
    v_dot2c_f32_bf16 v185, v53, v53
    v_dot2c_f32_bf16 v186, v54, v54
    v_dot2c_f32_bf16 v187, v55, v55
    s_waitcnt lgkmcnt(6)
    v_mfma_f32_16x16x32_bf16 v[120:123], a[0:3], v[40:43], 0
    ds_read_b64_tr_b16 a[20:21], v9 offset:5120
    ds_read_b64_tr_b16 a[22:23], v9 offset:7680
    s_add_u32 m0, s101, 10240
    v_mfma_f32_16x16x32_bf16 v[124:127], a[4:7], v[40:43], 0
    buffer_load_dwordx4 v162, s[4:7], s38 offen lds
    ds_read_b64_tr_b16 a[24:25], v9 offset:5152
    ds_read_b64_tr_b16 a[26:27], v9 offset:7712
    s_waitcnt lgkmcnt(6)
    v_mfma_f32_16x16x32_bf16 v[128:131], a[8:11], v[40:43], 0
    ds_read_b64_tr_b16 a[28:29], v9 offset:5184
    ds_read_b64_tr_b16 a[30:31], v9 offset:7744
    s_add_u32 m0, s101, 11264
    v_mfma_f32_16x16x32_bf16 v[132:135], a[12:15], v[40:43], 0
    buffer_load_dwordx4 v163, s[4:7], s38 offen lds
    ds_read_b64_tr_b16 a[32:33], v9 offset:5216
    ds_read_b64_tr_b16 a[34:35], v9 offset:7776
    s_waitcnt lgkmcnt(8)
    v_mfma_f32_16x16x32_bf16 v[136:139], a[16:19], v[40:43], 0
    ds_read_b64_tr_b16 a[36:37], v9 offset:5248
    ds_read_b64_tr_b16 a[38:39], v9 offset:7808
    s_cmp_lg_u32 s64, 0
    s_cbranch_scc1 L_cs_5
    v_mfma_f32_16x16x32_bf16 v[140:143], a[0:3], v[176:179], v[140:143]
    v_mfma_f32_16x16x32_bf16 v[144:147], a[4:7], v[176:179], v[144:147]
    v_mfma_f32_16x16x32_bf16 v[148:151], a[8:11], v[176:179], v[148:151]
    v_mfma_f32_16x16x32_bf16 v[152:155], a[12:15], v[176:179], v[152:155]
    v_mfma_f32_16x16x32_bf16 v[156:159], a[16:19], v[176:179], v[156:159]
L_cs_5:
    s_waitcnt lgkmcnt(6)
    v_mfma_f32_16x16x32_bf16 v[120:123], a[20:23], v[44:47], v[120:123]
    ds_read_b64_tr_b16 a[0:1], v9 offset:10240
    ds_read_b64_tr_b16 a[2:3], v9 offset:12800
    s_add_u32 m0, s83, 40960
    v_mfma_f32_16x16x32_bf16 v[124:127], a[24:27], v[44:47], v[124:127]
    buffer_load_dwordx4 v168, s[8:11], s49 offen lds
    ds_read_b64_tr_b16 a[4:5], v9 offset:10272
    ds_read_b64_tr_b16 a[6:7], v9 offset:12832
    s_waitcnt lgkmcnt(6)
    v_mfma_f32_16x16x32_bf16 v[128:131], a[28:31], v[44:47], v[128:131]
    ds_read_b64_tr_b16 a[8:9], v9 offset:10304
    ds_read_b64_tr_b16 a[10:11], v9 offset:12864
    s_add_u32 m0, s83, 41984
    v_mfma_f32_16x16x32_bf16 v[132:135], a[32:35], v[44:47], v[132:135]
    buffer_load_dwordx4 v169, s[8:11], s49 offen lds
    ds_read_b64_tr_b16 a[12:13], v9 offset:10336
    ds_read_b64_tr_b16 a[14:15], v9 offset:12896
    s_waitcnt lgkmcnt(8)
    v_mfma_f32_16x16x32_bf16 v[136:139], a[36:39], v[44:47], v[136:139]
    ds_read_b64_tr_b16 a[16:17], v9 offset:10368
    ds_read_b64_tr_b16 a[18:19], v9 offset:12928
    s_cmp_lg_u32 s64, 1
    s_cbranch_scc1 L_cs_6
    v_mfma_f32_16x16x32_bf16 v[140:143], a[20:23], v[176:179], v[140:143]
    v_mfma_f32_16x16x32_bf16 v[144:147], a[24:27], v[176:179], v[144:147]
    v_mfma_f32_16x16x32_bf16 v[148:151], a[28:31], v[176:179], v[148:151]
    v_mfma_f32_16x16x32_bf16 v[152:155], a[32:35], v[176:179], v[152:155]
    v_mfma_f32_16x16x32_bf16 v[156:159], a[36:39], v[176:179], v[156:159]
L_cs_6:
    s_waitcnt lgkmcnt(6)
    v_mfma_f32_16x16x32_bf16 v[120:123], a[0:3], v[48:51], v[120:123]
    ds_read_b64_tr_b16 a[20:21], v9 offset:15360
    ds_read_b64_tr_b16 a[22:23], v9 offset:17920
    s_add_u32 m0, s83, 43008
    v_mfma_f32_16x16x32_bf16 v[124:127], a[4:7], v[48:51], v[124:127]
    buffer_load_dwordx4 v170, s[8:11], s49 offen lds
    ds_read_b64_tr_b16 a[24:25], v9 offset:15392
    ds_read_b64_tr_b16 a[26:27], v9 offset:17952
    s_waitcnt lgkmcnt(6)
    v_mfma_f32_16x16x32_bf16 v[128:131], a[8:11], v[48:51], v[128:131]
    ds_read_b64_tr_b16 a[28:29], v9 offset:15424
    ds_read_b64_tr_b16 a[30:31], v9 offset:17984
    s_add_u32 m0, s83, 44032
    v_mfma_f32_16x16x32_bf16 v[132:135], a[12:15], v[48:51], v[132:135]
    buffer_load_dwordx4 v171, s[8:11], s49 offen lds
    ds_read_b64_tr_b16 a[32:33], v9 offset:15456
    ds_read_b64_tr_b16 a[34:35], v9 offset:18016
    s_waitcnt lgkmcnt(8)
    v_mfma_f32_16x16x32_bf16 v[136:139], a[16:19], v[48:51], v[136:139]
    ds_read_b64_tr_b16 a[36:37], v9 offset:15488
    ds_read_b64_tr_b16 a[38:39], v9 offset:18048
    s_cmp_lg_u32 s64, 2
    s_cbranch_scc1 L_cs_7
    v_mfma_f32_16x16x32_bf16 v[140:143], a[0:3], v[176:179], v[140:143]
    v_mfma_f32_16x16x32_bf16 v[144:147], a[4:7], v[176:179], v[144:147]
    v_mfma_f32_16x16x32_bf16 v[148:151], a[8:11], v[176:179], v[148:151]
    v_mfma_f32_16x16x32_bf16 v[152:155], a[12:15], v[176:179], v[152:155]
    v_mfma_f32_16x16x32_bf16 v[156:159], a[16:19], v[176:179], v[156:159]
L_cs_7:
    s_waitcnt lgkmcnt(6)
    v_mfma_f32_16x16x32_bf16 v[120:123], a[20:23], v[52:55], v[120:123]
    s_add_u32 m0, s83, 45056
    v_mfma_f32_16x16x32_bf16 v[124:127], a[24:27], v[52:55], v[124:127]
    buffer_load_dwordx4 v172, s[8:11], s49 offen lds
    s_waitcnt lgkmcnt(2)
    v_mfma_f32_16x16x32_bf16 v[128:131], a[28:31], v[52:55], v[128:131]
    v_mfma_f32_16x16x32_bf16 v[132:135], a[32:35], v[52:55], v[132:135]
    s_waitcnt lgkmcnt(0)
    v_mfma_f32_16x16x32_bf16 v[136:139], a[36:39], v[52:55], v[136:139]
    s_cmp_lg_u32 s64, 3
    s_cbranch_scc1 L_cs_8
    v_mfma_f32_16x16x32_bf16 v[140:143], a[20:23], v[176:179], v[140:143]
    v_mfma_f32_16x16x32_bf16 v[144:147], a[24:27], v[176:179], v[144:147]
    v_mfma_f32_16x16x32_bf16 v[148:151], a[28:31], v[176:179], v[148:151]
    v_mfma_f32_16x16x32_bf16 v[152:155], a[32:35], v[176:179], v[152:155]
    v_mfma_f32_16x16x32_bf16 v[156:159], a[36:39], v[176:179], v[156:159]
L_cs_8:
    buffer_load_dword v199, v38, s[32:35], 0 offen sc1
    s_waitcnt vmcnt(15)
    ds_read_b128 v[56:59], v164 offset:4096
    ds_read_b128 v[60:63], v165 offset:4096
    ds_read_b128 v[64:67], v166 offset:4096
    ds_read_b128 v[68:71], v167 offset:4096
    s_waitcnt vmcnt(10)
    s_barrier
    ds_read_b64_tr_b16 a[0:1], v9 offset:20480
    ds_read_b64_tr_b16 a[2:3], v9 offset:23040
    ds_read_b64_tr_b16 a[4:5], v9 offset:20512
    ds_read_b64_tr_b16 a[6:7], v9 offset:23072
    ds_read_b64_tr_b16 a[8:9], v9 offset:20544
    ds_read_b64_tr_b16 a[10:11], v9 offset:23104
    ds_read_b64_tr_b16 a[12:13], v9 offset:20576
    ds_read_b64_tr_b16 a[14:15], v9 offset:23136
    ds_read_b64_tr_b16 a[16:17], v9 offset:20608
    ds_read_b64_tr_b16 a[18:19], v9 offset:23168
    s_waitcnt lgkmcnt(12)
    v_dot2c_f32_bf16 v180, s74, v56
    v_dot2c_f32_bf16 v181, s74, v57
    s_add_u32 m0, s101, 0
    v_dot2c_f32_bf16 v182, s74, v58
    buffer_load_dwordx4 v160, s[4:7], s39 offen lds
    v_dot2c_f32_bf16 v183, s74, v59
    v_dot2c_f32_bf16 v184, v56, v56
    v_dot2c_f32_bf16 v185, v57, v57
    v_dot2c_f32_bf16 v186, v58, v58
    v_dot2c_f32_bf16 v187, v59, v59
    v_dot2c_f32_bf16 v180, s74, v60
    v_dot2c_f32_bf16 v181, s74, v61
    v_dot2c_f32_bf16 v182, s74, v62
    v_dot2c_f32_bf16 v183, s74, v63
    v_dot2c_f32_bf16 v184, v60, v60
    v_dot2c_f32_bf16 v185, v61, v61
    v_dot2c_f32_bf16 v186, v62, v62
    v_dot2c_f32_bf16 v187, v63, v63
    s_waitcnt lgkmcnt(10)
    v_dot2c_f32_bf16 v180, s74, v64
    v_dot2c_f32_bf16 v181, s74, v65
    s_add_u32 m0, s101, 1024
    v_dot2c_f32_bf16 v182, s74, v66
    buffer_load_dwordx4 v161, s[4:7], s39 offen lds
    v_dot2c_f32_bf16 v183, s74, v67
    v_dot2c_f32_bf16 v184, v64, v64
    v_dot2c_f32_bf16 v185, v65, v65
    v_dot2c_f32_bf16 v186, v66, v66
    v_dot2c_f32_bf16 v187, v67, v67
    v_dot2c_f32_bf16 v180, s74, v68
    v_dot2c_f32_bf16 v181, s74, v69
    v_dot2c_f32_bf16 v182, s74, v70
    v_dot2c_f32_bf16 v183, s74, v71
    v_dot2c_f32_bf16 v184, v68, v68
    v_dot2c_f32_bf16 v185, v69, v69
    v_dot2c_f32_bf16 v186, v70, v70
    v_dot2c_f32_bf16 v187, v71, v71
    s_waitcnt lgkmcnt(6)
    v_mfma_f32_16x16x32_bf16 v[120:123], a[0:3], v[56:59], v[120:123]
    ds_read_b64_tr_b16 a[20:21], v9 offset:25600
    ds_read_b64_tr_b16 a[22:23], v9 offset:28160
    s_add_u32 m0, s101, 2048
    v_mfma_f32_16x16x32_bf16 v[124:127], a[4:7], v[56:59], v[124:127]
    buffer_load_dwordx4 v162, s[4:7], s39 offen lds
    ds_read_b64_tr_b16 a[24:25], v9 offset:25632
    ds_read_b64_tr_b16 a[26:27], v9 offset:28192
    s_waitcnt lgkmcnt(6)
    v_mfma_f32_16x16x32_bf16 v[128:131], a[8:11], v[56:59], v[128:131]
    ds_read_b64_tr_b16 a[28:29], v9 offset:25664
    ds_read_b64_tr_b16 a[30:31], v9 offset:28224
    s_add_u32 m0, s101, 3072
    v_mfma_f32_16x16x32_bf16 v[132:135], a[12:15], v[56:59], v[132:135]
    buffer_load_dwordx4 v163, s[4:7], s39 offen lds
    ds_read_b64_tr_b16 a[32:33], v9 offset:25696
    ds_read_b64_tr_b16 a[34:35], v9 offset:28256
    s_waitcnt lgkmcnt(8)
    v_mfma_f32_16x16x32_bf16 v[136:139], a[16:19], v[56:59], v[136:139]
    ds_read_b64_tr_b16 a[36:37], v9 offset:25728
    ds_read_b64_tr_b16 a[38:39], v9 offset:28288
    s_cmp_lg_u32 s64, 0
    s_cbranch_scc1 L_cs_9
    v_mfma_f32_16x16x32_bf16 v[140:143], a[0:3], v[176:179], v[140:143]
    v_mfma_f32_16x16x32_bf16 v[144:147], a[4:7], v[176:179], v[144:147]
    v_mfma_f32_16x16x32_bf16 v[148:151], a[8:11], v[176:179], v[148:151]
    v_mfma_f32_16x16x32_bf16 v[152:155], a[12:15], v[176:179], v[152:155]
    v_mfma_f32_16x16x32_bf16 v[156:159], a[16:19], v[176:179], v[156:159]
L_cs_9:
    s_waitcnt lgkmcnt(6)
    v_mfma_f32_16x16x32_bf16 v[120:123], a[20:23], v[60:63], v[120:123]
    ds_read_b64_tr_b16 a[0:1], v9 offset:30720
    ds_read_b64_tr_b16 a[2:3], v9 offset:33280
    s_add_u32 m0, s83, 61440
    v_mfma_f32_16x16x32_bf16 v[124:127], a[24:27], v[60:63], v[124:127]
    buffer_load_dwordx4 v168, s[8:11], s50 offen lds
    ds_read_b64_tr_b16 a[4:5], v9 offset:30752
    ds_read_b64_tr_b16 a[6:7], v9 offset:33312
    s_waitcnt lgkmcnt(6)
    v_mfma_f32_16x16x32_bf16 v[128:131], a[28:31], v[60:63], v[128:131]
    ds_read_b64_tr_b16 a[8:9], v9 offset:30784
    ds_read_b64_tr_b16 a[10:11], v9 offset:33344
    s_add_u32 m0, s83, 62464
    v_mfma_f32_16x16x32_bf16 v[132:135], a[32:35], v[60:63], v[132:135]
    buffer_load_dwordx4 v169, s[8:11], s50 offen lds
    ds_read_b64_tr_b16 a[12:13], v9 offset:30816
    ds_read_b64_tr_b16 a[14:15], v9 offset:33376
    s_waitcnt lgkmcnt(8)
    v_mfma_f32_16x16x32_bf16 v[136:139], a[36:39], v[60:63], v[136:139]
    ds_read_b64_tr_b16 a[16:17], v9 offset:30848
    ds_read_b64_tr_b16 a[18:19], v9 offset:33408
    s_cmp_lg_u32 s64, 1
    s_cbranch_scc1 L_cs_10
    v_mfma_f32_16x16x32_bf16 v[140:143], a[20:23], v[176:179], v[140:143]
    v_mfma_f32_16x16x32_bf16 v[144:147], a[24:27], v[176:179], v[144:147]
    v_mfma_f32_16x16x32_bf16 v[148:151], a[28:31], v[176:179], v[148:151]
    v_mfma_f32_16x16x32_bf16 v[152:155], a[32:35], v[176:179], v[152:155]
    v_mfma_f32_16x16x32_bf16 v[156:159], a[36:39], v[176:179], v[156:159]
L_cs_10:
    s_waitcnt lgkmcnt(6)
    v_mfma_f32_16x16x32_bf16 v[120:123], a[0:3], v[64:67], v[120:123]
    ds_read_b64_tr_b16 a[20:21], v9 offset:35840
    ds_read_b64_tr_b16 a[22:23], v9 offset:38400
    s_add_u32 m0, s83, 63488
    v_mfma_f32_16x16x32_bf16 v[124:127], a[4:7], v[64:67], v[124:127]
    buffer_load_dwordx4 v170, s[8:11], s50 offen lds
    ds_read_b64_tr_b16 a[24:25], v9 offset:35872
    ds_read_b64_tr_b16 a[26:27], v9 offset:38432
    s_waitcnt lgkmcnt(6)
    v_mfma_f32_16x16x32_bf16 v[128:131], a[8:11], v[64:67], v[128:131]
    ds_read_b64_tr_b16 a[28:29], v9 offset:35904
    ds_read_b64_tr_b16 a[30:31], v9 offset:38464
    s_add_u32 m0, s83, 64512
    v_mfma_f32_16x16x32_bf16 v[132:135], a[12:15], v[64:67], v[132:135]
    buffer_load_dwordx4 v171, s[8:11], s50 offen lds
    ds_read_b64_tr_b16 a[32:33], v9 offset:35936
    ds_read_b64_tr_b16 a[34:35], v9 offset:38496
    s_waitcnt lgkmcnt(8)
    v_mfma_f32_16x16x32_bf16 v[136:139], a[16:19], v[64:67], v[136:139]
    ds_read_b64_tr_b16 a[36:37], v9 offset:35968
    ds_read_b64_tr_b16 a[38:39], v9 offset:38528
    s_cmp_lg_u32 s64, 2
    s_cbranch_scc1 L_cs_11
    v_mfma_f32_16x16x32_bf16 v[140:143], a[0:3], v[176:179], v[140:143]
    v_mfma_f32_16x16x32_bf16 v[144:147], a[4:7], v[176:179], v[144:147]
    v_mfma_f32_16x16x32_bf16 v[148:151], a[8:11], v[176:179], v[148:151]
    v_mfma_f32_16x16x32_bf16 v[152:155], a[12:15], v[176:179], v[152:155]
    v_mfma_f32_16x16x32_bf16 v[156:159], a[16:19], v[176:179], v[156:159]
L_cs_11:
    s_waitcnt lgkmcnt(6)
    v_mfma_f32_16x16x32_bf16 v[120:123], a[20:23], v[68:71], v[120:123]
    s_add_u32 m0, s83, 65536
    v_mfma_f32_16x16x32_bf16 v[124:127], a[24:27], v[68:71], v[124:127]
    buffer_load_dwordx4 v172, s[8:11], s50 offen lds
    s_waitcnt lgkmcnt(2)
    v_mfma_f32_16x16x32_bf16 v[128:131], a[28:31], v[68:71], v[128:131]
    v_mfma_f32_16x16x32_bf16 v[132:135], a[32:35], v[68:71], v[132:135]
    s_waitcnt lgkmcnt(0)
    v_mfma_f32_16x16x32_bf16 v[136:139], a[36:39], v[68:71], v[136:139]
    s_cmp_lg_u32 s64, 3
    s_cbranch_scc1 L_cs_12
    v_mfma_f32_16x16x32_bf16 v[140:143], a[20:23], v[176:179], v[140:143]
    v_mfma_f32_16x16x32_bf16 v[144:147], a[24:27], v[176:179], v[144:147]
    v_mfma_f32_16x16x32_bf16 v[148:151], a[28:31], v[176:179], v[148:151]
    v_mfma_f32_16x16x32_bf16 v[152:155], a[32:35], v[176:179], v[152:155]
    v_mfma_f32_16x16x32_bf16 v[156:159], a[36:39], v[176:179], v[156:159]
L_cs_12:
    s_mov_b64 s[24:25], s[42:43]
    s_mov_b32 s26, 5120
    s_mov_b32 s27, 0x20000
    s_mul_i32 s76, s66, 640
    v_lshlrev_b32 v198, 3, v2
    buffer_load_dwordx2 v[200:201], v198, s[24:27], s76 offen offset:0
    buffer_load_dwordx2 v[202:203], v198, s[24:27], s76 offen offset:128
    buffer_load_dwordx2 v[204:205], v198, s[24:27], s76 offen offset:256
    buffer_load_dwordx2 v[206:207], v198, s[24:27], s76 offen offset:384
    buffer_load_dwordx2 v[208:209], v198, s[24:27], s76 offen offset:512
    s_and_b32 s76, s84, 3
    s_andn2_b32 s84, s84, 3
    s_cmp_eq_u32 s76, 0
    s_cselect_b64 s[24:25], s[52:53], s[56:57]
    s_cmp_eq_u32 s76, 1
    s_cselect_b64 s[24:25], s[54:55], s[24:25]
    s_mov_b32 s77, 1280
    s_cselect_b32 s77, 3456, s77
    s_cmp_eq_u32 s76, 0
    s_mov_b32 s76, 2211840
    s_cselect_b32 s26, 819200, s76
    s_mov_b32 s27, 0x20000
    v_lshrrev_b32 v192, 3, v0
    v_mul_u32_u24 v192, s77, v192
    v_and_b32 v193, 7, v0
    v_lshl_add_u32 v192, v193, 4, v192
    s_lshl_b32 s77, s77, 3
    s_add_u32 m0, s83, 0
    s_nop 0
    buffer_load_dwordx4 v192, s[24:27], s84 offen lds
    s_add_u32 s84, s84, s77
    s_add_u32 m0, s83, 1024
    s_nop 0
    buffer_load_dwordx4 v192, s[24:27], s84 offen lds
    s_add_u32 m0, s83, 2048
    s_nop 0
    buffer_load_dwordx4 v192, s[24:27], s85 offen lds
    s_add_u32 s85, s85, s77
    s_add_u32 m0, s83, 3072
    s_nop 0
    buffer_load_dwordx4 v192, s[24:27], s85 offen lds
    v_lshrrev_b32 v192, 2, v0
    v_lshlrev_b32 v192, 7, v192
    v_and_b32 v193, 3, v0
    v_lshl_add_u32 v192, v193, 3, v192
    s_add_u32 s76, s83, 0
    v_add_u32 v192, s76, v192
    v_mov_b32 v193, s90
    v_writelane_b32 v193, s91, 2
    v_writelane_b32 v193, s91, 3
    v_and_b32 v194, 1, v0
    v_lshlrev_b32 v194, 4, v194
    v_lshrrev_b32 v193, v194, v193
    v_and_b32 v193, 0xffff, v193
    v_lshlrev_b32 v193, 7, v193
    v_mov_b32 v194, 0x7ffffff0
    v_cmp_lt_u32 vcc, 0x10000, v193
    s_nop 1
    v_cndmask_b32 v193, v193, v194, vcc
    s_waitcnt vmcnt(24)
    ds_read_b128 v[72:75], v164 offset:8192
    ds_read_b128 v[76:79], v165 offset:8192
    ds_read_b128 v[80:83], v166 offset:8192
    ds_read_b128 v[84:87], v167 offset:8192
    s_waitcnt vmcnt(19)
    s_waitcnt vmcnt(18)
    v_cmp_gt_u32 vcc, 16, v199
    s_cbranch_vccz L_ok_14
    s_mov_b32 s79, 0
L_spin_13:
    s_sleep 1
    buffer_load_dword v199, v38, s[32:35], 0 offen sc1
    s_add_u32 s79, s79, 1
    s_cmp_gt_u32 s79, 200000
    s_cbranch_scc1 L_ok_14
    s_waitcnt vmcnt(0)
    v_cmp_gt_u32 vcc, 16, v199
    s_cbranch_vccnz L_spin_13
L_ok_14:
    s_cmp_lg_u32 s64, 3
    s_cbranch_scc1 L_nop3c_15
    s_mov_b64 exec, 15
    buffer_atomic_add v34, v174, s[12:15], 0 offen sc1
    s_mov_b64 exec, -1
L_nop3c_15:
    s_barrier
    ds_read_b64_tr_b16 a[0:1], v9 offset:40960
    ds_read_b64_tr_b16 a[2:3], v9 offset:43520
    ds_read_b64_tr_b16 a[4:5], v9 offset:40992
    ds_read_b64_tr_b16 a[6:7], v9 offset:43552
    ds_read_b64_tr_b16 a[8:9], v9 offset:41024
    ds_read_b64_tr_b16 a[10:11], v9 offset:43584
    ds_read_b64_tr_b16 a[12:13], v9 offset:41056
    ds_read_b64_tr_b16 a[14:15], v9 offset:43616
    ds_read_b64_tr_b16 a[16:17], v9 offset:41088
    ds_read_b64_tr_b16 a[18:19], v9 offset:43648
    s_waitcnt lgkmcnt(12)
    v_dot2c_f32_bf16 v180, s74, v72
    v_dot2c_f32_bf16 v181, s74, v73
    s_add_u32 m0, s101, 4096
    v_dot2c_f32_bf16 v182, s74, v74
    buffer_load_dwordx4 v160, s[4:7], s40 offen lds
    v_dot2c_f32_bf16 v183, s74, v75
    v_dot2c_f32_bf16 v184, v72, v72
    v_dot2c_f32_bf16 v185, v73, v73
    v_dot2c_f32_bf16 v186, v74, v74
    v_dot2c_f32_bf16 v187, v75, v75
    v_dot2c_f32_bf16 v180, s74, v76
    v_dot2c_f32_bf16 v181, s74, v77
    v_dot2c_f32_bf16 v182, s74, v78
    v_dot2c_f32_bf16 v183, s74, v79
    v_dot2c_f32_bf16 v184, v76, v76
    v_dot2c_f32_bf16 v185, v77, v77
    v_dot2c_f32_bf16 v186, v78, v78
    v_dot2c_f32_bf16 v187, v79, v79
    s_waitcnt lgkmcnt(10)
    v_dot2c_f32_bf16 v180, s74, v80
    v_dot2c_f32_bf16 v181, s74, v81
    s_add_u32 m0, s101, 5120
    v_dot2c_f32_bf16 v182, s74, v82
    buffer_load_dwordx4 v161, s[4:7], s40 offen lds
    v_dot2c_f32_bf16 v183, s74, v83
    v_dot2c_f32_bf16 v184, v80, v80
    v_dot2c_f32_bf16 v185, v81, v81
    v_dot2c_f32_bf16 v186, v82, v82
    v_dot2c_f32_bf16 v187, v83, v83
    v_dot2c_f32_bf16 v180, s74, v84
    v_dot2c_f32_bf16 v181, s74, v85
    v_dot2c_f32_bf16 v182, s74, v86
    v_dot2c_f32_bf16 v183, s74, v87
    v_dot2c_f32_bf16 v184, v84, v84
    v_dot2c_f32_bf16 v185, v85, v85
    v_dot2c_f32_bf16 v186, v86, v86
    v_dot2c_f32_bf16 v187, v87, v87
    s_waitcnt lgkmcnt(6)
    v_mfma_f32_16x16x32_bf16 v[120:123], a[0:3], v[72:75], v[120:123]
    ds_read_b64_tr_b16 a[20:21], v9 offset:46080
    ds_read_b64_tr_b16 a[22:23], v9 offset:48640
    s_add_u32 m0, s101, 6144
    v_mfma_f32_16x16x32_bf16 v[124:127], a[4:7], v[72:75], v[124:127]
    buffer_load_dwordx4 v162, s[4:7], s40 offen lds
    ds_read_b64_tr_b16 a[24:25], v9 offset:46112
    ds_read_b64_tr_b16 a[26:27], v9 offset:48672
    s_waitcnt lgkmcnt(6)
    v_mfma_f32_16x16x32_bf16 v[128:131], a[8:11], v[72:75], v[128:131]
    ds_read_b64_tr_b16 a[28:29], v9 offset:46144
    ds_read_b64_tr_b16 a[30:31], v9 offset:48704
    s_add_u32 m0, s101, 7168
    v_mfma_f32_16x16x32_bf16 v[132:135], a[12:15], v[72:75], v[132:135]
    buffer_load_dwordx4 v163, s[4:7], s40 offen lds
    ds_read_b64_tr_b16 a[32:33], v9 offset:46176
    ds_read_b64_tr_b16 a[34:35], v9 offset:48736
    s_waitcnt lgkmcnt(8)
    v_mfma_f32_16x16x32_bf16 v[136:139], a[16:19], v[72:75], v[136:139]
    ds_read_b64_tr_b16 a[36:37], v9 offset:46208
    ds_read_b64_tr_b16 a[38:39], v9 offset:48768
    s_cmp_lg_u32 s64, 0
    s_cbranch_scc1 L_cs_16
    v_mfma_f32_16x16x32_bf16 v[140:143], a[0:3], v[176:179], v[140:143]
    v_mfma_f32_16x16x32_bf16 v[144:147], a[4:7], v[176:179], v[144:147]
    v_mfma_f32_16x16x32_bf16 v[148:151], a[8:11], v[176:179], v[148:151]
    v_mfma_f32_16x16x32_bf16 v[152:155], a[12:15], v[176:179], v[152:155]
    v_mfma_f32_16x16x32_bf16 v[156:159], a[16:19], v[176:179], v[156:159]
L_cs_16:
    s_waitcnt lgkmcnt(6)
    v_mfma_f32_16x16x32_bf16 v[120:123], a[20:23], v[76:79], v[120:123]
    ds_read_b64_tr_b16 a[0:1], v9 offset:51200
    ds_read_b64_tr_b16 a[2:3], v9 offset:53760
    s_add_u32 m0, s83, 81920
    v_mfma_f32_16x16x32_bf16 v[124:127], a[24:27], v[76:79], v[124:127]
    buffer_load_dwordx4 v168, s[8:11], s51 offen lds
    ds_read_b64_tr_b16 a[4:5], v9 offset:51232
    ds_read_b64_tr_b16 a[6:7], v9 offset:53792
    s_waitcnt lgkmcnt(6)
    v_mfma_f32_16x16x32_bf16 v[128:131], a[28:31], v[76:79], v[128:131]
    ds_read_b64_tr_b16 a[8:9], v9 offset:51264
    ds_read_b64_tr_b16 a[10:11], v9 offset:53824
    s_add_u32 m0, s83, 82944
    v_mfma_f32_16x16x32_bf16 v[132:135], a[32:35], v[76:79], v[132:135]
    buffer_load_dwordx4 v169, s[8:11], s51 offen lds
    ds_read_b64_tr_b16 a[12:13], v9 offset:51296
    ds_read_b64_tr_b16 a[14:15], v9 offset:53856
    s_waitcnt lgkmcnt(8)
    v_mfma_f32_16x16x32_bf16 v[136:139], a[36:39], v[76:79], v[136:139]
    ds_read_b64_tr_b16 a[16:17], v9 offset:51328
    ds_read_b64_tr_b16 a[18:19], v9 offset:53888
    s_cmp_lg_u32 s64, 1
    s_cbranch_scc1 L_cs_17
    v_mfma_f32_16x16x32_bf16 v[140:143], a[20:23], v[176:179], v[140:143]
    v_mfma_f32_16x16x32_bf16 v[144:147], a[24:27], v[176:179], v[144:147]
    v_mfma_f32_16x16x32_bf16 v[148:151], a[28:31], v[176:179], v[148:151]
    v_mfma_f32_16x16x32_bf16 v[152:155], a[32:35], v[176:179], v[152:155]
    v_mfma_f32_16x16x32_bf16 v[156:159], a[36:39], v[176:179], v[156:159]
L_cs_17:
    s_waitcnt lgkmcnt(6)
    v_mfma_f32_16x16x32_bf16 v[120:123], a[0:3], v[80:83], v[120:123]
    ds_read_b64_tr_b16 a[20:21], v9 offset:56320
    ds_read_b64_tr_b16 a[22:23], v9 offset:58880
    s_add_u32 m0, s83, 83968
    v_mfma_f32_16x16x32_bf16 v[124:127], a[4:7], v[80:83], v[124:127]
    buffer_load_dwordx4 v170, s[8:11], s51 offen lds
    ds_read_b64_tr_b16 a[24:25], v9 offset:56352
    ds_read_b64_tr_b16 a[26:27], v9 offset:58912
    s_waitcnt lgkmcnt(6)
    v_mfma_f32_16x16x32_bf16 v[128:131], a[8:11], v[80:83], v[128:131]
    ds_read_b64_tr_b16 a[28:29], v9 offset:56384
    ds_read_b64_tr_b16 a[30:31], v9 offset:58944
    s_add_u32 m0, s83, 84992
    v_mfma_f32_16x16x32_bf16 v[132:135], a[12:15], v[80:83], v[132:135]
    buffer_load_dwordx4 v171, s[8:11], s51 offen lds
    ds_read_b64_tr_b16 a[32:33], v9 offset:56416
    ds_read_b64_tr_b16 a[34:35], v9 offset:58976
    s_waitcnt lgkmcnt(8)
    v_mfma_f32_16x16x32_bf16 v[136:139], a[16:19], v[80:83], v[136:139]
    ds_read_b64_tr_b16 a[36:37], v9 offset:56448
    ds_read_b64_tr_b16 a[38:39], v9 offset:59008
    s_cmp_lg_u32 s64, 2
    s_cbranch_scc1 L_cs_18
    v_mfma_f32_16x16x32_bf16 v[140:143], a[0:3], v[176:179], v[140:143]
    v_mfma_f32_16x16x32_bf16 v[144:147], a[4:7], v[176:179], v[144:147]
    v_mfma_f32_16x16x32_bf16 v[148:151], a[8:11], v[176:179], v[148:151]
    v_mfma_f32_16x16x32_bf16 v[152:155], a[12:15], v[176:179], v[152:155]
    v_mfma_f32_16x16x32_bf16 v[156:159], a[16:19], v[176:179], v[156:159]
L_cs_18:
    s_waitcnt lgkmcnt(6)
    v_mfma_f32_16x16x32_bf16 v[120:123], a[20:23], v[84:87], v[120:123]
    s_add_u32 m0, s83, 86016
    v_mfma_f32_16x16x32_bf16 v[124:127], a[24:27], v[84:87], v[124:127]
    buffer_load_dwordx4 v172, s[8:11], s51 offen lds
    s_waitcnt lgkmcnt(2)
    v_mfma_f32_16x16x32_bf16 v[128:131], a[28:31], v[84:87], v[128:131]
    v_mfma_f32_16x16x32_bf16 v[132:135], a[32:35], v[84:87], v[132:135]
    s_waitcnt lgkmcnt(0)
    v_mfma_f32_16x16x32_bf16 v[136:139], a[36:39], v[84:87], v[136:139]
    s_cmp_lg_u32 s64, 3
    s_cbranch_scc1 L_cs_19
    v_mfma_f32_16x16x32_bf16 v[140:143], a[20:23], v[176:179], v[140:143]
    v_mfma_f32_16x16x32_bf16 v[144:147], a[24:27], v[176:179], v[144:147]
    v_mfma_f32_16x16x32_bf16 v[148:151], a[28:31], v[176:179], v[148:151]
    v_mfma_f32_16x16x32_bf16 v[152:155], a[32:35], v[176:179], v[152:155]
    v_mfma_f32_16x16x32_bf16 v[156:159], a[36:39], v[176:179], v[156:159]
L_cs_19:
    s_waitcnt vmcnt(23)
    ds_read_b128 v[88:91], v164 offset:0
    ds_read_b128 v[92:95], v165 offset:0
    ds_read_b128 v[96:99], v166 offset:0
    ds_read_b128 v[100:103], v167 offset:0
    s_waitcnt vmcnt(18)
    s_barrier
    s_waitcnt vmcnt(9)
    ds_read_b64_tr_b16 a[200:201], v192 offset:0
    ds_read_b64_tr_b16 a[202:203], v192 offset:2048
    ds_read_b64_tr_b16 a[204:205], v192 offset:32
    ds_read_b64_tr_b16 a[206:207], v192 offset:2080
    ds_read_b64_tr_b16 a[208:209], v192 offset:64
    ds_read_b64_tr_b16 a[210:211], v192 offset:2112
    ds_read_b64_tr_b16 a[212:213], v192 offset:96
    ds_read_b64_tr_b16 a[214:215], v192 offset:2144
    ds_read_b64_tr_b16 a[0:1], v9 offset:61440
    ds_read_b64_tr_b16 a[2:3], v9 offset:64000
    ds_read_b64_tr_b16 a[4:5], v9 offset:61472
    ds_read_b64_tr_b16 a[6:7], v9 offset:64032
    ds_read_b64_tr_b16 a[8:9], v9 offset:61504
    ds_read_b64_tr_b16 a[10:11], v9 offset:64064
    ds_read_b64_tr_b16 a[12:13], v9 offset:61536
    ds_read_b64_tr_b16 a[14:15], v9 offset:64096
    ds_read_b64_tr_b16 a[16:17], v9 offset:61568
    ds_read_b64_tr_b16 a[18:19], v9 offset:64128
    s_waitcnt lgkmcnt(15)
    v_dot2c_f32_bf16 v180, s74, v88
    v_dot2c_f32_bf16 v181, s74, v89
    s_waitcnt lgkmcnt(15)
    v_dot2c_f32_bf16 v182, s74, v90
    buffer_store_dwordx4 a[200:203], v1, s[12:15], s86 offen sc1
    v_dot2c_f32_bf16 v183, s74, v91
    v_dot2c_f32_bf16 v184, v88, v88
    v_dot2c_f32_bf16 v185, v89, v89
    v_dot2c_f32_bf16 v186, v90, v90
    v_dot2c_f32_bf16 v187, v91, v91
    v_dot2c_f32_bf16 v180, s74, v92
    v_dot2c_f32_bf16 v181, s74, v93
    v_dot2c_f32_bf16 v182, s74, v94
    v_dot2c_f32_bf16 v183, s74, v95
    v_dot2c_f32_bf16 v184, v92, v92
    v_dot2c_f32_bf16 v185, v93, v93
    v_dot2c_f32_bf16 v186, v94, v94
    v_dot2c_f32_bf16 v187, v95, v95
    v_dot2c_f32_bf16 v180, s74, v96
    v_dot2c_f32_bf16 v181, s74, v97
    v_dot2c_f32_bf16 v182, s74, v98
    s_waitcnt lgkmcnt(14)
    v_dot2c_f32_bf16 v183, s74, v99
    buffer_store_dwordx4 a[204:207], v1, s[12:15], s87 offen sc1
    v_dot2c_f32_bf16 v184, v96, v96
    v_dot2c_f32_bf16 v185, v97, v97
    v_dot2c_f32_bf16 v186, v98, v98
    v_dot2c_f32_bf16 v187, v99, v99
    v_dot2c_f32_bf16 v180, s74, v100
    v_dot2c_f32_bf16 v181, s74, v101
    v_dot2c_f32_bf16 v182, s74, v102
    v_dot2c_f32_bf16 v183, s74, v103
    v_dot2c_f32_bf16 v184, v100, v100
    v_dot2c_f32_bf16 v185, v101, v101
    v_dot2c_f32_bf16 v186, v102, v102
    v_dot2c_f32_bf16 v187, v103, v103
    s_waitcnt lgkmcnt(6)
    v_mfma_f32_16x16x32_bf16 v[120:123], a[0:3], v[88:91], v[120:123]
    ds_read_b64_tr_b16 a[20:21], v10 offset:1024
    ds_read_b64_tr_b16 a[22:23], v10 offset:3584
    v_mfma_f32_16x16x32_bf16 v[124:127], a[4:7], v[88:91], v[124:127]
    buffer_store_dwordx4 a[208:211], v1, s[12:15], s88 offen sc1
    ds_read_b64_tr_b16 a[24:25], v10 offset:1056
    ds_read_b64_tr_b16 a[26:27], v10 offset:3616
    s_waitcnt lgkmcnt(6)
    v_mfma_f32_16x16x32_bf16 v[128:131], a[8:11], v[88:91], v[128:131]
    ds_read_b64_tr_b16 a[28:29], v10 offset:1088
    ds_read_b64_tr_b16 a[30:31], v10 offset:3648
    v_mfma_f32_16x16x32_bf16 v[132:135], a[12:15], v[88:91], v[132:135]
    buffer_store_dwordx4 a[212:215], v1, s[12:15], s89 offen sc1
    ds_read_b64_tr_b16 a[32:33], v10 offset:1120
    ds_read_b64_tr_b16 a[34:35], v10 offset:3680
    s_waitcnt lgkmcnt(8)
    v_mfma_f32_16x16x32_bf16 v[136:139], a[16:19], v[88:91], v[136:139]
    ds_read_b64_tr_b16 a[36:37], v10 offset:1152
    ds_read_b64_tr_b16 a[38:39], v10 offset:3712
    s_cmp_lg_u32 s64, 0
    s_cbranch_scc1 L_cs_20
    v_mfma_f32_16x16x32_bf16 v[140:143], a[0:3], v[176:179], v[140:143]
    v_mfma_f32_16x16x32_bf16 v[144:147], a[4:7], v[176:179], v[144:147]
    v_mfma_f32_16x16x32_bf16 v[148:151], a[8:11], v[176:179], v[148:151]
    v_mfma_f32_16x16x32_bf16 v[152:155], a[12:15], v[176:179], v[152:155]
    v_mfma_f32_16x16x32_bf16 v[156:159], a[16:19], v[176:179], v[156:159]
L_cs_20:
    s_waitcnt lgkmcnt(6)
    v_mfma_f32_16x16x32_bf16 v[120:123], a[20:23], v[92:95], v[120:123]
    ds_read_b64_tr_b16 a[0:1], v10 offset:6144
    ds_read_b64_tr_b16 a[2:3], v10 offset:8704
    v_mfma_f32_16x16x32_bf16 v[124:127], a[24:27], v[92:95], v[124:127]
    ds_read_b64_tr_b16 a[4:5], v10 offset:6176
    ds_read_b64_tr_b16 a[6:7], v10 offset:8736
    s_waitcnt lgkmcnt(6)
    v_mfma_f32_16x16x32_bf16 v[128:131], a[28:31], v[92:95], v[128:131]
    ds_read_b64_tr_b16 a[8:9], v10 offset:6208
    ds_read_b64_tr_b16 a[10:11], v10 offset:8768
    v_mfma_f32_16x16x32_bf16 v[132:135], a[32:35], v[92:95], v[132:135]
    ds_read_b64_tr_b16 a[12:13], v10 offset:6240
    ds_read_b64_tr_b16 a[14:15], v10 offset:8800
    s_waitcnt lgkmcnt(8)
    v_mfma_f32_16x16x32_bf16 v[136:139], a[36:39], v[92:95], v[136:139]
    ds_read_b64_tr_b16 a[16:17], v10 offset:6272
    ds_read_b64_tr_b16 a[18:19], v10 offset:8832
    s_cmp_lg_u32 s64, 1
    s_cbranch_scc1 L_cs_21
    v_mfma_f32_16x16x32_bf16 v[140:143], a[20:23], v[176:179], v[140:143]
    v_mfma_f32_16x16x32_bf16 v[144:147], a[24:27], v[176:179], v[144:147]
    v_mfma_f32_16x16x32_bf16 v[148:151], a[28:31], v[176:179], v[148:151]
    v_mfma_f32_16x16x32_bf16 v[152:155], a[32:35], v[176:179], v[152:155]
    v_mfma_f32_16x16x32_bf16 v[156:159], a[36:39], v[176:179], v[156:159]
L_cs_21:
    s_waitcnt lgkmcnt(6)
    v_mfma_f32_16x16x32_bf16 v[120:123], a[0:3], v[96:99], v[120:123]
    ds_read_b64_tr_b16 a[20:21], v10 offset:11264
    ds_read_b64_tr_b16 a[22:23], v10 offset:13824
    v_mfma_f32_16x16x32_bf16 v[124:127], a[4:7], v[96:99], v[124:127]
    ds_read_b64_tr_b16 a[24:25], v10 offset:11296
    ds_read_b64_tr_b16 a[26:27], v10 offset:13856
    s_waitcnt lgkmcnt(6)
    v_mfma_f32_16x16x32_bf16 v[128:131], a[8:11], v[96:99], v[128:131]
    ds_read_b64_tr_b16 a[28:29], v10 offset:11328
    ds_read_b64_tr_b16 a[30:31], v10 offset:13888
    v_mfma_f32_16x16x32_bf16 v[132:135], a[12:15], v[96:99], v[132:135]
    ds_read_b64_tr_b16 a[32:33], v10 offset:11360
    ds_read_b64_tr_b16 a[34:35], v10 offset:13920
    s_waitcnt lgkmcnt(8)
    v_mfma_f32_16x16x32_bf16 v[136:139], a[16:19], v[96:99], v[136:139]
    ds_read_b64_tr_b16 a[36:37], v10 offset:11392
    ds_read_b64_tr_b16 a[38:39], v10 offset:13952
    s_cmp_lg_u32 s64, 2
    s_cbranch_scc1 L_cs_22
    v_mfma_f32_16x16x32_bf16 v[140:143], a[0:3], v[176:179], v[140:143]
    v_mfma_f32_16x16x32_bf16 v[144:147], a[4:7], v[176:179], v[144:147]
    v_mfma_f32_16x16x32_bf16 v[148:151], a[8:11], v[176:179], v[148:151]
    v_mfma_f32_16x16x32_bf16 v[152:155], a[12:15], v[176:179], v[152:155]
    v_mfma_f32_16x16x32_bf16 v[156:159], a[16:19], v[176:179], v[156:159]
L_cs_22:
    s_waitcnt lgkmcnt(6)
    v_mfma_f32_16x16x32_bf16 v[120:123], a[20:23], v[100:103], v[120:123]
    v_mfma_f32_16x16x32_bf16 v[124:127], a[24:27], v[100:103], v[124:127]
    s_waitcnt lgkmcnt(2)
    v_mfma_f32_16x16x32_bf16 v[128:131], a[28:31], v[100:103], v[128:131]
    v_mfma_f32_16x16x32_bf16 v[132:135], a[32:35], v[100:103], v[132:135]
    s_waitcnt lgkmcnt(0)
    v_mfma_f32_16x16x32_bf16 v[136:139], a[36:39], v[100:103], v[136:139]
    s_cmp_lg_u32 s64, 3
    s_cbranch_scc1 L_cs_23
    v_mfma_f32_16x16x32_bf16 v[140:143], a[20:23], v[176:179], v[140:143]
    v_mfma_f32_16x16x32_bf16 v[144:147], a[24:27], v[176:179], v[144:147]
    v_mfma_f32_16x16x32_bf16 v[148:151], a[28:31], v[176:179], v[148:151]
    v_mfma_f32_16x16x32_bf16 v[152:155], a[32:35], v[176:179], v[152:155]
    v_mfma_f32_16x16x32_bf16 v[156:159], a[36:39], v[176:179], v[156:159]
L_cs_23:
    s_lshl_b32 s62, s66, 7
    s_add_u32 s62, s62, 61440
    buffer_load_dword v199, v38, s[12:15], s62 offen sc1
    s_waitcnt vmcnt(10)
    ds_read_b128 v[104:107], v164 offset:4096
    ds_read_b128 v[108:111], v165 offset:4096
    ds_read_b128 v[112:115], v166 offset:4096
    ds_read_b128 v[116:119], v167 offset:4096
    s_waitcnt vmcnt(5)
    s_barrier
    ds_read_b64_tr_b16 a[0:1], v10 offset:16384
    ds_read_b64_tr_b16 a[2:3], v10 offset:18944
    ds_read_b64_tr_b16 a[4:5], v10 offset:16416
    ds_read_b64_tr_b16 a[6:7], v10 offset:18976
    ds_read_b64_tr_b16 a[8:9], v10 offset:16448
    ds_read_b64_tr_b16 a[10:11], v10 offset:19008
    ds_read_b64_tr_b16 a[12:13], v10 offset:16480
    ds_read_b64_tr_b16 a[14:15], v10 offset:19040
    ds_read_b64_tr_b16 a[16:17], v10 offset:16512
    ds_read_b64_tr_b16 a[18:19], v10 offset:19072
    s_waitcnt lgkmcnt(12)
    v_dot2c_f32_bf16 v180, s74, v104
    v_dot2c_f32_bf16 v181, s74, v105
    s_sub_u32 s61, s67, 4
    s_mul_i32 s61, s61, 1280
    v_add_u32 v160, s61, v4
    v_add_u32 v161, s61, v5
    v_add_u32 v162, s61, v6
    v_add_u32 v163, s61, v7
    s_add_u32 m0, s101, 0
    v_dot2c_f32_bf16 v182, s74, v106
    buffer_load_dwordx4 v160, s[16:19], s75 offen lds
    v_dot2c_f32_bf16 v183, s74, v107
    v_dot2c_f32_bf16 v184, v104, v104
    v_dot2c_f32_bf16 v185, v105, v105
    v_dot2c_f32_bf16 v186, v106, v106
    v_dot2c_f32_bf16 v187, v107, v107
    v_dot2c_f32_bf16 v180, s74, v108
    v_dot2c_f32_bf16 v181, s74, v109
    v_dot2c_f32_bf16 v182, s74, v110
    v_dot2c_f32_bf16 v183, s74, v111
    s_add_u32 m0, s101, 1024
    v_dot2c_f32_bf16 v184, v108, v108
    buffer_load_dwordx4 v161, s[16:19], s75 offen lds
    v_dot2c_f32_bf16 v185, v109, v109
    v_dot2c_f32_bf16 v186, v110, v110
    v_dot2c_f32_bf16 v187, v111, v111
    s_waitcnt lgkmcnt(10)
    v_dot2c_f32_bf16 v180, s74, v112
    v_dot2c_f32_bf16 v181, s74, v113
    v_dot2c_f32_bf16 v182, s74, v114
    v_dot2c_f32_bf16 v183, s74, v115
    v_dot2c_f32_bf16 v184, v112, v112
    v_dot2c_f32_bf16 v185, v113, v113
    v_dot2c_f32_bf16 v186, v114, v114
    v_dot2c_f32_bf16 v187, v115, v115
    v_dot2c_f32_bf16 v180, s74, v116
    v_dot2c_f32_bf16 v181, s74, v117
    v_dot2c_f32_bf16 v182, s74, v118
    s_add_u32 m0, s101, 2048
    v_dot2c_f32_bf16 v183, s74, v119
    buffer_load_dwordx4 v162, s[16:19], s75 offen lds
    v_dot2c_f32_bf16 v184, v116, v116
    v_dot2c_f32_bf16 v185, v117, v117
    v_dot2c_f32_bf16 v186, v118, v118
    v_dot2c_f32_bf16 v187, v119, v119
    s_waitcnt lgkmcnt(6)
    v_mfma_f32_16x16x32_bf16 v[120:123], a[0:3], v[104:107], v[120:123]
    ds_read_b64_tr_b16 a[20:21], v10 offset:21504
    ds_read_b64_tr_b16 a[22:23], v10 offset:24064
    s_add_u32 m0, s101, 3072
    v_mfma_f32_16x16x32_bf16 v[124:127], a[4:7], v[104:107], v[124:127]
    s_mov_b64 exec, 0xff
    buffer_load_dwordx4 v163, s[16:19], s75 offen lds
    s_mov_b64 exec, -1
    ds_read_b64_tr_b16 a[24:25], v10 offset:21536
    ds_read_b64_tr_b16 a[26:27], v10 offset:24096
    s_waitcnt lgkmcnt(6)
    v_mfma_f32_16x16x32_bf16 v[128:131], a[8:11], v[104:107], v[128:131]
    ds_read_b64_tr_b16 a[28:29], v10 offset:21568
    ds_read_b64_tr_b16 a[30:31], v10 offset:24128
    s_mul_i32 s61, s67, 1280
    s_add_u32 s61, s61, s75
    s_add_u32 m0, s101, 3200
    v_mfma_f32_16x16x32_bf16 v[132:135], a[12:15], v[104:107], v[132:135]
    buffer_load_dwordx4 v4, s[20:23], s61 offen lds
    ds_read_b64_tr_b16 a[32:33], v10 offset:21600
    ds_read_b64_tr_b16 a[34:35], v10 offset:24160
    s_waitcnt lgkmcnt(8)
    v_mfma_f32_16x16x32_bf16 v[136:139], a[16:19], v[104:107], v[136:139]
    ds_read_b64_tr_b16 a[36:37], v10 offset:21632
    ds_read_b64_tr_b16 a[38:39], v10 offset:24192
    s_cmp_lg_u32 s64, 0
    s_cbranch_scc1 L_cs_24
    v_mfma_f32_16x16x32_bf16 v[140:143], a[0:3], v[176:179], v[140:143]
    v_mfma_f32_16x16x32_bf16 v[144:147], a[4:7], v[176:179], v[144:147]
    v_mfma_f32_16x16x32_bf16 v[148:151], a[8:11], v[176:179], v[148:151]
    v_mfma_f32_16x16x32_bf16 v[152:155], a[12:15], v[176:179], v[152:155]
    v_mfma_f32_16x16x32_bf16 v[156:159], a[16:19], v[176:179], v[156:159]
L_cs_24:
    s_waitcnt lgkmcnt(6)
    v_mfma_f32_16x16x32_bf16 v[120:123], a[20:23], v[108:111], v[120:123]
    ds_read_b64_tr_b16 a[0:1], v10 offset:26624
    ds_read_b64_tr_b16 a[2:3], v10 offset:29184
    s_add_u32 m0, s101, 4224
    v_mfma_f32_16x16x32_bf16 v[124:127], a[24:27], v[108:111], v[124:127]
    buffer_load_dwordx4 v5, s[20:23], s61 offen lds
    ds_read_b64_tr_b16 a[4:5], v10 offset:26656
    ds_read_b64_tr_b16 a[6:7], v10 offset:29216
    s_waitcnt lgkmcnt(6)
    v_mfma_f32_16x16x32_bf16 v[128:131], a[28:31], v[108:111], v[128:131]
    ds_read_b64_tr_b16 a[8:9], v10 offset:26688
    ds_read_b64_tr_b16 a[10:11], v10 offset:29248
    s_add_u32 m0, s101, 5248
    v_mfma_f32_16x16x32_bf16 v[132:135], a[32:35], v[108:111], v[132:135]
    s_mov_b32 exec_hi, 0
    buffer_load_dwordx4 v6, s[20:23], s61 offen lds
    s_mov_b64 exec, -1
    ds_read_b64_tr_b16 a[12:13], v10 offset:26720
    ds_read_b64_tr_b16 a[14:15], v10 offset:29280
    s_waitcnt lgkmcnt(8)
    v_mfma_f32_16x16x32_bf16 v[136:139], a[36:39], v[108:111], v[136:139]
    ds_read_b64_tr_b16 a[16:17], v10 offset:26752
    ds_read_b64_tr_b16 a[18:19], v10 offset:29312
    s_cmp_lg_u32 s64, 1
    s_cbranch_scc1 L_cs_25
    v_mfma_f32_16x16x32_bf16 v[140:143], a[20:23], v[176:179], v[140:143]
    v_mfma_f32_16x16x32_bf16 v[144:147], a[24:27], v[176:179], v[144:147]
    v_mfma_f32_16x16x32_bf16 v[148:151], a[28:31], v[176:179], v[148:151]
    v_mfma_f32_16x16x32_bf16 v[152:155], a[32:35], v[176:179], v[152:155]
    v_mfma_f32_16x16x32_bf16 v[156:159], a[36:39], v[176:179], v[156:159]
L_cs_25:
    s_waitcnt lgkmcnt(6)
    v_mfma_f32_16x16x32_bf16 v[120:123], a[0:3], v[112:115], v[120:123]
    ds_read_b64_tr_b16 a[20:21], v10 offset:31744
    ds_read_b64_tr_b16 a[22:23], v10 offset:34304
    v_mfma_f32_16x16x32_bf16 v[124:127], a[4:7], v[112:115], v[124:127]
    ds_read_b64_tr_b16 a[24:25], v10 offset:31776
    ds_read_b64_tr_b16 a[26:27], v10 offset:34336
    s_waitcnt lgkmcnt(6)
    v_mfma_f32_16x16x32_bf16 v[128:131], a[8:11], v[112:115], v[128:131]
    ds_read_b64_tr_b16 a[28:29], v10 offset:31808
    ds_read_b64_tr_b16 a[30:31], v10 offset:34368
    v_mfma_f32_16x16x32_bf16 v[132:135], a[12:15], v[112:115], v[132:135]
    ds_read_b64_tr_b16 a[32:33], v10 offset:31840
    ds_read_b64_tr_b16 a[34:35], v10 offset:34400
    s_waitcnt lgkmcnt(8)
    v_mfma_f32_16x16x32_bf16 v[136:139], a[16:19], v[112:115], v[136:139]
    ds_read_b64_tr_b16 a[36:37], v10 offset:31872
    ds_read_b64_tr_b16 a[38:39], v10 offset:34432
    s_cmp_lg_u32 s64, 2
    s_cbranch_scc1 L_cs_26
    v_mfma_f32_16x16x32_bf16 v[140:143], a[0:3], v[176:179], v[140:143]
    v_mfma_f32_16x16x32_bf16 v[144:147], a[4:7], v[176:179], v[144:147]
    v_mfma_f32_16x16x32_bf16 v[148:151], a[8:11], v[176:179], v[148:151]
    v_mfma_f32_16x16x32_bf16 v[152:155], a[12:15], v[176:179], v[152:155]
    v_mfma_f32_16x16x32_bf16 v[156:159], a[16:19], v[176:179], v[156:159]
L_cs_26:
    s_waitcnt lgkmcnt(6)
    v_mfma_f32_16x16x32_bf16 v[120:123], a[20:23], v[116:119], v[120:123]
    v_mfma_f32_16x16x32_bf16 v[124:127], a[24:27], v[116:119], v[124:127]
    s_waitcnt lgkmcnt(2)
    v_mfma_f32_16x16x32_bf16 v[128:131], a[28:31], v[116:119], v[128:131]
    v_mfma_f32_16x16x32_bf16 v[132:135], a[32:35], v[116:119], v[132:135]
    s_waitcnt lgkmcnt(0)
    v_mfma_f32_16x16x32_bf16 v[136:139], a[36:39], v[116:119], v[136:139]
    s_cmp_lg_u32 s64, 3
    s_cbranch_scc1 L_cs_27
    v_mfma_f32_16x16x32_bf16 v[140:143], a[20:23], v[176:179], v[140:143]
    v_mfma_f32_16x16x32_bf16 v[144:147], a[24:27], v[176:179], v[144:147]
    v_mfma_f32_16x16x32_bf16 v[148:151], a[28:31], v[176:179], v[148:151]
    v_mfma_f32_16x16x32_bf16 v[152:155], a[32:35], v[176:179], v[152:155]
    v_mfma_f32_16x16x32_bf16 v[156:159], a[36:39], v[176:179], v[156:159]
L_cs_27:
    v_lshlrev_b32 v189, 4, v37
    v_add_u32 v188, s101, v189
    v_add_u32 v189, 102400, v189
    s_mov_b32 exec_lo, 0x00010001
    s_mov_b32 exec_hi, 0x00010001
    ds_write_b128 v188, v[140:143] offset:11520
    ds_write_b128 v188, v[144:147] offset:11584
    ds_write_b128 v188, v[148:151] offset:11648
    ds_write_b128 v188, v[152:155] offset:11712
    ds_write_b128 v188, v[156:159] offset:11776
    s_mov_b64 exec, -1
    s_waitcnt lgkmcnt(0)
    s_barrier
    ds_read_b128 v[40:43], v189 offset:11520
    ds_read_b128 v[44:47], v189 offset:11584
    ds_read_b128 v[48:51], v189 offset:11648
    ds_read_b128 v[52:55], v189 offset:11712
    ds_read_b128 v[56:59], v189 offset:11776
    ds_read_b128 v[60:63], v189 offset:23808
    ds_read_b128 v[64:67], v189 offset:23872
    ds_read_b128 v[68:71], v189 offset:23936
    ds_read_b128 v[72:75], v189 offset:24000
    ds_read_b128 v[76:79], v189 offset:24064
    ds_read_b128 v[80:83], v189 offset:36096
    ds_read_b128 v[84:87], v189 offset:36160
    ds_read_b128 v[88:91], v189 offset:36224
    ds_read_b128 v[92:95], v189 offset:36288
    ds_read_b128 v[96:99], v189 offset:36352
    ds_read_b128 v[100:103], v189 offset:48384
    ds_read_b128 v[104:107], v189 offset:48448
    ds_read_b128 v[108:111], v189 offset:48512
    ds_read_b128 v[112:115], v189 offset:48576
    ds_read_b128 v[116:119], v189 offset:48640
    v_add_f32 v180, v180, v181
    v_add_f32 v182, v182, v183
    v_add_f32 v184, v184, v185
    v_add_f32 v186, v186, v187
    v_add_f32 v180, v180, v182
    v_add_f32 v181, v184, v186
    s_nop 1
    v_permlane16_swap_b32 v180, v181
    v_add_f32 v180, v180, v181
    v_mov_b32 v182, v180
    s_nop 1
    v_permlane32_swap_b32 v180, v182
    v_add_f32 v180, v180, v182
    v_mov_b32 v181, v180
    s_nop 1
    v_permlane16_swap_b32 v180, v181
    v_mul_f32 v184, s71, v180
    v_mul_f32 v181, s71, v181
    v_fma_f32 v181, -v184, v184, v181
    v_max_f32 v181, 0, v181
    v_add_f32 v182, s72, v181
    v_rsq_f32 v185, v182
    s_lshl_b32 s76, s65, 3
    v_mul_f32 v181, v181, v185
    v_mul_f32 v182, v182, v185
    v_mul_f32 v181, v181, v185
    v_add_f32 v181, s72, v181
    v_rsq_f32 v183, v181
    s_add_u32 s76, s76, s66
    v_mul_f32 v181, v181, v183
    v_mul_f32 v183, v185, v183
    v_mul_f32 v187, v181, v182
    v_sub_f32 v186, 0, v184
    v_mul_f32 v190, v183, v183
    v_mul_f32 v191, s69, v183
    v_mul_f32 v190, v190, v183
    v_mul_f32 v190, s68, v190
    s_lshl_b32 s76, s76, 9
    s_lshl_b32 s77, s64, 7
    s_add_u32 s2, s76, s77
    s_add_u32 s76, s2, 2684928
    s_mov_b64 exec, 0xffff
    buffer_store_dwordx2 v[184:185], v3, s[12:15], s76 offen sc1
    s_mov_b64 exec, -1
    s_lshl_b32 s48, s65, 2
    s_add_u32 s48, s48, s64
    s_lshl_b32 s98, s48, 7
    s_mul_i32 s48, s48, 20480
    s_mul_i32 s49, s66, 2560
    s_add_u32 s49, s49, s48
    s_add_u32 s78, s49, 65536
    s_waitcnt vmcnt(8)
    v_cmp_gt_u32 vcc, 40, v199
    s_cbranch_vccz L_ok_29
    s_mov_b32 s79, 0
L_spin_28:
    s_sleep 1
    buffer_load_dword v199, v38, s[12:15], s62 offen sc1
    s_add_u32 s79, s79, 1
    s_cmp_gt_u32 s79, 200000
    s_cbranch_scc1 L_ok_29
    s_waitcnt vmcnt(0)
    v_cmp_gt_u32 vcc, 40, v199
    s_cbranch_vccnz L_spin_28
L_ok_29:
    s_waitcnt lgkmcnt(10)
    v_pk_add_f32 v[40:41], v[40:41], v[60:61]
    v_pk_add_f32 v[42:43], v[42:43], v[62:63]
    v_pk_add_f32 v[44:45], v[44:45], v[64:65]
    v_pk_add_f32 v[46:47], v[46:47], v[66:67]
    v_pk_add_f32 v[48:49], v[48:49], v[68:69]
    v_pk_add_f32 v[50:51], v[50:51], v[70:71]
    v_pk_add_f32 v[52:53], v[52:53], v[72:73]
    v_pk_add_f32 v[54:55], v[54:55], v[74:75]
    v_pk_add_f32 v[56:57], v[56:57], v[76:77]
    v_pk_add_f32 v[58:59], v[58:59], v[78:79]
    s_waitcnt lgkmcnt(0)
    v_pk_add_f32 v[80:81], v[80:81], v[100:101]
    v_pk_add_f32 v[82:83], v[82:83], v[102:103]
    v_pk_add_f32 v[84:85], v[84:85], v[104:105]
    v_pk_add_f32 v[86:87], v[86:87], v[106:107]
    v_pk_add_f32 v[88:89], v[88:89], v[108:109]
    v_pk_add_f32 v[90:91], v[90:91], v[110:111]
    v_pk_add_f32 v[92:93], v[92:93], v[112:113]
    v_pk_add_f32 v[94:95], v[94:95], v[114:115]
    v_pk_add_f32 v[96:97], v[96:97], v[116:117]
    v_pk_add_f32 v[98:99], v[98:99], v[118:119]
    v_pk_add_f32 v[40:41], v[40:41], v[80:81]
    v_pk_add_f32 v[42:43], v[42:43], v[82:83]
    v_pk_add_f32 v[44:45], v[44:45], v[84:85]
    v_pk_add_f32 v[46:47], v[46:47], v[86:87]
    v_pk_add_f32 v[48:49], v[48:49], v[88:89]
    v_pk_add_f32 v[50:51], v[50:51], v[90:91]
    v_pk_add_f32 v[52:53], v[52:53], v[92:93]
    v_pk_add_f32 v[54:55], v[54:55], v[94:95]
    v_pk_add_f32 v[56:57], v[56:57], v[96:97]
    v_pk_add_f32 v[58:59], v[58:59], v[98:99]
    v_pk_fma_f32 v[120:121], v[40:41], v[186:187], v[120:121] op_sel_hi:[1,0,1]
    v_pk_fma_f32 v[122:123], v[42:43], v[186:187], v[122:123] op_sel_hi:[1,0,1]
    v_pk_fma_f32 v[124:125], v[44:45], v[186:187], v[124:125] op_sel_hi:[1,0,1]
    v_pk_fma_f32 v[126:127], v[46:47], v[186:187], v[126:127] op_sel_hi:[1,0,1]
    v_pk_fma_f32 v[128:129], v[48:49], v[186:187], v[128:129] op_sel_hi:[1,0,1]
    v_pk_fma_f32 v[130:131], v[50:51], v[186:187], v[130:131] op_sel_hi:[1,0,1]
    v_pk_fma_f32 v[132:133], v[52:53], v[186:187], v[132:133] op_sel_hi:[1,0,1]
    v_pk_fma_f32 v[134:135], v[54:55], v[186:187], v[134:135] op_sel_hi:[1,0,1]
    v_pk_fma_f32 v[136:137], v[56:57], v[186:187], v[136:137] op_sel_hi:[1,0,1]
    v_pk_fma_f32 v[138:139], v[58:59], v[186:187], v[138:139] op_sel_hi:[1,0,1]
    v_pk_mul_f32 v[80:81], v[120:121], v[120:121]
    v_pk_mul_f32 v[82:83], v[122:123], v[122:123]
    v_pk_mul_f32 v[84:85], v[124:125], v[124:125]
    v_pk_mul_f32 v[86:87], v[126:127], v[126:127]
    v_pk_fma_f32 v[80:81], v[80:81], v[190:191], v[190:191] op_sel:[0,0,1] op_sel_hi:[1,0,1]
    v_pk_fma_f32 v[82:83], v[82:83], v[190:191], v[190:191] op_sel:[0,0,1] op_sel_hi:[1,0,1]
    v_pk_fma_f32 v[84:85], v[84:85], v[190:191], v[190:191] op_sel:[0,0,1] op_sel_hi:[1,0,1]
    v_pk_fma_f32 v[86:87], v[86:87], v[190:191], v[190:191] op_sel:[0,0,1] op_sel_hi:[1,0,1]
    v_pk_mul_f32 v[80:81], v[80:81], v[120:121]
    v_pk_mul_f32 v[82:83], v[82:83], v[122:123]
    v_pk_mul_f32 v[84:85], v[84:85], v[124:125]
    v_pk_mul_f32 v[86:87], v[86:87], v[126:127]
    v_exp_f32 v80, v80
    v_exp_f32 v81, v81
    v_exp_f32 v82, v82
    v_exp_f32 v83, v83
    v_exp_f32 v84, v84
    v_exp_f32 v85, v85
    v_exp_f32 v86, v86
    v_exp_f32 v87, v87
    v_pk_fma_f32 v[80:81], v[80:81], v[186:187], v[186:187] op_sel:[0,1,1] op_sel_hi:[1,1,1]
    v_pk_fma_f32 v[82:83], v[82:83], v[186:187], v[186:187] op_sel:[0,1,1] op_sel_hi:[1,1,1]
    v_pk_fma_f32 v[84:85], v[84:85], v[186:187], v[186:187] op_sel:[0,1,1] op_sel_hi:[1,1,1]
    v_pk_fma_f32 v[86:87], v[86:87], v[186:187], v[186:187] op_sel:[0,1,1] op_sel_hi:[1,1,1]
    v_rcp_f32 v80, v80
    v_rcp_f32 v81, v81
    v_rcp_f32 v82, v82
    v_rcp_f32 v83, v83
    v_rcp_f32 v84, v84
    v_rcp_f32 v85, v85
    v_rcp_f32 v86, v86
    v_rcp_f32 v87, v87
    v_pk_mul_f32 v[80:81], v[80:81], v[120:121]
    v_pk_mul_f32 v[82:83], v[82:83], v[122:123]
    v_pk_mul_f32 v[84:85], v[84:85], v[124:125]
    v_pk_mul_f32 v[86:87], v[86:87], v[126:127]
    v_cvt_pk_bf16_f32 v100, v80, v81
    v_cvt_pk_bf16_f32 v101, v82, v83
    v_cvt_pk_bf16_f32 v102, v84, v85
    v_cvt_pk_bf16_f32 v103, v86, v87
    buffer_store_dwordx4 v[100:103], v1, s[12:15], s78 offen sc1
    v_pk_mul_f32 v[80:81], v[128:129], v[128:129]
    v_pk_mul_f32 v[82:83], v[130:131], v[130:131]
    v_pk_mul_f32 v[84:85], v[132:133], v[132:133]
    v_pk_mul_f32 v[86:87], v[134:135], v[134:135]
    v_pk_fma_f32 v[80:81], v[80:81], v[190:191], v[190:191] op_sel:[0,0,1] op_sel_hi:[1,0,1]
    v_pk_fma_f32 v[82:83], v[82:83], v[190:191], v[190:191] op_sel:[0,0,1] op_sel_hi:[1,0,1]
    v_pk_fma_f32 v[84:85], v[84:85], v[190:191], v[190:191] op_sel:[0,0,1] op_sel_hi:[1,0,1]
    v_pk_fma_f32 v[86:87], v[86:87], v[190:191], v[190:191] op_sel:[0,0,1] op_sel_hi:[1,0,1]
    v_pk_mul_f32 v[80:81], v[80:81], v[128:129]
    v_pk_mul_f32 v[82:83], v[82:83], v[130:131]
    v_pk_mul_f32 v[84:85], v[84:85], v[132:133]
    v_pk_mul_f32 v[86:87], v[86:87], v[134:135]
    v_exp_f32 v80, v80
    v_exp_f32 v81, v81
    v_exp_f32 v82, v82
    v_exp_f32 v83, v83
    v_exp_f32 v84, v84
    v_exp_f32 v85, v85
    v_exp_f32 v86, v86
    v_exp_f32 v87, v87
    v_pk_fma_f32 v[80:81], v[80:81], v[186:187], v[186:187] op_sel:[0,1,1] op_sel_hi:[1,1,1]
    v_pk_fma_f32 v[82:83], v[82:83], v[186:187], v[186:187] op_sel:[0,1,1] op_sel_hi:[1,1,1]
    v_pk_fma_f32 v[84:85], v[84:85], v[186:187], v[186:187] op_sel:[0,1,1] op_sel_hi:[1,1,1]
    v_pk_fma_f32 v[86:87], v[86:87], v[186:187], v[186:187] op_sel:[0,1,1] op_sel_hi:[1,1,1]
    v_rcp_f32 v80, v80
    v_rcp_f32 v81, v81
    v_rcp_f32 v82, v82
    v_rcp_f32 v83, v83
    v_rcp_f32 v84, v84
    v_rcp_f32 v85, v85
    v_rcp_f32 v86, v86
    v_rcp_f32 v87, v87
    v_pk_mul_f32 v[80:81], v[80:81], v[128:129]
    v_pk_mul_f32 v[82:83], v[82:83], v[130:131]
    v_pk_mul_f32 v[84:85], v[84:85], v[132:133]
    v_pk_mul_f32 v[86:87], v[86:87], v[134:135]
    v_cvt_pk_bf16_f32 v104, v80, v81
    v_cvt_pk_bf16_f32 v105, v82, v83
    v_cvt_pk_bf16_f32 v106, v84, v85
    v_cvt_pk_bf16_f32 v107, v86, v87
    buffer_store_dwordx4 v[104:107], v1, s[12:15], s78 offen offset:1024 sc1
    v_pk_mul_f32 v[80:81], v[136:137], v[136:137]
    v_pk_mul_f32 v[82:83], v[138:139], v[138:139]
    v_pk_fma_f32 v[80:81], v[80:81], v[190:191], v[190:191] op_sel:[0,0,1] op_sel_hi:[1,0,1]
    v_pk_fma_f32 v[82:83], v[82:83], v[190:191], v[190:191] op_sel:[0,0,1] op_sel_hi:[1,0,1]
    v_pk_mul_f32 v[80:81], v[80:81], v[136:137]
    v_pk_mul_f32 v[82:83], v[82:83], v[138:139]
    v_exp_f32 v80, v80
    v_exp_f32 v81, v81
    v_exp_f32 v82, v82
    v_exp_f32 v83, v83
    v_pk_fma_f32 v[80:81], v[80:81], v[186:187], v[186:187] op_sel:[0,1,1] op_sel_hi:[1,1,1]
    v_pk_fma_f32 v[82:83], v[82:83], v[186:187], v[186:187] op_sel:[0,1,1] op_sel_hi:[1,1,1]
    v_rcp_f32 v80, v80
    v_rcp_f32 v81, v81
    v_rcp_f32 v82, v82
    v_rcp_f32 v83, v83
    v_pk_mul_f32 v[80:81], v[80:81], v[136:137]
    v_pk_mul_f32 v[82:83], v[82:83], v[138:139]
    v_cvt_pk_bf16_f32 v108, v80, v81
    v_cvt_pk_bf16_f32 v109, v82, v83
    buffer_store_dwordx2 v[108:109], v3, s[12:15], s78 offen sc1
    s_add_u32 s78, s64, 1
    s_min_u32 s78, s78, 3
    s_sub_u32 s78, s78, s64
    s_lshl_b32 s78, s78, 7
    s_mul_i32 s61, s67, 1280
    s_add_u32 s61, s61, s75
    s_add_u32 m0, s101, 5760
    v_lshlrev_b32 v35, 2, v0
    buffer_load_dwordx4 v4, s[4:7], s61 offen lds
    v_mov_b32 v163, s78
    v_cmp_lt_u32 vcc, 7, v0
    s_nop 1
    v_cndmask_b32 v35, v35, v163, vcc
    v_add_u32 v160, s101, v9
    v_mov_b32 v9, v1
    v_add_u32 v10, 0x10000, v1
    s_add_u32 m0, s101, 6784
    v_add_u32 v11, 0x20000, v1
    buffer_load_dwordx4 v5, s[4:7], s61 offen lds
    v_mul_u32_u24 v161, 160, v2
    v_lshl_add_u32 v161, v37, 3, v161
    v_add_u32 v161, s101, v161
    v_mov_b32 v183, 0xffff
    v_alignbit_b32 v228, v200, v200, 16
    v_alignbit_b32 v229, v201, v201, 16
    v_and_b32 v230, v183, v200
    v_bfi_b32 v231, v183, v201, v200
    v_and_b32 v232, s73, v201
    v_alignbit_b32 v233, v202, v202, 16
    v_alignbit_b32 v234, v203, v203, 16
    v_and_b32 v235, v183, v202
    s_add_u32 m0, s101, 7808
    v_bfi_b32 v236, v183, v203, v202
    s_mov_b32 exec_hi, 0
    buffer_load_dwordx4 v6, s[4:7], s61 offen lds
    s_mov_b64 exec, -1
    v_and_b32 v237, s73, v203
    v_alignbit_b32 v238, v204, v204, 16
    v_alignbit_b32 v239, v205, v205, 16
    v_and_b32 v240, v183, v204
    v_bfi_b32 v241, v183, v205, v204
    v_and_b32 v242, s73, v205
    v_alignbit_b32 v243, v206, v206, 16
    v_alignbit_b32 v244, v207, v207, 16
    v_and_b32 v245, v183, v206
    v_bfi_b32 v246, v183, v207, v206
    s_mul_i32 s83, s64, 25600
    s_mul_i32 s82, s66, 102400
    s_add_u32 s82, s82, s83
    s_add_u32 s82, s82, 20643840
    s_add_u32 m0, s83, 0
    v_and_b32 v247, s73, v207
    buffer_load_dwordx4 v1, s[12:15], s82 offen offset:0 sc1 lds
    v_alignbit_b32 v248, v208, v208, 16
    v_alignbit_b32 v249, v209, v209, 16
    v_and_b32 v250, v183, v208
    v_bfi_b32 v251, v183, v209, v208
    v_and_b32 v252, s73, v209
    v_mul_u32_u24 v162, 144, v2
    v_lshlrev_b32 v163, 3, v37
    v_sub_u32 v162, v162, v163
    s_lshl_b32 s78, s64, 5
    s_sub_u32 s78, 151672, s78
    v_add_u32 v162, s78, v162
    buffer_load_dwordx4 v1, s[12:15], s82 offen offset:1024 sc1 lds
    v_lshrrev_b32 v157, 3, v0
    v_and_b32 v158, 7, v0
    v_lshlrev_b32 v158, 4, v158
    v_mul_u32_u24 v156, 144, v157
    v_add_u32 v156, v156, v158
    s_mul_i32 s78, s64, 2880
    s_add_u32 s78, s78, 151552
    v_add_u32 v156, s78, v156
    v_lshl_add_u32 v157, v157, 12, v158
    s_mul_i32 s78, s66, 80
    s_mul_i32 s79, s64, 20
    s_add_u32 s78, s78, s79
    s_lshl_b32 s78, s78, 12
    s_lshl_b32 s79, s65, 7
    s_sub_u32 s78, s78, s79
    s_add_u32 s39, s78, 12914560
    s_waitcnt vmcnt(9)
    ds_read_b64_tr_b16 v[60:61], v160 offset:0
    ds_read_b64_tr_b16 v[62:63], v160 offset:640
    ds_read_b64_tr_b16 v[64:65], v160 offset:3200
    ds_read_b64_tr_b16 v[66:67], v160 offset:32
    ds_read_b64_tr_b16 v[68:69], v160 offset:672
    ds_read_b64_tr_b16 v[70:71], v160 offset:3232
    ds_read_b64_tr_b16 v[72:73], v160 offset:64
    ds_read_b64_tr_b16 v[74:75], v160 offset:704
    ds_read_b64_tr_b16 v[76:77], v160 offset:3264
    ds_read_b64_tr_b16 v[78:79], v160 offset:96
    ds_read_b64_tr_b16 v[80:81], v160 offset:736
    ds_read_b64_tr_b16 v[82:83], v160 offset:3296
    ds_read_b64_tr_b16 v[84:85], v160 offset:128
    ds_read_b64_tr_b16 v[86:87], v160 offset:768
    ds_read_b64_tr_b16 v[88:89], v160 offset:3328
    s_waitcnt lgkmcnt(0)
    s_waitcnt vmcnt(5)
    s_lshl_b32 s78, s66, 2
    s_add_u32 s78, s78, s98
    s_mov_b64 exec, 1
    buffer_store_dword v34, v38, s[12:15], s78 offen sc1
    s_mov_b64 exec, -1
    s_mov_b64 exec, 15
    buffer_atomic_add v34, v193, s[12:15], 0 offen sc1
    s_mov_b64 exec, -1
    v_dot2_f32_bf16 v40, v62, v230, 0
    buffer_load_dwordx4 v1, s[12:15], s82 offen offset:2048 sc1 lds
    v_dot2_f32_bf16 v41, v62, v228, 0
    buffer_load_dwordx4 v1, s[12:15], s82 offen offset:3072 sc1 lds
    s_add_u32 s82, s82, 4096
    s_add_u32 m0, s83, 4096
    v_dot2_f32_bf16 v42, v63, v230, 0
    buffer_load_dwordx4 v1, s[12:15], s82 offen offset:0 sc1 lds
    v_dot2_f32_bf16 v43, v63, v228, 0
    v_lshlrev_b32 v48, 16, v64
    v_and_b32 v49, s73, v64
    v_dot2_f32_bf16 v40, v61, v231, v40
    v_dot2_f32_bf16 v41, v61, v229, v41
    v_dot2_f32_bf16 v42, v62, v231, v42
    v_dot2_f32_bf16 v43, v62, v229, v43
    v_dot2_f32_bf16 v40, v60, v232, v40
    v_dot2_f32_bf16 v42, v61, v232, v42
    v_lshlrev_b32 v50, 16, v65
    buffer_load_dwordx4 v1, s[12:15], s82 offen offset:1024 sc1 lds
    v_and_b32 v51, s73, v65
    s_nop 0
    v_pk_mul_f32 v[40:41], v[40:41], v[48:49]
    v_pk_mul_f32 v[42:43], v[42:43], v[50:51]
    v_cvt_pk_bf16_f32 v91, v41, v40
    v_cvt_pk_bf16_f32 v90, v43, v42
    ds_write_b64 v162, v[90:91] offset:0
    v_dot2_f32_bf16 v44, v68, v235, 0
    v_dot2_f32_bf16 v45, v68, v233, 0
    v_dot2_f32_bf16 v46, v69, v235, 0
    v_dot2_f32_bf16 v47, v69, v233, 0
    v_lshlrev_b32 v52, 16, v70
    v_and_b32 v53, s73, v70
    v_dot2_f32_bf16 v44, v67, v236, v44
    buffer_load_dwordx4 v1, s[12:15], s82 offen offset:2048 sc1 lds
    v_dot2_f32_bf16 v45, v67, v234, v45
    v_dot2_f32_bf16 v46, v68, v236, v46
    v_dot2_f32_bf16 v47, v68, v234, v47
    v_dot2_f32_bf16 v44, v66, v237, v44
    v_dot2_f32_bf16 v46, v67, v237, v46
    v_lshlrev_b32 v54, 16, v71
    v_and_b32 v55, s73, v71
    s_nop 0
    v_pk_mul_f32 v[44:45], v[44:45], v[52:53]
    v_pk_mul_f32 v[46:47], v[46:47], v[54:55]
    v_cvt_pk_bf16_f32 v93, v45, v44
    v_cvt_pk_bf16_f32 v92, v47, v46
    ds_write_b64 v162, v[92:93] offset:2304
    v_dot2_f32_bf16 v40, v74, v240, 0
    buffer_load_dwordx4 v1, s[12:15], s82 offen offset:3072 sc1 lds
    v_dot2_f32_bf16 v41, v74, v238, 0
    v_dot2_f32_bf16 v42, v75, v240, 0
    v_dot2_f32_bf16 v43, v75, v238, 0
    v_lshlrev_b32 v48, 16, v76
    v_and_b32 v49, s73, v76
    v_dot2_f32_bf16 v40, v73, v241, v40
    v_dot2_f32_bf16 v41, v73, v239, v41
    v_dot2_f32_bf16 v42, v74, v241, v42
    v_dot2_f32_bf16 v43, v74, v239, v43
    v_dot2_f32_bf16 v40, v72, v242, v40
    v_dot2_f32_bf16 v42, v73, v242, v42
    v_lshlrev_b32 v50, 16, v77
    v_and_b32 v51, s73, v77
    s_nop 0
    s_add_u32 s82, s82, 4096
    s_add_u32 m0, s83, 8192
    v_pk_mul_f32 v[40:41], v[40:41], v[48:49]
    buffer_load_dwordx4 v1, s[12:15], s82 offen offset:0 sc1 lds
    v_pk_mul_f32 v[42:43], v[42:43], v[50:51]
    v_cvt_pk_bf16_f32 v95, v41, v40
    v_cvt_pk_bf16_f32 v94, v43, v42
    ds_write_b64 v162, v[94:95] offset:4608
    v_dot2_f32_bf16 v44, v80, v245, 0
    v_dot2_f32_bf16 v45, v80, v243, 0
    v_dot2_f32_bf16 v46, v81, v245, 0
    v_dot2_f32_bf16 v47, v81, v243, 0
    v_lshlrev_b32 v52, 16, v82
    v_and_b32 v53, s73, v82
    v_dot2_f32_bf16 v44, v79, v246, v44
    buffer_load_dwordx4 v1, s[12:15], s82 offen offset:1024 sc1 lds
    v_dot2_f32_bf16 v45, v79, v244, v45
    v_dot2_f32_bf16 v46, v80, v246, v46
    v_dot2_f32_bf16 v47, v80, v244, v47
    v_dot2_f32_bf16 v44, v78, v247, v44
    v_dot2_f32_bf16 v46, v79, v247, v46
    v_lshlrev_b32 v54, 16, v83
    v_and_b32 v55, s73, v83
    s_nop 0
    v_pk_mul_f32 v[44:45], v[44:45], v[52:53]
    v_pk_mul_f32 v[46:47], v[46:47], v[54:55]
    v_cvt_pk_bf16_f32 v97, v45, v44
    v_cvt_pk_bf16_f32 v96, v47, v46
    ds_write_b64 v162, v[96:97] offset:6912
    v_dot2_f32_bf16 v40, v86, v250, 0
    buffer_load_dwordx4 v1, s[12:15], s82 offen offset:2048 sc1 lds
    v_dot2_f32_bf16 v41, v86, v248, 0
    v_dot2_f32_bf16 v42, v87, v250, 0
    v_dot2_f32_bf16 v43, v87, v248, 0
    v_lshlrev_b32 v48, 16, v88
    v_and_b32 v49, s73, v88
    v_dot2_f32_bf16 v40, v85, v251, v40
    v_dot2_f32_bf16 v41, v85, v249, v41
    v_dot2_f32_bf16 v42, v86, v251, v42
    v_dot2_f32_bf16 v43, v86, v249, v43
    v_dot2_f32_bf16 v40, v84, v252, v40
    v_dot2_f32_bf16 v42, v85, v252, v42
    v_lshlrev_b32 v50, 16, v89
    v_and_b32 v51, s73, v89
    s_nop 0
    v_pk_mul_f32 v[40:41], v[40:41], v[48:49]
    buffer_load_dwordx4 v1, s[12:15], s82 offen offset:3072 sc1 lds
    v_pk_mul_f32 v[42:43], v[42:43], v[50:51]
    v_cvt_pk_bf16_f32 v99, v41, v40
    v_cvt_pk_bf16_f32 v98, v43, v42
    ds_write_b64 v162, v[98:99] offset:9216
    s_add_u32 s82, s82, 4096
    s_add_u32 m0, s83, 12288
    s_nop 0
    buffer_load_dwordx4 v1, s[12:15], s82 offen offset:0 sc1 lds
    buffer_load_dwordx4 v1, s[12:15], s82 offen offset:1024 sc1 lds
    buffer_load_dwordx4 v1, s[12:15], s82 offen offset:2048 sc1 lds
    buffer_load_dwordx4 v1, s[12:15], s82 offen offset:3072 sc1 lds
    s_add_u32 s82, s82, 4096
    s_add_u32 m0, s83, 16384
    s_nop 0
    buffer_load_dwordx4 v1, s[12:15], s82 offen offset:0 sc1 lds
    buffer_load_dwordx4 v1, s[12:15], s82 offen offset:1024 sc1 lds
    buffer_load_dwordx4 v1, s[12:15], s82 offen offset:2048 sc1 lds
    buffer_load_dwordx4 v1, s[12:15], s82 offen offset:3072 sc1 lds
    s_add_u32 s82, s82, 4096
    s_add_u32 m0, s83, 20480
    s_nop 0
    buffer_load_dwordx4 v1, s[12:15], s82 offen offset:0 sc1 lds
    buffer_load_dword v36, v35, s[12:15], s98 offen sc1
    buffer_load_dwordx4 v1, s[12:15], s82 offen offset:1024 sc1 lds
    buffer_load_dwordx4 v1, s[12:15], s82 offen offset:2048 sc1 lds
    buffer_load_dwordx4 v1, s[12:15], s82 offen offset:3072 sc1 lds
    s_add_u32 s82, s82, 4096
    s_add_u32 m0, s83, 24576
    s_nop 0
    buffer_load_dwordx4 v1, s[12:15], s82 offen offset:0 sc1 lds
    s_waitcnt vmcnt(4)
    v_cmp_ne_u32 vcc, 1, v36
    s_cbranch_vccz L_ok_31
    s_mov_b32 s79, 0
L_spin_30:
    s_sleep 1
    buffer_load_dword v36, v35, s[12:15], s98 offen sc1
    s_add_u32 s79, s79, 1
    s_cmp_gt_u32 s79, 200000
    s_cbranch_scc1 L_ok_31
    s_waitcnt vmcnt(0)
    v_cmp_ne_u32 vcc, 1, v36
    s_cbranch_vccnz L_spin_30
L_ok_31:
    s_add_u32 s92, s48, 65536
    s_add_u32 s93, s48, 70656
    s_add_u32 s94, s48, 75776
    s_add_u32 s95, s48, 80896
    buffer_load_dwordx4 v[40:43], v1, s[12:15], s92 offen offset:0 sc1
    buffer_load_dwordx4 v[44:47], v1, s[12:15], s92 offen offset:1024 sc1
    buffer_load_dwordx4 v[48:51], v1, s[12:15], s92 offen offset:2560 sc1
    buffer_load_dwordx4 v[52:55], v1, s[12:15], s92 offen offset:3584 sc1
    buffer_load_dwordx2 v[56:57], v3, s[12:15], s92 offen sc1
    buffer_load_dwordx2 v[58:59], v3, s[12:15], s92 offen offset:2560 sc1
    buffer_load_dwordx4 v[60:63], v1, s[12:15], s93 offen offset:0 sc1
    buffer_load_dwordx4 v[64:67], v1, s[12:15], s93 offen offset:1024 sc1
    buffer_load_dwordx4 v[68:71], v1, s[12:15], s93 offen offset:2560 sc1
    buffer_load_dwordx4 v[72:75], v1, s[12:15], s93 offen offset:3584 sc1
    buffer_load_dwordx2 v[76:77], v3, s[12:15], s93 offen sc1
    buffer_load_dwordx2 v[78:79], v3, s[12:15], s93 offen offset:2560 sc1
    s_lshl_b32 s76, s64, 4
    v_add_u32 v164, s76, v2
    v_cmp_eq_u32 vcc, 63, v164
    v_lshlrev_b32 v164, 3, v164
    v_add_u32 v164, 8, v164
    v_mov_b32 v165, 1520
    s_lshl_b32 s60, s65, 12
    s_add_u32 s60, s60, 2686976
    v_cndmask_b32 v164, v164, v165, vcc
    s_bfe_u32 s76, s65, 0x20002
    s_lshl_b32 s76, s76, 2
    s_and_b32 s77, s66, 3
    s_add_u32 s96, s76, s77
    s_lshr_b32 s97, s65, 4
    s_lshl_b32 s97, s97, 2
    s_and_b32 s76, s65, 3
    s_add_u32 s97, s97, s76
    s_lshl_b32 s97, s97, 1
    s_lshr_b32 s76, s66, 2
    s_add_u32 s97, s97, s76
    s_mul_i32 s59, s64, 7168
    s_mul_i32 s58, s96, 143360
    s_add_u32 s58, s58, s59
    s_lshr_b32 s76, 18742, s96
    s_and_b32 s76, s76, 1
    s_mul_i32 s76, s76, 20
    s_add_u32 s62, s76, 40
    s_lshl_b32 s63, s96, 7
    s_add_u32 s63, s63, 62464
    ds_read_b64 v[12:13], v161 offset:5760
    ds_read_b64 v[14:15], v161 offset:5792
    ds_read_b64 v[16:17], v161 offset:5824
    ds_read_b64 v[18:19], v161 offset:5856
    ds_read_b64 v[20:21], v161 offset:5888
    s_waitcnt vmcnt(12)
    s_waitcnt lgkmcnt(0)
    s_barrier
    ds_read_b128 v[144:147], v156 offset:0
    ds_read_b128 v[148:151], v156 offset:1152
    ds_read_b128 v[152:155], v156 offset:2304
    buffer_load_dwordx4 v[80:83], v1, s[12:15], s94 offen offset:0 sc1
    ds_read_b128 a[0:3], v9 offset:0
    ds_read_b128 a[4:7], v9 offset:1024
    ds_read_b128 a[8:11], v9 offset:2048
    ds_read_b128 a[12:15], v9 offset:3072
    ds_read_b128 a[16:19], v9 offset:4096
    buffer_load_dwordx4 v[84:87], v1, s[12:15], s94 offen offset:1024 sc1
    ds_read_b128 a[20:23], v9 offset:5120
    ds_read_b128 a[24:27], v9 offset:6144
    ds_read_b128 a[28:31], v9 offset:7168
    ds_read_b128 a[32:35], v9 offset:8192
    ds_read_b128 a[36:39], v9 offset:9216
    s_waitcnt vmcnt(13) lgkmcnt(5)
    v_mfma_f32_16x16x32_bf16 v[120:123], a[0:3], v[40:43], 0
    ds_read_b128 a[40:43], v9 offset:10240
    v_mfma_f32_16x16x32_bf16 v[124:127], a[4:7], v[40:43], 0
    buffer_load_dwordx4 v[88:91], v1, s[12:15], s94 offen offset:2560 sc1
    ds_read_b128 a[44:47], v9 offset:11264
    v_mfma_f32_16x16x32_bf16 v[128:131], a[8:11], v[40:43], 0
    ds_read_b128 a[48:51], v9 offset:12288
    v_mfma_f32_16x16x32_bf16 v[132:135], a[12:15], v[40:43], 0
    buffer_load_dwordx4 v[92:95], v1, s[12:15], s94 offen offset:3584 sc1
    ds_read_b128 a[52:55], v9 offset:13312
    v_mfma_f32_16x16x32_bf16 v[136:139], a[16:19], v[40:43], 0
    ds_read_b128 a[56:59], v9 offset:14336
    s_waitcnt vmcnt(14) lgkmcnt(5)
    v_mfma_f32_16x16x32_bf16 v[120:123], a[20:23], v[44:47], v[120:123]
    ds_read_b128 a[60:63], v9 offset:15360
    v_mfma_f32_16x16x32_bf16 v[124:127], a[24:27], v[44:47], v[124:127]
    buffer_load_dwordx2 v[96:97], v3, s[12:15], s94 offen sc1
    buffer_load_dwordx2 v[98:99], v3, s[12:15], s94 offen offset:2560 sc1
    ds_read_b128 a[64:67], v9 offset:16384
    v_mfma_f32_16x16x32_bf16 v[128:131], a[28:31], v[44:47], v[128:131]
    ds_read_b128 a[68:71], v9 offset:17408
    v_mfma_f32_16x16x32_bf16 v[132:135], a[32:35], v[44:47], v[132:135]
    buffer_load_dwordx4 v[100:103], v1, s[12:15], s95 offen offset:0 sc1
    ds_read_b128 a[72:75], v9 offset:18432
    v_mfma_f32_16x16x32_bf16 v[136:139], a[36:39], v[44:47], v[136:139]
    ds_read_b128 a[76:79], v9 offset:19456
    s_waitcnt vmcnt(16) lgkmcnt(5)
    v_mfma_f32_16x16x32_bf16 v[120:123], a[40:43], v[48:51], v[120:123]
    ds_read_b128 a[0:3], v9 offset:20480
    v_mfma_f32_16x16x32_bf16 v[124:127], a[44:47], v[48:51], v[124:127]
    buffer_load_dwordx4 v[104:107], v1, s[12:15], s95 offen offset:1024 sc1
    ds_read_b128 a[4:7], v9 offset:21504
    v_mfma_f32_16x16x32_bf16 v[128:131], a[48:51], v[48:51], v[128:131]
    ds_read_b128 a[8:11], v9 offset:22528
    v_mfma_f32_16x16x32_bf16 v[132:135], a[52:55], v[48:51], v[132:135]
    buffer_load_dwordx4 v[108:111], v1, s[12:15], s95 offen offset:2560 sc1
    ds_read_b128 a[12:15], v9 offset:23552
    v_mfma_f32_16x16x32_bf16 v[136:139], a[56:59], v[48:51], v[136:139]
    ds_read_b128 a[16:19], v9 offset:24576
    s_waitcnt vmcnt(17) lgkmcnt(5)
    v_mfma_f32_16x16x32_bf16 v[120:123], a[60:63], v[52:55], v[120:123]
    ds_read_b128 a[20:23], v9 offset:25600
    v_mfma_f32_16x16x32_bf16 v[124:127], a[64:67], v[52:55], v[124:127]
    buffer_load_dwordx4 v[112:115], v1, s[12:15], s95 offen offset:3584 sc1
    ds_read_b128 a[24:27], v9 offset:26624
    v_mfma_f32_16x16x32_bf16 v[128:131], a[68:71], v[52:55], v[128:131]
    ds_read_b128 a[28:31], v9 offset:27648
    v_mfma_f32_16x16x32_bf16 v[132:135], a[72:75], v[52:55], v[132:135]
    buffer_load_dwordx2 v[116:117], v3, s[12:15], s95 offen sc1
    buffer_load_dwordx2 v[118:119], v3, s[12:15], s95 offen offset:2560 sc1
    ds_read_b128 a[32:35], v9 offset:28672
    v_mfma_f32_16x16x32_bf16 v[136:139], a[76:79], v[52:55], v[136:139]
    ds_read_b128 a[36:39], v9 offset:29696
    s_waitcnt vmcnt(18) lgkmcnt(5)
    v_mfma_f32_16x16x32_bf16 v[120:123], a[0:3], v[56:59], v[120:123]
    ds_read_b128 a[40:43], v9 offset:30720
    v_mfma_f32_16x16x32_bf16 v[124:127], a[4:7], v[56:59], v[124:127]
    buffer_load_dwordx2 v[32:33], v164, s[12:15], s60 offen sc1
    ds_read_b128 a[44:47], v9 offset:31744
    v_mfma_f32_16x16x32_bf16 v[128:131], a[8:11], v[56:59], v[128:131]
    ds_read_b128 a[48:51], v9 offset:32768
    v_mfma_f32_16x16x32_bf16 v[132:135], a[12:15], v[56:59], v[132:135]
    buffer_load_dword v36, v38, s[12:15], s63 offen sc1
    ds_read_b128 a[52:55], v9 offset:33792
    v_mfma_f32_16x16x32_bf16 v[136:139], a[16:19], v[56:59], v[136:139]
    ds_read_b128 a[56:59], v9 offset:34816
    s_waitcnt vmcnt(19) lgkmcnt(5)
    v_mfma_f32_16x16x32_bf16 v[120:123], a[20:23], v[60:63], v[120:123]
    ds_read_b128 a[60:63], v9 offset:35840
    v_mfma_f32_16x16x32_bf16 v[124:127], a[24:27], v[60:63], v[124:127]
    buffer_store_dwordx4 v[144:147], v157, s[12:15], s39 offen sc1
    ds_read_b128 a[64:67], v9 offset:36864
    v_mfma_f32_16x16x32_bf16 v[128:131], a[28:31], v[60:63], v[128:131]
    ds_read_b128 a[68:71], v9 offset:37888
    s_add_u32 s39, s39, 32768
    v_mfma_f32_16x16x32_bf16 v[132:135], a[32:35], v[60:63], v[132:135]
    buffer_store_dwordx4 v[148:151], v157, s[12:15], s39 offen sc1
    ds_read_b128 a[72:75], v9 offset:38912
    v_mfma_f32_16x16x32_bf16 v[136:139], a[36:39], v[60:63], v[136:139]
    ds_read_b128 a[76:79], v9 offset:39936
    s_waitcnt vmcnt(20) lgkmcnt(5)
    v_mfma_f32_16x16x32_bf16 v[120:123], a[40:43], v[64:67], v[120:123]
    ds_read_b128 a[0:3], v9 offset:40960
    s_add_u32 s39, s39, 32768
    v_mfma_f32_16x16x32_bf16 v[124:127], a[44:47], v[64:67], v[124:127]
    s_mov_b32 exec_hi, 0
    buffer_store_dwordx4 v[152:155], v157, s[12:15], s39 offen sc1
    s_mov_b64 exec, -1
    ds_read_b128 a[4:7], v9 offset:41984
    v_mfma_f32_16x16x32_bf16 v[128:131], a[48:51], v[64:67], v[128:131]
    ds_read_b128 a[8:11], v9 offset:43008
    v_mfma_f32_16x16x32_bf16 v[132:135], a[52:55], v[64:67], v[132:135]
    ds_read_b128 a[12:15], v9 offset:44032
    v_mfma_f32_16x16x32_bf16 v[136:139], a[56:59], v[64:67], v[136:139]
    ds_read_b128 a[16:19], v9 offset:45056
    s_waitcnt vmcnt(20) lgkmcnt(5)
    v_mfma_f32_16x16x32_bf16 v[120:123], a[60:63], v[68:71], v[120:123]
    ds_read_b128 a[20:23], v9 offset:46080
    v_mfma_f32_16x16x32_bf16 v[124:127], a[64:67], v[68:71], v[124:127]
    ds_read_b128 a[24:27], v9 offset:47104
    v_mfma_f32_16x16x32_bf16 v[128:131], a[68:71], v[68:71], v[128:131]
    ds_read_b128 a[28:31], v9 offset:48128
    v_mfma_f32_16x16x32_bf16 v[132:135], a[72:75], v[68:71], v[132:135]
    ds_read_b128 a[32:35], v9 offset:49152
    v_mfma_f32_16x16x32_bf16 v[136:139], a[76:79], v[68:71], v[136:139]
    ds_read_b128 a[36:39], v9 offset:50176
    s_waitcnt vmcnt(19) lgkmcnt(5)
    v_mfma_f32_16x16x32_bf16 v[120:123], a[0:3], v[72:75], v[120:123]
    ds_read_b128 a[40:43], v9 offset:51200
    v_mfma_f32_16x16x32_bf16 v[124:127], a[4:7], v[72:75], v[124:127]
    ds_read_b128 a[44:47], v9 offset:52224
    v_mfma_f32_16x16x32_bf16 v[128:131], a[8:11], v[72:75], v[128:131]
    ds_read_b128 a[48:51], v9 offset:53248
    v_mfma_f32_16x16x32_bf16 v[132:135], a[12:15], v[72:75], v[132:135]
    ds_read_b128 a[52:55], v9 offset:54272
    v_mfma_f32_16x16x32_bf16 v[136:139], a[16:19], v[72:75], v[136:139]
    ds_read_b128 a[56:59], v9 offset:55296
    s_waitcnt vmcnt(17) lgkmcnt(5)
    v_mfma_f32_16x16x32_bf16 v[120:123], a[20:23], v[76:79], v[120:123]
    ds_read_b128 a[60:63], v9 offset:56320
    v_mfma_f32_16x16x32_bf16 v[124:127], a[24:27], v[76:79], v[124:127]
    ds_read_b128 a[64:67], v9 offset:57344
    v_mfma_f32_16x16x32_bf16 v[128:131], a[28:31], v[76:79], v[128:131]
    ds_read_b128 a[68:71], v9 offset:58368
    v_mfma_f32_16x16x32_bf16 v[132:135], a[32:35], v[76:79], v[132:135]
    ds_read_b128 a[72:75], v9 offset:59392
    v_mfma_f32_16x16x32_bf16 v[136:139], a[36:39], v[76:79], v[136:139]
    ds_read_b128 a[76:79], v9 offset:60416
    s_waitcnt vmcnt(16) lgkmcnt(5)
    v_mfma_f32_16x16x32_bf16 v[120:123], a[40:43], v[80:83], v[120:123]
    ds_read_b128 a[0:3], v9 offset:61440
    v_mfma_f32_16x16x32_bf16 v[124:127], a[44:47], v[80:83], v[124:127]
    ds_read_b128 a[4:7], v9 offset:62464
    v_mfma_f32_16x16x32_bf16 v[128:131], a[48:51], v[80:83], v[128:131]
    ds_read_b128 a[8:11], v9 offset:63488
    v_mfma_f32_16x16x32_bf16 v[132:135], a[52:55], v[80:83], v[132:135]
    ds_read_b128 a[12:15], v9 offset:64512
    v_mfma_f32_16x16x32_bf16 v[136:139], a[56:59], v[80:83], v[136:139]
    ds_read_b128 a[16:19], v10 offset:0
    s_waitcnt vmcnt(15) lgkmcnt(5)
    v_mfma_f32_16x16x32_bf16 v[120:123], a[60:63], v[84:87], v[120:123]
    ds_read_b128 a[20:23], v10 offset:1024
    v_mfma_f32_16x16x32_bf16 v[124:127], a[64:67], v[84:87], v[124:127]
    ds_read_b128 a[24:27], v10 offset:2048
    v_mfma_f32_16x16x32_bf16 v[128:131], a[68:71], v[84:87], v[128:131]
    ds_read_b128 a[28:31], v10 offset:3072
    v_mfma_f32_16x16x32_bf16 v[132:135], a[72:75], v[84:87], v[132:135]
    ds_read_b128 a[32:35], v10 offset:4096
    v_mfma_f32_16x16x32_bf16 v[136:139], a[76:79], v[84:87], v[136:139]
    ds_read_b128 a[36:39], v10 offset:5120
    s_waitcnt vmcnt(14) lgkmcnt(5)
    v_mfma_f32_16x16x32_bf16 v[120:123], a[0:3], v[88:91], v[120:123]
    ds_read_b128 a[40:43], v10 offset:6144
    v_mfma_f32_16x16x32_bf16 v[124:127], a[4:7], v[88:91], v[124:127]
    ds_read_b128 a[44:47], v10 offset:7168
    v_mfma_f32_16x16x32_bf16 v[128:131], a[8:11], v[88:91], v[128:131]
    ds_read_b128 a[48:51], v10 offset:8192
    v_mfma_f32_16x16x32_bf16 v[132:135], a[12:15], v[88:91], v[132:135]
    ds_read_b128 a[52:55], v10 offset:9216
    v_mfma_f32_16x16x32_bf16 v[136:139], a[16:19], v[88:91], v[136:139]
    ds_read_b128 a[56:59], v10 offset:10240
    s_waitcnt vmcnt(13) lgkmcnt(5)
    v_mfma_f32_16x16x32_bf16 v[120:123], a[20:23], v[92:95], v[120:123]
    ds_read_b128 a[60:63], v10 offset:11264
    v_mfma_f32_16x16x32_bf16 v[124:127], a[24:27], v[92:95], v[124:127]
    ds_read_b128 a[64:67], v10 offset:12288
    v_mfma_f32_16x16x32_bf16 v[128:131], a[28:31], v[92:95], v[128:131]
    ds_read_b128 a[68:71], v10 offset:13312
    v_mfma_f32_16x16x32_bf16 v[132:135], a[32:35], v[92:95], v[132:135]
    ds_read_b128 a[72:75], v10 offset:14336
    v_mfma_f32_16x16x32_bf16 v[136:139], a[36:39], v[92:95], v[136:139]
    ds_read_b128 a[76:79], v10 offset:15360
    s_waitcnt vmcnt(11) lgkmcnt(5)
    v_mfma_f32_16x16x32_bf16 v[120:123], a[40:43], v[96:99], v[120:123]
    ds_read_b128 a[0:3], v10 offset:16384
    v_mfma_f32_16x16x32_bf16 v[124:127], a[44:47], v[96:99], v[124:127]
    ds_read_b128 a[4:7], v10 offset:17408
    v_mfma_f32_16x16x32_bf16 v[128:131], a[48:51], v[96:99], v[128:131]
    ds_read_b128 a[8:11], v10 offset:18432
    v_mfma_f32_16x16x32_bf16 v[132:135], a[52:55], v[96:99], v[132:135]
    ds_read_b128 a[12:15], v10 offset:19456
    v_mfma_f32_16x16x32_bf16 v[136:139], a[56:59], v[96:99], v[136:139]
    ds_read_b128 a[16:19], v10 offset:20480
    s_waitcnt vmcnt(10) lgkmcnt(5)
    v_mfma_f32_16x16x32_bf16 v[120:123], a[60:63], v[100:103], v[120:123]
    ds_read_b128 a[20:23], v10 offset:21504
    v_mfma_f32_16x16x32_bf16 v[124:127], a[64:67], v[100:103], v[124:127]
    ds_read_b128 a[24:27], v10 offset:22528
    v_mfma_f32_16x16x32_bf16 v[128:131], a[68:71], v[100:103], v[128:131]
    ds_read_b128 a[28:31], v10 offset:23552
    v_mfma_f32_16x16x32_bf16 v[132:135], a[72:75], v[100:103], v[132:135]
    ds_read_b128 a[32:35], v10 offset:24576
    v_mfma_f32_16x16x32_bf16 v[136:139], a[76:79], v[100:103], v[136:139]
    ds_read_b128 a[36:39], v10 offset:25600
    s_waitcnt vmcnt(9) lgkmcnt(5)
    v_mfma_f32_16x16x32_bf16 v[120:123], a[0:3], v[104:107], v[120:123]
    ds_read_b128 a[40:43], v10 offset:26624
    v_mfma_f32_16x16x32_bf16 v[124:127], a[4:7], v[104:107], v[124:127]
    ds_read_b128 a[44:47], v10 offset:27648
    v_mfma_f32_16x16x32_bf16 v[128:131], a[8:11], v[104:107], v[128:131]
    ds_read_b128 a[48:51], v10 offset:28672
    v_mfma_f32_16x16x32_bf16 v[132:135], a[12:15], v[104:107], v[132:135]
    ds_read_b128 a[52:55], v10 offset:29696
    v_mfma_f32_16x16x32_bf16 v[136:139], a[16:19], v[104:107], v[136:139]
    ds_read_b128 a[56:59], v10 offset:30720
    s_waitcnt vmcnt(8) lgkmcnt(5)
    v_mfma_f32_16x16x32_bf16 v[120:123], a[20:23], v[108:111], v[120:123]
    ds_read_b128 a[60:63], v10 offset:31744
    v_mfma_f32_16x16x32_bf16 v[124:127], a[24:27], v[108:111], v[124:127]
    ds_read_b128 a[64:67], v10 offset:32768
    v_mfma_f32_16x16x32_bf16 v[128:131], a[28:31], v[108:111], v[128:131]
    ds_read_b128 a[68:71], v10 offset:33792
    v_mfma_f32_16x16x32_bf16 v[132:135], a[32:35], v[108:111], v[132:135]
    ds_read_b128 a[72:75], v10 offset:34816
    v_mfma_f32_16x16x32_bf16 v[136:139], a[36:39], v[108:111], v[136:139]
    ds_read_b128 a[76:79], v10 offset:35840
    s_waitcnt vmcnt(7) lgkmcnt(5)
    v_mfma_f32_16x16x32_bf16 v[120:123], a[40:43], v[112:115], v[120:123]
    v_mfma_f32_16x16x32_bf16 v[124:127], a[44:47], v[112:115], v[124:127]
    v_mfma_f32_16x16x32_bf16 v[128:131], a[48:51], v[112:115], v[128:131]
    v_mfma_f32_16x16x32_bf16 v[132:135], a[52:55], v[112:115], v[132:135]
    v_mfma_f32_16x16x32_bf16 v[136:139], a[56:59], v[112:115], v[136:139]
    s_waitcnt vmcnt(5) lgkmcnt(0)
    v_mfma_f32_16x16x32_bf16 v[120:123], a[60:63], v[116:119], v[120:123]
    v_mfma_f32_16x16x32_bf16 v[124:127], a[64:67], v[116:119], v[124:127]
    v_mfma_f32_16x16x32_bf16 v[128:131], a[68:71], v[116:119], v[128:131]
    v_mfma_f32_16x16x32_bf16 v[132:135], a[72:75], v[116:119], v[132:135]
    v_mfma_f32_16x16x32_bf16 v[136:139], a[76:79], v[116:119], v[136:139]
    s_waitcnt vmcnt(3)
    v_cmp_gt_u32 vcc, s62, v36
    s_cbranch_vccz L_ok_33
    s_mov_b32 s79, 0
L_spin_32:
    s_sleep 1
    buffer_load_dword v36, v38, s[12:15], s63 offen sc1
    s_add_u32 s79, s79, 1
    s_cmp_gt_u32 s79, 200000
    s_cbranch_scc1 L_ok_33
    s_waitcnt vmcnt(0)
    v_cmp_gt_u32 vcc, s62, v36
    s_cbranch_vccnz L_spin_32
L_ok_33:
    s_waitcnt lgkmcnt(0)
    s_barrier
    v_mul_f32 v32, v32, v33
    v_sub_f32 v32, 0, v32
    v_lshlrev_b32 v40, 16, v12
    v_and_b32 v41, s73, v12
    v_lshlrev_b32 v42, 16, v13
    v_and_b32 v43, s73, v13
    v_lshlrev_b32 v44, 16, v14
    v_and_b32 v45, s73, v14
    v_lshlrev_b32 v46, 16, v15
    v_and_b32 v47, s73, v15
    v_lshlrev_b32 v48, 16, v16
    v_and_b32 v49, s73, v16
    v_lshlrev_b32 v50, 16, v17
    v_and_b32 v51, s73, v17
    v_lshlrev_b32 v52, 16, v18
    v_and_b32 v53, s73, v18
    v_lshlrev_b32 v54, 16, v19
    v_and_b32 v55, s73, v19
    v_lshlrev_b32 v56, 16, v20
    v_and_b32 v57, s73, v20
    v_lshlrev_b32 v58, 16, v21
    v_and_b32 v59, s73, v21
    v_pk_fma_f32 v[120:121], v[40:41], v[32:33], v[120:121] op_sel:[0,1,0] op_sel_hi:[1,1,1]
    v_pk_fma_f32 v[122:123], v[42:43], v[32:33], v[122:123] op_sel:[0,1,0] op_sel_hi:[1,1,1]
    v_pk_fma_f32 v[124:125], v[44:45], v[32:33], v[124:125] op_sel:[0,1,0] op_sel_hi:[1,1,1]
    v_pk_fma_f32 v[126:127], v[46:47], v[32:33], v[126:127] op_sel:[0,1,0] op_sel_hi:[1,1,1]
    v_pk_fma_f32 v[128:129], v[48:49], v[32:33], v[128:129] op_sel:[0,1,0] op_sel_hi:[1,1,1]
    v_pk_fma_f32 v[130:131], v[50:51], v[32:33], v[130:131] op_sel:[0,1,0] op_sel_hi:[1,1,1]
    v_pk_fma_f32 v[132:133], v[52:53], v[32:33], v[132:133] op_sel:[0,1,0] op_sel_hi:[1,1,1]
    v_pk_fma_f32 v[134:135], v[54:55], v[32:33], v[134:135] op_sel:[0,1,0] op_sel_hi:[1,1,1]
    v_pk_fma_f32 v[136:137], v[56:57], v[32:33], v[136:137] op_sel:[0,1,0] op_sel_hi:[1,1,1]
    v_pk_fma_f32 v[138:139], v[58:59], v[32:33], v[138:139] op_sel:[0,1,0] op_sel_hi:[1,1,1]
    v_pk_add_f32 v[120:121], v[120:121], v[32:33] op_sel_hi:[1,0]
    v_pk_add_f32 v[122:123], v[122:123], v[32:33] op_sel_hi:[1,0]
    v_pk_add_f32 v[124:125], v[124:125], v[32:33] op_sel_hi:[1,0]
    v_pk_add_f32 v[126:127], v[126:127], v[32:33] op_sel_hi:[1,0]
    v_pk_add_f32 v[128:129], v[128:129], v[32:33] op_sel_hi:[1,0]
    v_pk_add_f32 v[130:131], v[130:131], v[32:33] op_sel_hi:[1,0]
    v_pk_add_f32 v[132:133], v[132:133], v[32:33] op_sel_hi:[1,0]
    v_pk_add_f32 v[134:135], v[134:135], v[32:33] op_sel_hi:[1,0]
    v_pk_add_f32 v[136:137], v[136:137], v[32:33] op_sel_hi:[1,0]
    v_pk_add_f32 v[138:139], v[138:139], v[32:33] op_sel_hi:[1,0]
    s_add_u32 s78, s49, 2818048
    v_cvt_pk_bf16_f32 v100, v120, v121
    v_cvt_pk_bf16_f32 v101, v122, v123
    v_cvt_pk_bf16_f32 v102, v124, v125
    v_cvt_pk_bf16_f32 v103, v126, v127
    v_cvt_pk_bf16_f32 v104, v128, v129
    v_cvt_pk_bf16_f32 v105, v130, v131
    v_cvt_pk_bf16_f32 v106, v132, v133
    v_cvt_pk_bf16_f32 v107, v134, v135
    v_cvt_pk_bf16_f32 v108, v136, v137
    v_cvt_pk_bf16_f32 v109, v138, v139
    buffer_store_dwordx4 v[100:103], v1, s[12:15], s78 offen sc1
    buffer_store_dwordx4 v[104:107], v1, s[12:15], s78 offen offset:1024 sc1
    buffer_store_dwordx2 v[108:109], v3, s[12:15], s78 offen sc1
    v_mov_b32 v80, 0
    v_mov_b32 v81, 0
    v_mov_b32 v82, 0
    v_mov_b32 v83, 0
    v_dot2c_f32_bf16 v80, s74, v100
    v_dot2c_f32_bf16 v82, v100, v100
    v_dot2c_f32_bf16 v81, s74, v101
    v_dot2c_f32_bf16 v83, v101, v101
    v_dot2c_f32_bf16 v80, s74, v102
    v_dot2c_f32_bf16 v82, v102, v102
    v_dot2c_f32_bf16 v81, s74, v103
    v_dot2c_f32_bf16 v83, v103, v103
    v_dot2c_f32_bf16 v80, s74, v104
    v_dot2c_f32_bf16 v82, v104, v104
    v_dot2c_f32_bf16 v81, s74, v105
    v_dot2c_f32_bf16 v83, v105, v105
    v_dot2c_f32_bf16 v80, s74, v106
    v_dot2c_f32_bf16 v82, v106, v106
    v_dot2c_f32_bf16 v81, s74, v107
    v_dot2c_f32_bf16 v83, v107, v107
    v_dot2c_f32_bf16 v80, s74, v108
    v_dot2c_f32_bf16 v82, v108, v108
    v_dot2c_f32_bf16 v81, s74, v109
    v_dot2c_f32_bf16 v83, v109, v109
    s_add_u32 s78, s2, 5437440
    s_nop 0
    v_add_f32 v80, v80, v81
    v_add_f32 v81, v82, v83
    s_nop 1
    v_permlane16_swap_b32 v80, v81
    v_add_f32 v80, v80, v81
    v_mov_b32 v82, v80
    s_nop 1
    v_permlane32_swap_b32 v80, v82
    v_add_f32 v80, v80, v82
    v_mov_b32 v81, v80
    s_nop 1
    v_permlane16_swap_b32 v80, v81
    s_mov_b64 exec, 0xffff
    buffer_store_dwordx2 v[80:81], v3, s[12:15], s78 offen sc1
    s_mov_b64 exec, -1
    s_add_u32 s83, s58, 21495808
    s_add_u32 m0, s59, 0
    v_mov_b32 v22, v100
    buffer_load_dwordx4 v1, s[12:15], s83 offen offset:0 sc1 lds
    v_mov_b32 v23, v101
    v_mov_b32 v24, v102
    v_mov_b32 v25, v103
    v_mov_b32 v26, v104
    v_mov_b32 v27, v105
    buffer_load_dwordx4 v1, s[12:15], s83 offen offset:1024 sc1 lds
    v_mov_b32 v28, v106
    v_mov_b32 v29, v107
    v_mov_b32 v30, v108
    v_mov_b32 v31, v109
    v_add_u32 v173, s59, v9
    v_add_u32 v174, 0x10000, v173
    buffer_load_dwordx4 v1, s[12:15], s83 offen offset:2048 sc1 lds
    v_mov_b32 v176, s74
    v_mov_b32 v177, s74
    v_mov_b32 v178, s74
    v_mov_b32 v179, s74
    v_and_b32 v35, 7, v0
    v_lshlrev_b32 v35, 2, v35
    v_bfe_u32 v183, v0, 3, 1
    buffer_load_dwordx4 v1, s[12:15], s83 offen offset:3072 sc1 lds
    v_lshl_add_u32 v35, v183, 7, v35
    s_lshl_b32 s76, s97, 3
    s_lshl_b32 s77, s64, 1
    s_add_u32 s3, s76, s77
    s_lshl_b32 s100, s3, 7
    s_add_u32 s100, s100, 16384
    s_add_u32 s83, s83, 4096
    s_add_u32 m0, s59, 4096
    s_nop 0
    buffer_load_dwordx4 v1, s[12:15], s83 offen offset:0 sc1 lds
    buffer_load_dwordx4 v1, s[12:15], s83 offen offset:1024 sc1 lds
    buffer_load_dwordx4 v1, s[12:15], s83 offen offset:2048 sc1 lds
    s_add_u32 s83, s58, 21524480
    s_add_u32 m0, s59, 28672
    s_nop 0
    buffer_load_dwordx4 v1, s[12:15], s83 offen offset:0 sc1 lds
    s_waitcnt vmcnt(8)
    s_lshl_b32 s78, s66, 2
    s_add_u32 s78, s78, s98
    s_add_u32 s78, s78, 16384
    s_mov_b64 exec, 1
    buffer_store_dword v34, v38, s[12:15], s78 offen sc1
    s_mov_b64 exec, -1
    s_lshl_b32 s78, s66, 2
    s_add_u32 s78, s78, s64
    s_lshl_b32 s78, s78, 7
    s_lshl_b32 s79, s65, 2
    s_add_u32 s78, s78, s79
    s_add_u32 s78, s78, 49152
    s_mov_b64 exec, 1
    buffer_store_dword v34, v38, s[12:15], s78 offen sc1
    s_mov_b64 exec, -1
    buffer_load_dwordx4 v1, s[12:15], s83 offen offset:1024 sc1 lds
    buffer_load_dwordx4 v1, s[12:15], s83 offen offset:2048 sc1 lds
    buffer_load_dwordx4 v1, s[12:15], s83 offen offset:3072 sc1 lds
    s_add_u32 s83, s83, 4096
    s_add_u32 m0, s59, 32768
    s_nop 0
    buffer_load_dwordx4 v1, s[12:15], s83 offen offset:0 sc1 lds
    buffer_load_dwordx4 v1, s[12:15], s83 offen offset:1024 sc1 lds
    buffer_load_dwordx4 v1, s[12:15], s83 offen offset:2048 sc1 lds
    s_waitcnt vmcnt(9)
    ds_read_b128 a[0:3], v173 offset:0
    ds_read_b128 a[4:7], v173 offset:1024
    ds_read_b128 a[8:11], v173 offset:2048
    ds_read_b128 a[12:15], v173 offset:3072
    ds_read_b128 a[16:19], v173 offset:4096
    ds_read_b128 a[20:23], v173 offset:5120
    ds_read_b128 a[24:27], v173 offset:6144
    s_add_u32 s83, s58, 21553152
    s_add_u32 m0, s59, 57344
    s_nop 0
    buffer_load_dwordx4 v1, s[12:15], s83 offen offset:0 sc1 lds
    buffer_load_dwordx4 v1, s[12:15], s83 offen offset:1024 sc1 lds
    buffer_load_dwordx4 v1, s[12:15], s83 offen offset:2048 sc1 lds
    s_waitcnt vmcnt(3)
    s_waitcnt lgkmcnt(0)
    v_mfma_f32_16x16x32_bf16 a[172:175], a[0:3], v[176:179], 0
    buffer_load_dwordx4 v1, s[12:15], s83 offen offset:3072 sc1 lds
    ds_read_b128 a[28:31], v173 offset:28672
    v_mfma_f32_16x16x32_bf16 a[176:179], a[4:7], v[176:179], 0
    ds_read_b128 a[32:35], v173 offset:29696
    s_add_u32 s83, s83, 4096
    s_add_u32 m0, s59, 61440
    v_mfma_f32_16x16x32_bf16 a[180:183], a[8:11], v[176:179], 0
    buffer_load_dwordx4 v1, s[12:15], s83 offen offset:0 sc1 lds
    ds_read_b128 a[36:39], v173 offset:30720
    v_mfma_f32_16x16x32_bf16 a[184:187], a[12:15], v[176:179], 0
    ds_read_b128 a[40:43], v173 offset:31744
    v_mfma_f32_16x16x32_bf16 a[188:191], a[16:19], v[176:179], 0
    buffer_load_dwordx4 v1, s[12:15], s83 offen offset:1024 sc1 lds
    ds_read_b128 a[44:47], v173 offset:32768
    v_mfma_f32_16x16x32_bf16 a[192:195], a[20:23], v[176:179], 0
    ds_read_b128 a[48:51], v173 offset:33792
    v_mfma_f32_16x16x32_bf16 a[196:199], a[24:27], v[176:179], 0
    buffer_load_dwordx4 v1, s[12:15], s83 offen offset:2048 sc1 lds
    ds_read_b128 a[52:55], v173 offset:34816
    buffer_load_dword v36, v35, s[12:15], s100 offen sc1
    s_waitcnt lgkmcnt(0)
    v_mfma_f32_16x16x32_bf16 a[172:175], a[28:31], v[176:179], a[172:175]
    v_mfma_f32_16x16x32_bf16 a[176:179], a[32:35], v[176:179], a[176:179]
    v_mfma_f32_16x16x32_bf16 a[180:183], a[36:39], v[176:179], a[180:183]
    v_mfma_f32_16x16x32_bf16 a[184:187], a[40:43], v[176:179], a[184:187]
    v_mfma_f32_16x16x32_bf16 a[188:191], a[44:47], v[176:179], a[188:191]
    v_mfma_f32_16x16x32_bf16 a[192:195], a[48:51], v[176:179], a[192:195]
    v_mfma_f32_16x16x32_bf16 a[196:199], a[52:55], v[176:179], a[196:199]
    s_waitcnt vmcnt(0)
    v_cmp_ne_u32 vcc, 1, v36
    s_cbranch_vccz L_ok_35
    s_mov_b32 s79, 0
L_spin_34:
    s_sleep 1
    buffer_load_dword v36, v35, s[12:15], s100 offen sc1
    s_add_u32 s79, s79, 1
    s_cmp_gt_u32 s79, 200000
    s_cbranch_scc1 L_ok_35
    s_waitcnt vmcnt(0)
    v_cmp_ne_u32 vcc, 1, v36
    s_cbranch_vccnz L_spin_34
L_ok_35:
    s_mul_i32 s77, s3, 20480
    s_add_u32 s92, s77, 2818048
    s_add_u32 s93, s77, 2823168
    s_add_u32 s94, s77, 2828288
    s_add_u32 s95, s77, 2833408
    buffer_load_dwordx4 v[40:43], v1, s[12:15], s92 offen offset:0 sc1
    s_add_u32 s60, s92, 20480
    buffer_load_dwordx4 v[44:47], v1, s[12:15], s60 offen offset:0 sc1
    buffer_load_dwordx4 v[48:51], v1, s[12:15], s92 offen offset:1024 sc1
    buffer_load_dwordx4 v[52:55], v1, s[12:15], s60 offen offset:1024 sc1
    buffer_load_dwordx4 v[56:59], v1, s[12:15], s92 offen offset:2560 sc1
    buffer_load_dwordx4 v[60:63], v1, s[12:15], s60 offen offset:2560 sc1
    s_mul_i32 s76, s64, 448
    v_lshlrev_b32 v250, 4, v37
    v_add_u32 v250, 143360, v250
    v_add_u32 v249, s76, v250
    ds_read_b128 a[0:3], v173 offset:57344
    ds_read_b128 a[4:7], v173 offset:58368
    ds_read_b128 a[8:11], v173 offset:59392
    ds_read_b128 a[12:15], v173 offset:60416
    ds_read_b128 a[16:19], v173 offset:61440
    ds_read_b128 a[20:23], v173 offset:62464
    ds_read_b128 a[24:27], v173 offset:63488
    s_waitcnt lgkmcnt(0)
    v_mfma_f32_16x16x32_bf16 a[172:175], a[0:3], v[176:179], a[172:175]
    buffer_load_dwordx4 v[64:67], v1, s[12:15], s92 offen offset:3584 sc1
    v_mfma_f32_16x16x32_bf16 a[176:179], a[4:7], v[176:179], a[176:179]
    v_mfma_f32_16x16x32_bf16 a[180:183], a[8:11], v[176:179], a[180:183]
    buffer_load_dwordx4 v[68:71], v1, s[12:15], s60 offen offset:3584 sc1
    v_mfma_f32_16x16x32_bf16 a[184:187], a[12:15], v[176:179], a[184:187]
    v_mfma_f32_16x16x32_bf16 a[188:191], a[16:19], v[176:179], a[188:191]
    buffer_load_dwordx2 v[72:73], v3, s[12:15], s92 offen sc1
    buffer_load_dwordx2 v[74:75], v3, s[12:15], s92 offen offset:2560 sc1
    v_mfma_f32_16x16x32_bf16 a[192:195], a[20:23], v[176:179], a[192:195]
    v_mfma_f32_16x16x32_bf16 a[196:199], a[24:27], v[176:179], a[196:199]
    buffer_load_dwordx2 v[76:77], v3, s[12:15], s60 offen sc1
    buffer_load_dwordx2 v[78:79], v3, s[12:15], s60 offen offset:2560 sc1
    s_lshr_b32 s76, s3, 2
    s_lshl_b32 s76, s76, 12
    s_and_b32 s77, s3, 3
    s_lshl_b32 s77, s77, 7
    s_add_u32 s76, s76, s77
    s_add_u32 s61, s76, 5439488
    v_lshlrev_b32 v248, 10, v37
    v_lshl_add_u32 v248, v2, 3, v248
    s_waitcnt lgkmcnt(0)
    s_barrier
    ds_read_b128 a[200:203], v9 offset:0
    ds_read_b128 a[204:207], v9 offset:1024
    ds_read_b128 a[208:211], v9 offset:2048
    ds_read_b128 a[212:215], v9 offset:3072
    ds_read_b128 a[216:219], v9 offset:4096
    ds_read_b128 a[220:223], v9 offset:5120
    ds_read_b128 a[224:227], v9 offset:6144
    s_waitcnt vmcnt(10) lgkmcnt(0)
    v_mfma_f32_16x16x32_bf16 v[184:187], a[200:203], v[40:43], 0
    ds_read_b128 a[228:231], v9 offset:7168
    v_mfma_f32_16x16x32_bf16 v[212:215], a[200:203], v[44:47], 0
    ds_read_b128 a[232:235], v9 offset:8192
    v_mfma_f32_16x16x32_bf16 v[188:191], a[204:207], v[40:43], 0
    ds_read_b128 a[236:239], v9 offset:9216
    v_mfma_f32_16x16x32_bf16 v[216:219], a[204:207], v[44:47], 0
    ds_read_b128 a[240:243], v9 offset:10240
    v_mfma_f32_16x16x32_bf16 v[192:195], a[208:211], v[40:43], 0
    ds_read_b128 a[244:247], v9 offset:11264
    v_mfma_f32_16x16x32_bf16 v[220:223], a[208:211], v[44:47], 0
    ds_read_b128 a[248:251], v9 offset:12288
    v_mfma_f32_16x16x32_bf16 v[196:199], a[212:215], v[40:43], 0
    ds_read_b128 a[252:255], v9 offset:13312
    v_mfma_f32_16x16x32_bf16 v[224:227], a[212:215], v[44:47], 0
    buffer_load_dwordx4 v[80:83], v1, s[12:15], s93 offen offset:0 sc1
    v_mfma_f32_16x16x32_bf16 v[200:203], a[216:219], v[40:43], 0
    s_add_u32 s60, s93, 20480
    v_mfma_f32_16x16x32_bf16 v[228:231], a[216:219], v[44:47], 0
    buffer_load_dwordx4 v[84:87], v1, s[12:15], s60 offen offset:0 sc1
    v_mfma_f32_16x16x32_bf16 v[204:207], a[220:223], v[40:43], 0
    s_add_u32 s83, s58, 21581824
    s_add_u32 m0, s59, 86016
    v_mfma_f32_16x16x32_bf16 v[232:235], a[220:223], v[44:47], 0
    buffer_load_dwordx4 v1, s[12:15], s83 offen offset:0 sc1 lds
    v_mfma_f32_16x16x32_bf16 v[208:211], a[224:227], v[40:43], 0
    v_mfma_f32_16x16x32_bf16 v[236:239], a[224:227], v[44:47], 0
    s_waitcnt vmcnt(11) lgkmcnt(0)
    v_mfma_f32_16x16x32_bf16 v[184:187], a[228:231], v[48:51], v[184:187]
    ds_read_b128 a[200:203], v9 offset:14336
    v_mfma_f32_16x16x32_bf16 v[212:215], a[228:231], v[52:55], v[212:215]
    ds_read_b128 a[204:207], v9 offset:15360
    v_mfma_f32_16x16x32_bf16 v[188:191], a[232:235], v[48:51], v[188:191]
    ds_read_b128 a[208:211], v9 offset:16384
    v_mfma_f32_16x16x32_bf16 v[216:219], a[232:235], v[52:55], v[216:219]
    ds_read_b128 a[212:215], v9 offset:17408
    v_mfma_f32_16x16x32_bf16 v[192:195], a[236:239], v[48:51], v[192:195]
    ds_read_b128 a[216:219], v9 offset:18432
    v_mfma_f32_16x16x32_bf16 v[220:223], a[236:239], v[52:55], v[220:223]
    ds_read_b128 a[220:223], v9 offset:19456
    v_mfma_f32_16x16x32_bf16 v[196:199], a[240:243], v[48:51], v[196:199]
    ds_read_b128 a[224:227], v9 offset:20480
    v_mfma_f32_16x16x32_bf16 v[224:227], a[240:243], v[52:55], v[224:227]
    buffer_load_dwordx4 v[88:91], v1, s[12:15], s93 offen offset:1024 sc1
    v_mfma_f32_16x16x32_bf16 v[200:203], a[244:247], v[48:51], v[200:203]
    v_mfma_f32_16x16x32_bf16 v[228:231], a[244:247], v[52:55], v[228:231]
    buffer_load_dwordx4 v[92:95], v1, s[12:15], s60 offen offset:1024 sc1
    v_mfma_f32_16x16x32_bf16 v[204:207], a[248:251], v[48:51], v[204:207]
    v_mfma_f32_16x16x32_bf16 v[232:235], a[248:251], v[52:55], v[232:235]
    buffer_load_dwordx4 v1, s[12:15], s83 offen offset:1024 sc1 lds
    v_mfma_f32_16x16x32_bf16 v[208:211], a[252:255], v[48:51], v[208:211]
    v_mfma_f32_16x16x32_bf16 v[236:239], a[252:255], v[52:55], v[236:239]
    s_waitcnt vmcnt(12) lgkmcnt(0)
    v_mfma_f32_16x16x32_bf16 v[184:187], a[200:203], v[56:59], v[184:187]
    ds_read_b128 a[228:231], v9 offset:21504
    v_mfma_f32_16x16x32_bf16 v[212:215], a[200:203], v[60:63], v[212:215]
    ds_read_b128 a[232:235], v9 offset:22528
    v_mfma_f32_16x16x32_bf16 v[188:191], a[204:207], v[56:59], v[188:191]
    ds_read_b128 a[236:239], v9 offset:23552
    v_mfma_f32_16x16x32_bf16 v[216:219], a[204:207], v[60:63], v[216:219]
    ds_read_b128 a[240:243], v9 offset:24576
    v_mfma_f32_16x16x32_bf16 v[192:195], a[208:211], v[56:59], v[192:195]
    ds_read_b128 a[244:247], v9 offset:25600
    v_mfma_f32_16x16x32_bf16 v[220:223], a[208:211], v[60:63], v[220:223]
    ds_read_b128 a[248:251], v9 offset:26624
    v_mfma_f32_16x16x32_bf16 v[196:199], a[212:215], v[56:59], v[196:199]
    ds_read_b128 a[252:255], v9 offset:27648
    v_mfma_f32_16x16x32_bf16 v[224:227], a[212:215], v[60:63], v[224:227]
    buffer_load_dwordx4 v[96:99], v1, s[12:15], s93 offen offset:2560 sc1
    v_mfma_f32_16x16x32_bf16 v[200:203], a[216:219], v[56:59], v[200:203]
    v_mfma_f32_16x16x32_bf16 v[228:231], a[216:219], v[60:63], v[228:231]
    buffer_load_dwordx4 v[100:103], v1, s[12:15], s60 offen offset:2560 sc1
    v_mfma_f32_16x16x32_bf16 v[204:207], a[220:223], v[56:59], v[204:207]
    v_mfma_f32_16x16x32_bf16 v[232:235], a[220:223], v[60:63], v[232:235]
    buffer_load_dwordx4 v1, s[12:15], s83 offen offset:2048 sc1 lds
    v_mfma_f32_16x16x32_bf16 v[208:211], a[224:227], v[56:59], v[208:211]
    v_mfma_f32_16x16x32_bf16 v[236:239], a[224:227], v[60:63], v[236:239]
    s_waitcnt vmcnt(13) lgkmcnt(0)
    v_mfma_f32_16x16x32_bf16 v[184:187], a[228:231], v[64:67], v[184:187]
    ds_read_b128 a[200:203], v9 offset:28672
    v_mfma_f32_16x16x32_bf16 v[212:215], a[228:231], v[68:71], v[212:215]
    ds_read_b128 a[204:207], v9 offset:29696
    v_mfma_f32_16x16x32_bf16 v[188:191], a[232:235], v[64:67], v[188:191]
    ds_read_b128 a[208:211], v9 offset:30720
    v_mfma_f32_16x16x32_bf16 v[216:219], a[232:235], v[68:71], v[216:219]
    ds_read_b128 a[212:215], v9 offset:31744
    v_mfma_f32_16x16x32_bf16 v[192:195], a[236:239], v[64:67], v[192:195]
    ds_read_b128 a[216:219], v9 offset:32768
    v_mfma_f32_16x16x32_bf16 v[220:223], a[236:239], v[68:71], v[220:223]
    ds_read_b128 a[220:223], v9 offset:33792
    v_mfma_f32_16x16x32_bf16 v[196:199], a[240:243], v[64:67], v[196:199]
    ds_read_b128 a[224:227], v9 offset:34816
    v_mfma_f32_16x16x32_bf16 v[224:227], a[240:243], v[68:71], v[224:227]
    buffer_load_dwordx4 v[104:107], v1, s[12:15], s93 offen offset:3584 sc1
    v_mfma_f32_16x16x32_bf16 v[200:203], a[244:247], v[64:67], v[200:203]
    v_mfma_f32_16x16x32_bf16 v[228:231], a[244:247], v[68:71], v[228:231]
    buffer_load_dwordx4 v[108:111], v1, s[12:15], s60 offen offset:3584 sc1
    v_mfma_f32_16x16x32_bf16 v[204:207], a[248:251], v[64:67], v[204:207]
    v_mfma_f32_16x16x32_bf16 v[232:235], a[248:251], v[68:71], v[232:235]
    buffer_load_dwordx4 v1, s[12:15], s83 offen offset:3072 sc1 lds
    v_mfma_f32_16x16x32_bf16 v[208:211], a[252:255], v[64:67], v[208:211]
    v_mfma_f32_16x16x32_bf16 v[236:239], a[252:255], v[68:71], v[236:239]
    s_waitcnt vmcnt(12) lgkmcnt(0)
    v_mfma_f32_16x16x32_bf16 v[184:187], a[200:203], v[72:75], v[184:187]
    ds_read_b128 a[228:231], v9 offset:35840
    v_mfma_f32_16x16x32_bf16 v[212:215], a[200:203], v[76:79], v[212:215]
    ds_read_b128 a[232:235], v9 offset:36864
    v_mfma_f32_16x16x32_bf16 v[188:191], a[204:207], v[72:75], v[188:191]
    ds_read_b128 a[236:239], v9 offset:37888
    v_mfma_f32_16x16x32_bf16 v[216:219], a[204:207], v[76:79], v[216:219]
    ds_read_b128 a[240:243], v9 offset:38912
    v_mfma_f32_16x16x32_bf16 v[192:195], a[208:211], v[72:75], v[192:195]
    ds_read_b128 a[244:247], v9 offset:39936
    v_mfma_f32_16x16x32_bf16 v[220:223], a[208:211], v[76:79], v[220:223]
    ds_read_b128 a[248:251], v9 offset:40960
    v_mfma_f32_16x16x32_bf16 v[196:199], a[212:215], v[72:75], v[196:199]
    ds_read_b128 a[252:255], v9 offset:41984
    v_mfma_f32_16x16x32_bf16 v[224:227], a[212:215], v[76:79], v[224:227]
    s_cmp_lt_u32 s81, 640
    s_cbranch_scc1 L_nossm_36
    s_mov_b64 s[24:25], s[44:45]
    s_mov_b32 s26, 2621440
    s_mov_b32 s27, 0x20000
    s_sub_u32 s43, s81, 640
    s_mul_i32 s43, s43, 6912
    v_lshlrev_b32 v252, 7, v0
    s_mov_b32 exec_hi, 0x3fffff
    buffer_load_dword v253, v252, s[24:27], s43 offen
    s_mov_b64 exec, -1
L_nossm_36:
    v_mfma_f32_16x16x32_bf16 v[200:203], a[216:219], v[72:75], v[200:203]
    v_mfma_f32_16x16x32_bf16 v[228:231], a[216:219], v[76:79], v[228:231]
    buffer_load_dwordx2 v[112:113], v3, s[12:15], s93 offen sc1
    buffer_load_dwordx2 v[114:115], v3, s[12:15], s93 offen offset:2560 sc1
    v_mfma_f32_16x16x32_bf16 v[204:207], a[220:223], v[72:75], v[204:207]
    v_mfma_f32_16x16x32_bf16 v[232:235], a[220:223], v[76:79], v[232:235]
    buffer_load_dwordx2 v[116:117], v3, s[12:15], s60 offen sc1
    buffer_load_dwordx2 v[118:119], v3, s[12:15], s60 offen offset:2560 sc1
    v_mfma_f32_16x16x32_bf16 v[208:211], a[224:227], v[72:75], v[208:211]
    v_mfma_f32_16x16x32_bf16 v[236:239], a[224:227], v[76:79], v[236:239]
    s_waitcnt vmcnt(14) lgkmcnt(0)
    v_mfma_f32_16x16x32_bf16 v[184:187], a[228:231], v[80:83], v[184:187]
    ds_read_b128 a[200:203], v9 offset:43008
    v_mfma_f32_16x16x32_bf16 v[212:215], a[228:231], v[84:87], v[212:215]
    ds_read_b128 a[204:207], v9 offset:44032
    v_mfma_f32_16x16x32_bf16 v[188:191], a[232:235], v[80:83], v[188:191]
    ds_read_b128 a[208:211], v9 offset:45056
    v_mfma_f32_16x16x32_bf16 v[216:219], a[232:235], v[84:87], v[216:219]
    ds_read_b128 a[212:215], v9 offset:46080
    v_mfma_f32_16x16x32_bf16 v[192:195], a[236:239], v[80:83], v[192:195]
    ds_read_b128 a[216:219], v9 offset:47104
    v_mfma_f32_16x16x32_bf16 v[220:223], a[236:239], v[84:87], v[220:223]
    ds_read_b128 a[220:223], v9 offset:48128
    v_mfma_f32_16x16x32_bf16 v[196:199], a[240:243], v[80:83], v[196:199]
    ds_read_b128 a[224:227], v9 offset:49152
    s_add_u32 s83, s83, 4096
    s_add_u32 m0, s59, 90112
    v_mfma_f32_16x16x32_bf16 v[224:227], a[240:243], v[84:87], v[224:227]
    buffer_load_dwordx4 v1, s[12:15], s83 offen offset:0 sc1 lds
    v_mfma_f32_16x16x32_bf16 v[200:203], a[244:247], v[80:83], v[200:203]
    v_mfma_f32_16x16x32_bf16 v[228:231], a[244:247], v[84:87], v[228:231]
    buffer_load_dwordx4 v[120:123], v1, s[12:15], s94 offen offset:0 sc1
    v_mfma_f32_16x16x32_bf16 v[204:207], a[248:251], v[80:83], v[204:207]
    s_add_u32 s60, s94, 20480
    v_mfma_f32_16x16x32_bf16 v[232:235], a[248:251], v[84:87], v[232:235]
    buffer_load_dwordx4 v[124:127], v1, s[12:15], s60 offen offset:0 sc1
    v_mfma_f32_16x16x32_bf16 v[208:211], a[252:255], v[80:83], v[208:211]
    v_mfma_f32_16x16x32_bf16 v[236:239], a[252:255], v[84:87], v[236:239]
    s_waitcnt vmcnt(14) lgkmcnt(0)
    v_mfma_f32_16x16x32_bf16 v[184:187], a[200:203], v[88:91], v[184:187]
    ds_read_b128 a[228:231], v9 offset:50176
    v_mfma_f32_16x16x32_bf16 v[212:215], a[200:203], v[92:95], v[212:215]
    ds_read_b128 a[232:235], v9 offset:51200
    v_mfma_f32_16x16x32_bf16 v[188:191], a[204:207], v[88:91], v[188:191]
    ds_read_b128 a[236:239], v9 offset:52224
    v_mfma_f32_16x16x32_bf16 v[216:219], a[204:207], v[92:95], v[216:219]
    ds_read_b128 a[240:243], v9 offset:53248
    v_mfma_f32_16x16x32_bf16 v[192:195], a[208:211], v[88:91], v[192:195]
    ds_read_b128 a[244:247], v9 offset:54272
    v_mfma_f32_16x16x32_bf16 v[220:223], a[208:211], v[92:95], v[220:223]
    ds_read_b128 a[248:251], v9 offset:55296
    v_mfma_f32_16x16x32_bf16 v[196:199], a[212:215], v[88:91], v[196:199]
    ds_read_b128 a[252:255], v9 offset:56320
    v_mfma_f32_16x16x32_bf16 v[224:227], a[212:215], v[92:95], v[224:227]
    buffer_load_dwordx4 v1, s[12:15], s83 offen offset:1024 sc1 lds
    v_mfma_f32_16x16x32_bf16 v[200:203], a[216:219], v[88:91], v[200:203]
    v_mfma_f32_16x16x32_bf16 v[228:231], a[216:219], v[92:95], v[228:231]
    buffer_load_dwordx4 v[128:131], v1, s[12:15], s94 offen offset:1024 sc1
    v_mfma_f32_16x16x32_bf16 v[204:207], a[220:223], v[88:91], v[204:207]
    v_mfma_f32_16x16x32_bf16 v[232:235], a[220:223], v[92:95], v[232:235]
    buffer_load_dwordx4 v[132:135], v1, s[12:15], s60 offen offset:1024 sc1
    v_mfma_f32_16x16x32_bf16 v[208:211], a[224:227], v[88:91], v[208:211]
    v_mfma_f32_16x16x32_bf16 v[236:239], a[224:227], v[92:95], v[236:239]
    s_waitcnt vmcnt(14) lgkmcnt(0)
    v_mfma_f32_16x16x32_bf16 v[184:187], a[228:231], v[96:99], v[184:187]
    ds_read_b128 a[200:203], v9 offset:57344
    v_mfma_f32_16x16x32_bf16 v[212:215], a[228:231], v[100:103], v[212:215]
    ds_read_b128 a[204:207], v9 offset:58368
    v_mfma_f32_16x16x32_bf16 v[188:191], a[232:235], v[96:99], v[188:191]
    ds_read_b128 a[208:211], v9 offset:59392
    v_mfma_f32_16x16x32_bf16 v[216:219], a[232:235], v[100:103], v[216:219]
    ds_read_b128 a[212:215], v9 offset:60416
    v_mfma_f32_16x16x32_bf16 v[192:195], a[236:239], v[96:99], v[192:195]
    ds_read_b128 a[216:219], v9 offset:61440
    v_mfma_f32_16x16x32_bf16 v[220:223], a[236:239], v[100:103], v[220:223]
    ds_read_b128 a[220:223], v9 offset:62464
    v_mfma_f32_16x16x32_bf16 v[196:199], a[240:243], v[96:99], v[196:199]
    ds_read_b128 a[224:227], v9 offset:63488
    v_mfma_f32_16x16x32_bf16 v[224:227], a[240:243], v[100:103], v[224:227]
    buffer_load_dwordx4 v1, s[12:15], s83 offen offset:2048 sc1 lds
    v_mfma_f32_16x16x32_bf16 v[200:203], a[244:247], v[96:99], v[200:203]
    v_mfma_f32_16x16x32_bf16 v[228:231], a[244:247], v[100:103], v[228:231]
    buffer_load_dwordx4 v[136:139], v1, s[12:15], s94 offen offset:2560 sc1
    v_mfma_f32_16x16x32_bf16 v[204:207], a[248:251], v[96:99], v[204:207]
    v_mfma_f32_16x16x32_bf16 v[232:235], a[248:251], v[100:103], v[232:235]
    buffer_load_dwordx4 v[140:143], v1, s[12:15], s60 offen offset:2560 sc1
    v_mfma_f32_16x16x32_bf16 v[208:211], a[252:255], v[96:99], v[208:211]
    v_mfma_f32_16x16x32_bf16 v[236:239], a[252:255], v[100:103], v[236:239]
    s_waitcnt vmcnt(14) lgkmcnt(0)
    v_mfma_f32_16x16x32_bf16 v[184:187], a[200:203], v[104:107], v[184:187]
    ds_read_b128 a[228:231], v9 offset:64512
    v_mfma_f32_16x16x32_bf16 v[212:215], a[200:203], v[108:111], v[212:215]
    ds_read_b128 a[232:235], v10 offset:0
    v_mfma_f32_16x16x32_bf16 v[188:191], a[204:207], v[104:107], v[188:191]
    ds_read_b128 a[236:239], v10 offset:1024
    v_mfma_f32_16x16x32_bf16 v[216:219], a[204:207], v[108:111], v[216:219]
    ds_read_b128 a[240:243], v10 offset:2048
    v_mfma_f32_16x16x32_bf16 v[192:195], a[208:211], v[104:107], v[192:195]
    ds_read_b128 a[244:247], v10 offset:3072
    v_mfma_f32_16x16x32_bf16 v[220:223], a[208:211], v[108:111], v[220:223]
    ds_read_b128 a[248:251], v10 offset:4096
    v_mfma_f32_16x16x32_bf16 v[196:199], a[212:215], v[104:107], v[196:199]
    ds_read_b128 a[252:255], v10 offset:5120
    s_add_u32 s83, s58, 21610496
    s_add_u32 m0, s59, 114688
    v_mfma_f32_16x16x32_bf16 v[224:227], a[212:215], v[108:111], v[224:227]
    buffer_load_dwordx4 v1, s[12:15], s83 offen offset:0 sc1 lds
    v_mfma_f32_16x16x32_bf16 v[200:203], a[216:219], v[104:107], v[200:203]
    v_mfma_f32_16x16x32_bf16 v[228:231], a[216:219], v[108:111], v[228:231]
    buffer_load_dwordx4 v[144:147], v1, s[12:15], s94 offen offset:3584 sc1
    v_mfma_f32_16x16x32_bf16 v[204:207], a[220:223], v[104:107], v[204:207]
    v_mfma_f32_16x16x32_bf16 v[232:235], a[220:223], v[108:111], v[232:235]
    buffer_load_dwordx4 v[148:151], v1, s[12:15], s60 offen offset:3584 sc1
    v_mfma_f32_16x16x32_bf16 v[208:211], a[224:227], v[104:107], v[208:211]
    v_mfma_f32_16x16x32_bf16 v[236:239], a[224:227], v[108:111], v[236:239]
    s_waitcnt vmcnt(12) lgkmcnt(0)
    v_mfma_f32_16x16x32_bf16 v[184:187], a[228:231], v[112:115], v[184:187]
    ds_read_b128 a[200:203], v10 offset:6144
    v_mfma_f32_16x16x32_bf16 v[212:215], a[228:231], v[116:119], v[212:215]
    ds_read_b128 a[204:207], v10 offset:7168
    v_mfma_f32_16x16x32_bf16 v[188:191], a[232:235], v[112:115], v[188:191]
    ds_read_b128 a[208:211], v10 offset:8192
    v_mfma_f32_16x16x32_bf16 v[216:219], a[232:235], v[116:119], v[216:219]
    ds_read_b128 a[212:215], v10 offset:9216
    v_mfma_f32_16x16x32_bf16 v[192:195], a[236:239], v[112:115], v[192:195]
    ds_read_b128 a[216:219], v10 offset:10240
    v_mfma_f32_16x16x32_bf16 v[220:223], a[236:239], v[116:119], v[220:223]
    ds_read_b128 a[220:223], v10 offset:11264
    v_mfma_f32_16x16x32_bf16 v[196:199], a[240:243], v[112:115], v[196:199]
    ds_read_b128 a[224:227], v10 offset:12288
    v_mfma_f32_16x16x32_bf16 v[224:227], a[240:243], v[116:119], v[224:227]
    buffer_load_dwordx4 v1, s[12:15], s83 offen offset:1024 sc1 lds
    v_mfma_f32_16x16x32_bf16 v[200:203], a[244:247], v[112:115], v[200:203]
    v_mfma_f32_16x16x32_bf16 v[228:231], a[244:247], v[116:119], v[228:231]
    buffer_load_dwordx2 v[152:153], v3, s[12:15], s94 offen sc1
    buffer_load_dwordx2 v[154:155], v3, s[12:15], s94 offen offset:2560 sc1
    v_mfma_f32_16x16x32_bf16 v[204:207], a[248:251], v[112:115], v[204:207]
    v_mfma_f32_16x16x32_bf16 v[232:235], a[248:251], v[116:119], v[232:235]
    buffer_load_dwordx2 v[156:157], v3, s[12:15], s60 offen sc1
    buffer_load_dwordx2 v[158:159], v3, s[12:15], s60 offen offset:2560 sc1
    v_mfma_f32_16x16x32_bf16 v[208:211], a[252:255], v[112:115], v[208:211]
    v_mfma_f32_16x16x32_bf16 v[236:239], a[252:255], v[116:119], v[236:239]
    s_waitcnt vmcnt(14) lgkmcnt(0)
    v_mfma_f32_16x16x32_bf16 v[184:187], a[200:203], v[120:123], v[184:187]
    ds_read_b128 a[228:231], v10 offset:13312
    v_mfma_f32_16x16x32_bf16 v[212:215], a[200:203], v[124:127], v[212:215]
    ds_read_b128 a[232:235], v10 offset:14336
    v_mfma_f32_16x16x32_bf16 v[188:191], a[204:207], v[120:123], v[188:191]
    ds_read_b128 a[236:239], v10 offset:15360
    v_mfma_f32_16x16x32_bf16 v[216:219], a[204:207], v[124:127], v[216:219]
    ds_read_b128 a[240:243], v10 offset:16384
    v_mfma_f32_16x16x32_bf16 v[192:195], a[208:211], v[120:123], v[192:195]
    ds_read_b128 a[244:247], v10 offset:17408
    v_mfma_f32_16x16x32_bf16 v[220:223], a[208:211], v[124:127], v[220:223]
    ds_read_b128 a[248:251], v10 offset:18432
    v_mfma_f32_16x16x32_bf16 v[196:199], a[212:215], v[120:123], v[196:199]
    ds_read_b128 a[252:255], v10 offset:19456
    v_mfma_f32_16x16x32_bf16 v[224:227], a[212:215], v[124:127], v[224:227]
    buffer_load_dwordx4 v1, s[12:15], s83 offen offset:2048 sc1 lds
    v_mfma_f32_16x16x32_bf16 v[200:203], a[216:219], v[120:123], v[200:203]
    v_mfma_f32_16x16x32_bf16 v[228:231], a[216:219], v[124:127], v[228:231]
    buffer_load_dwordx4 v[40:43], v1, s[12:15], s95 offen offset:0 sc1
    v_mfma_f32_16x16x32_bf16 v[204:207], a[220:223], v[120:123], v[204:207]
    s_add_u32 s60, s95, 20480
    v_mfma_f32_16x16x32_bf16 v[232:235], a[220:223], v[124:127], v[232:235]
    buffer_load_dwordx4 v[44:47], v1, s[12:15], s60 offen offset:0 sc1
    v_mfma_f32_16x16x32_bf16 v[208:211], a[224:227], v[120:123], v[208:211]
    v_mfma_f32_16x16x32_bf16 v[236:239], a[224:227], v[124:127], v[236:239]
    s_waitcnt vmcnt(13)
    s_barrier
    s_waitcnt lgkmcnt(0)
    v_mfma_f32_16x16x32_bf16 v[184:187], a[228:231], v[128:131], v[184:187]
    ds_read_b128 a[200:203], v10 offset:20480
    v_mfma_f32_16x16x32_bf16 v[212:215], a[228:231], v[132:135], v[212:215]
    ds_read_b128 a[204:207], v10 offset:21504
    v_mfma_f32_16x16x32_bf16 v[188:191], a[232:235], v[128:131], v[188:191]
    ds_read_b128 a[208:211], v10 offset:22528
    v_mfma_f32_16x16x32_bf16 v[216:219], a[232:235], v[132:135], v[216:219]
    ds_read_b128 a[212:215], v10 offset:23552
    v_mfma_f32_16x16x32_bf16 v[192:195], a[236:239], v[128:131], v[192:195]
    ds_read_b128 a[216:219], v10 offset:24576
    v_mfma_f32_16x16x32_bf16 v[220:223], a[236:239], v[132:135], v[220:223]
    ds_read_b128 a[220:223], v10 offset:25600
    v_mfma_f32_16x16x32_bf16 v[196:199], a[240:243], v[128:131], v[196:199]
    ds_read_b128 a[224:227], v10 offset:26624
    v_mfma_f32_16x16x32_bf16 v[224:227], a[240:243], v[132:135], v[224:227]
    buffer_load_dwordx4 v1, s[12:15], s83 offen offset:3072 sc1 lds
    v_mfma_f32_16x16x32_bf16 v[200:203], a[244:247], v[128:131], v[200:203]
    v_mfma_f32_16x16x32_bf16 v[228:231], a[244:247], v[132:135], v[228:231]
    buffer_load_dwordx4 v[48:51], v1, s[12:15], s95 offen offset:1024 sc1
    v_mfma_f32_16x16x32_bf16 v[204:207], a[248:251], v[128:131], v[204:207]
    v_mfma_f32_16x16x32_bf16 v[232:235], a[248:251], v[132:135], v[232:235]
    buffer_load_dwordx4 v[52:55], v1, s[12:15], s60 offen offset:1024 sc1
    v_mfma_f32_16x16x32_bf16 v[208:211], a[252:255], v[128:131], v[208:211]
    v_mfma_f32_16x16x32_bf16 v[236:239], a[252:255], v[132:135], v[236:239]
    s_waitcnt vmcnt(14) lgkmcnt(0)
    v_mfma_f32_16x16x32_bf16 v[184:187], a[200:203], v[136:139], v[184:187]
    ds_read_b128 a[228:231], v10 offset:27648
    v_mfma_f32_16x16x32_bf16 v[212:215], a[200:203], v[140:143], v[212:215]
    ds_read_b128 a[232:235], v10 offset:28672
    v_mfma_f32_16x16x32_bf16 v[188:191], a[204:207], v[136:139], v[188:191]
    ds_read_b128 a[236:239], v10 offset:29696
    v_mfma_f32_16x16x32_bf16 v[216:219], a[204:207], v[140:143], v[216:219]
    ds_read_b128 a[240:243], v10 offset:30720
    v_mfma_f32_16x16x32_bf16 v[192:195], a[208:211], v[136:139], v[192:195]
    ds_read_b128 a[244:247], v10 offset:31744
    v_mfma_f32_16x16x32_bf16 v[220:223], a[208:211], v[140:143], v[220:223]
    ds_read_b128 a[248:251], v10 offset:32768
    v_mfma_f32_16x16x32_bf16 v[196:199], a[212:215], v[136:139], v[196:199]
    ds_read_b128 a[252:255], v10 offset:33792
    s_add_u32 s83, s83, 4096
    s_add_u32 m0, s59, 118784
    v_mfma_f32_16x16x32_bf16 v[224:227], a[212:215], v[140:143], v[224:227]
    buffer_load_dwordx4 v1, s[12:15], s83 offen offset:0 sc1 lds
    v_mfma_f32_16x16x32_bf16 v[200:203], a[216:219], v[136:139], v[200:203]
    s_lshl_b32 s82, s66, 2
    s_add_u32 s82, s82, s64
    s_lshl_b32 s82, s82, 7
    s_add_u32 s82, s82, 53248
    v_mfma_f32_16x16x32_bf16 v[228:231], a[216:219], v[140:143], v[228:231]
    buffer_load_dword v36, v38, s[12:15], s82 offen sc1
    v_mfma_f32_16x16x32_bf16 v[204:207], a[220:223], v[136:139], v[204:207]
    v_mfma_f32_16x16x32_bf16 v[232:235], a[220:223], v[140:143], v[232:235]
    buffer_load_dwordx4 v[56:59], v1, s[12:15], s95 offen offset:2560 sc1
    v_mfma_f32_16x16x32_bf16 v[208:211], a[224:227], v[136:139], v[208:211]
    v_mfma_f32_16x16x32_bf16 v[236:239], a[224:227], v[140:143], v[236:239]
    s_cmp_lg_u32 s64, 0
    s_cbranch_scc1 L_cs3_37
    v_mfma_f32_16x16x32_bf16 a[172:175], a[200:203], v[176:179], a[172:175]
    v_mfma_f32_16x16x32_bf16 a[176:179], a[204:207], v[176:179], a[176:179]
    v_mfma_f32_16x16x32_bf16 a[180:183], a[208:211], v[176:179], a[180:183]
    v_mfma_f32_16x16x32_bf16 a[184:187], a[212:215], v[176:179], a[184:187]
    v_mfma_f32_16x16x32_bf16 a[188:191], a[216:219], v[176:179], a[188:191]
    v_mfma_f32_16x16x32_bf16 a[192:195], a[220:223], v[176:179], a[192:195]
    v_mfma_f32_16x16x32_bf16 a[196:199], a[224:227], v[176:179], a[196:199]
L_cs3_37:
    s_waitcnt vmcnt(14) lgkmcnt(0)
    v_mfma_f32_16x16x32_bf16 v[184:187], a[228:231], v[144:147], v[184:187]
    ds_read_b128 a[200:203], v10 offset:34816
    v_mfma_f32_16x16x32_bf16 v[212:215], a[228:231], v[148:151], v[212:215]
    ds_read_b128 a[204:207], v10 offset:35840
    v_mfma_f32_16x16x32_bf16 v[188:191], a[232:235], v[144:147], v[188:191]
    ds_read_b128 a[208:211], v10 offset:36864
    v_mfma_f32_16x16x32_bf16 v[216:219], a[232:235], v[148:151], v[216:219]
    ds_read_b128 a[212:215], v10 offset:37888
    v_mfma_f32_16x16x32_bf16 v[192:195], a[236:239], v[144:147], v[192:195]
    ds_read_b128 a[216:219], v10 offset:38912
    v_mfma_f32_16x16x32_bf16 v[220:223], a[236:239], v[148:151], v[220:223]
    ds_read_b128 a[220:223], v10 offset:39936
    v_mfma_f32_16x16x32_bf16 v[196:199], a[240:243], v[144:147], v[196:199]
    ds_read_b128 a[224:227], v10 offset:40960
    v_mfma_f32_16x16x32_bf16 v[224:227], a[240:243], v[148:151], v[224:227]
    buffer_load_dwordx4 v[60:63], v1, s[12:15], s60 offen offset:2560 sc1
    v_mfma_f32_16x16x32_bf16 v[200:203], a[244:247], v[144:147], v[200:203]
    v_mfma_f32_16x16x32_bf16 v[228:231], a[244:247], v[148:151], v[228:231]
    buffer_load_dwordx4 v1, s[12:15], s83 offen offset:1024 sc1 lds
    v_mfma_f32_16x16x32_bf16 v[204:207], a[248:251], v[144:147], v[204:207]
    v_mfma_f32_16x16x32_bf16 v[232:235], a[248:251], v[148:151], v[232:235]
    buffer_load_dwordx4 v[64:67], v1, s[12:15], s95 offen offset:3584 sc1
    v_mfma_f32_16x16x32_bf16 v[208:211], a[252:255], v[144:147], v[208:211]
    v_mfma_f32_16x16x32_bf16 v[236:239], a[252:255], v[148:151], v[236:239]
    s_cmp_lg_u32 s64, 1
    s_cbranch_scc1 L_cs3_38
    v_mfma_f32_16x16x32_bf16 a[172:175], a[228:231], v[176:179], a[172:175]
    v_mfma_f32_16x16x32_bf16 a[176:179], a[232:235], v[176:179], a[176:179]
    v_mfma_f32_16x16x32_bf16 a[180:183], a[236:239], v[176:179], a[180:183]
    v_mfma_f32_16x16x32_bf16 a[184:187], a[240:243], v[176:179], a[184:187]
    v_mfma_f32_16x16x32_bf16 a[188:191], a[244:247], v[176:179], a[188:191]
    v_mfma_f32_16x16x32_bf16 a[192:195], a[248:251], v[176:179], a[192:195]
    v_mfma_f32_16x16x32_bf16 a[196:199], a[252:255], v[176:179], a[196:199]
L_cs3_38:
    s_waitcnt vmcnt(12) lgkmcnt(0)
    v_mfma_f32_16x16x32_bf16 v[184:187], a[200:203], v[152:155], v[184:187]
    ds_read_b128 a[228:231], v10 offset:41984
    v_mfma_f32_16x16x32_bf16 v[212:215], a[200:203], v[156:159], v[212:215]
    ds_read_b128 a[232:235], v10 offset:43008
    v_mfma_f32_16x16x32_bf16 v[188:191], a[204:207], v[152:155], v[188:191]
    ds_read_b128 a[236:239], v10 offset:44032
    v_mfma_f32_16x16x32_bf16 v[216:219], a[204:207], v[156:159], v[216:219]
    ds_read_b128 a[240:243], v10 offset:45056
    v_mfma_f32_16x16x32_bf16 v[192:195], a[208:211], v[152:155], v[192:195]
    ds_read_b128 a[244:247], v10 offset:46080
    v_mfma_f32_16x16x32_bf16 v[220:223], a[208:211], v[156:159], v[220:223]
    ds_read_b128 a[248:251], v10 offset:47104
    v_mfma_f32_16x16x32_bf16 v[196:199], a[212:215], v[152:155], v[196:199]
    ds_read_b128 a[252:255], v10 offset:48128
    v_mfma_f32_16x16x32_bf16 v[224:227], a[212:215], v[156:159], v[224:227]
    buffer_load_dwordx4 v[68:71], v1, s[12:15], s60 offen offset:3584 sc1
    v_mfma_f32_16x16x32_bf16 v[200:203], a[216:219], v[152:155], v[200:203]
    v_mfma_f32_16x16x32_bf16 v[228:231], a[216:219], v[156:159], v[228:231]
    buffer_load_dwordx4 v1, s[12:15], s83 offen offset:2048 sc1 lds
    v_mfma_f32_16x16x32_bf16 v[204:207], a[220:223], v[152:155], v[204:207]
    v_mfma_f32_16x16x32_bf16 v[232:235], a[220:223], v[156:159], v[232:235]
    buffer_load_dwordx2 v[72:73], v3, s[12:15], s95 offen sc1
    buffer_load_dwordx2 v[74:75], v3, s[12:15], s95 offen offset:2560 sc1
    v_mfma_f32_16x16x32_bf16 v[208:211], a[224:227], v[152:155], v[208:211]
    v_mfma_f32_16x16x32_bf16 v[236:239], a[224:227], v[156:159], v[236:239]
    s_cmp_lg_u32 s64, 2
    s_cbranch_scc1 L_cs3_39
    v_mfma_f32_16x16x32_bf16 a[172:175], a[200:203], v[176:179], a[172:175]
    v_mfma_f32_16x16x32_bf16 a[176:179], a[204:207], v[176:179], a[176:179]
    v_mfma_f32_16x16x32_bf16 a[180:183], a[208:211], v[176:179], a[180:183]
    v_mfma_f32_16x16x32_bf16 a[184:187], a[212:215], v[176:179], a[184:187]
    v_mfma_f32_16x16x32_bf16 a[188:191], a[216:219], v[176:179], a[188:191]
    v_mfma_f32_16x16x32_bf16 a[192:195], a[220:223], v[176:179], a[192:195]
    v_mfma_f32_16x16x32_bf16 a[196:199], a[224:227], v[176:179], a[196:199]
L_cs3_39:
    s_waitcnt vmcnt(2)
    s_barrier
    v_cmp_gt_u32 vcc, 28, v36
    s_cbranch_vccz L_ok_41
    s_mov_b32 s79, 0
L_spin_40:
    s_sleep 1
    buffer_load_dword v36, v38, s[12:15], s82 offen sc1
    s_add_u32 s79, s79, 1
    s_cmp_gt_u32 s79, 200000
    s_cbranch_scc1 L_ok_41
    s_waitcnt vmcnt(0)
    v_cmp_gt_u32 vcc, 28, v36
    s_cbranch_vccnz L_spin_40
L_ok_41:
    s_waitcnt lgkmcnt(0)
    v_mfma_f32_16x16x32_bf16 v[184:187], a[228:231], v[40:43], v[184:187]
    ds_read_b128 a[200:203], v10 offset:49152
    v_mfma_f32_16x16x32_bf16 v[212:215], a[228:231], v[44:47], v[212:215]
    ds_read_b128 a[204:207], v10 offset:50176
    v_mfma_f32_16x16x32_bf16 v[188:191], a[232:235], v[40:43], v[188:191]
    ds_read_b128 a[208:211], v10 offset:51200
    v_mfma_f32_16x16x32_bf16 v[216:219], a[232:235], v[44:47], v[216:219]
    ds_read_b128 a[212:215], v10 offset:52224
    v_mfma_f32_16x16x32_bf16 v[192:195], a[236:239], v[40:43], v[192:195]
    ds_read_b128 a[216:219], v10 offset:53248
    v_mfma_f32_16x16x32_bf16 v[220:223], a[236:239], v[44:47], v[220:223]
    ds_read_b128 a[220:223], v10 offset:54272
    v_mfma_f32_16x16x32_bf16 v[196:199], a[240:243], v[40:43], v[196:199]
    ds_read_b128 a[224:227], v10 offset:55296
    v_mfma_f32_16x16x32_bf16 v[224:227], a[240:243], v[44:47], v[224:227]
    buffer_load_dwordx2 v[76:77], v3, s[12:15], s60 offen sc1
    buffer_load_dwordx2 v[78:79], v3, s[12:15], s60 offen offset:2560 sc1
    v_mfma_f32_16x16x32_bf16 v[200:203], a[244:247], v[40:43], v[200:203]
    v_mfma_f32_16x16x32_bf16 v[228:231], a[244:247], v[44:47], v[228:231]
    buffer_load_dwordx2 v[240:241], v248, s[12:15], s61 offen offset:0 sc1
    buffer_load_dwordx2 v[242:243], v248, s[12:15], s61 offen offset:512 sc1
    buffer_load_dwordx2 v[244:245], v248, s[12:15], s61 offen offset:128 sc1
    buffer_load_dwordx2 v[246:247], v248, s[12:15], s61 offen offset:640 sc1
    v_mfma_f32_16x16x32_bf16 v[204:207], a[248:251], v[40:43], v[204:207]
    s_lshl_b32 s99, s66, 2
    s_add_u32 s99, s99, s64
    s_mul_i32 s99, s99, 71680
    s_add_u32 s99, s99, 18219008
    v_mfma_f32_16x16x32_bf16 v[232:235], a[248:251], v[44:47], v[232:235]
    buffer_load_dwordx4 a[0:3], v1, s[12:15], s99 offen offset:0 sc1
    v_mfma_f32_16x16x32_bf16 v[208:211], a[252:255], v[40:43], v[208:211]
    v_mfma_f32_16x16x32_bf16 v[236:239], a[252:255], v[44:47], v[236:239]
    s_cmp_lg_u32 s64, 3
    s_cbranch_scc1 L_cs3_42
    v_mfma_f32_16x16x32_bf16 a[172:175], a[228:231], v[176:179], a[172:175]
    v_mfma_f32_16x16x32_bf16 a[176:179], a[232:235], v[176:179], a[176:179]
    v_mfma_f32_16x16x32_bf16 a[180:183], a[236:239], v[176:179], a[180:183]
    v_mfma_f32_16x16x32_bf16 a[184:187], a[240:243], v[176:179], a[184:187]
    v_mfma_f32_16x16x32_bf16 a[188:191], a[244:247], v[176:179], a[188:191]
    v_mfma_f32_16x16x32_bf16 a[192:195], a[248:251], v[176:179], a[192:195]
    v_mfma_f32_16x16x32_bf16 a[196:199], a[252:255], v[176:179], a[196:199]
L_cs3_42:
    s_waitcnt lgkmcnt(0)
    v_mfma_f32_16x16x32_bf16 v[184:187], a[200:203], v[48:51], v[184:187]
    ds_read_b128 a[228:231], v10 offset:56320
    v_mfma_f32_16x16x32_bf16 v[212:215], a[200:203], v[52:55], v[212:215]
    ds_read_b128 a[232:235], v10 offset:57344
    v_mfma_f32_16x16x32_bf16 v[188:191], a[204:207], v[48:51], v[188:191]
    ds_read_b128 a[236:239], v10 offset:58368
    v_mfma_f32_16x16x32_bf16 v[216:219], a[204:207], v[52:55], v[216:219]
    ds_read_b128 a[240:243], v10 offset:59392
    v_mfma_f32_16x16x32_bf16 v[192:195], a[208:211], v[48:51], v[192:195]
    ds_read_b128 a[244:247], v10 offset:60416
    v_mfma_f32_16x16x32_bf16 v[220:223], a[208:211], v[52:55], v[220:223]
    ds_read_b128 a[248:251], v10 offset:61440
    v_mfma_f32_16x16x32_bf16 v[196:199], a[212:215], v[48:51], v[196:199]
    ds_read_b128 a[252:255], v10 offset:62464
    v_mfma_f32_16x16x32_bf16 v[224:227], a[212:215], v[52:55], v[224:227]
    buffer_load_dwordx4 a[4:7], v1, s[12:15], s99 offen offset:1024 sc1
    v_mfma_f32_16x16x32_bf16 v[200:203], a[216:219], v[48:51], v[200:203]
    v_mfma_f32_16x16x32_bf16 v[228:231], a[216:219], v[52:55], v[228:231]
    buffer_load_dwordx4 a[8:11], v1, s[12:15], s99 offen offset:2048 sc1
    v_mfma_f32_16x16x32_bf16 v[204:207], a[220:223], v[48:51], v[204:207]
    v_mfma_f32_16x16x32_bf16 v[232:235], a[220:223], v[52:55], v[232:235]
    buffer_load_dwordx4 a[12:15], v1, s[12:15], s99 offen offset:3072 sc1
    v_mfma_f32_16x16x32_bf16 v[208:211], a[224:227], v[48:51], v[208:211]
    v_mfma_f32_16x16x32_bf16 v[236:239], a[224:227], v[52:55], v[236:239]
    s_cmp_lg_u32 s64, 1
    s_cbranch_scc1 L_cs3_43
    v_mfma_f32_16x16x32_bf16 a[172:175], a[200:203], v[176:179], a[172:175]
    v_mfma_f32_16x16x32_bf16 a[176:179], a[204:207], v[176:179], a[176:179]
    v_mfma_f32_16x16x32_bf16 a[180:183], a[208:211], v[176:179], a[180:183]
    v_mfma_f32_16x16x32_bf16 a[184:187], a[212:215], v[176:179], a[184:187]
    v_mfma_f32_16x16x32_bf16 a[188:191], a[216:219], v[176:179], a[188:191]
    v_mfma_f32_16x16x32_bf16 a[192:195], a[220:223], v[176:179], a[192:195]
    v_mfma_f32_16x16x32_bf16 a[196:199], a[224:227], v[176:179], a[196:199]
L_cs3_43:
    s_waitcnt lgkmcnt(0)
    v_mfma_f32_16x16x32_bf16 v[184:187], a[228:231], v[56:59], v[184:187]
    ds_read_b128 a[200:203], v10 offset:63488
    v_mfma_f32_16x16x32_bf16 v[212:215], a[228:231], v[60:63], v[212:215]
    ds_read_b128 a[204:207], v10 offset:64512
    v_mfma_f32_16x16x32_bf16 v[188:191], a[232:235], v[56:59], v[188:191]
    ds_read_b128 a[208:211], v11 offset:0
    v_mfma_f32_16x16x32_bf16 v[216:219], a[232:235], v[60:63], v[216:219]
    ds_read_b128 a[212:215], v11 offset:1024
    v_mfma_f32_16x16x32_bf16 v[192:195], a[236:239], v[56:59], v[192:195]
    ds_read_b128 a[216:219], v11 offset:2048
    v_mfma_f32_16x16x32_bf16 v[220:223], a[236:239], v[60:63], v[220:223]
    ds_read_b128 a[220:223], v11 offset:3072
    v_mfma_f32_16x16x32_bf16 v[196:199], a[240:243], v[56:59], v[196:199]
    ds_read_b128 a[224:227], v11 offset:4096
    s_add_u32 s99, s99, 4096
    v_mfma_f32_16x16x32_bf16 v[224:227], a[240:243], v[60:63], v[224:227]
    buffer_load_dwordx4 a[16:19], v1, s[12:15], s99 offen offset:0 sc1
    v_mfma_f32_16x16x32_bf16 v[200:203], a[244:247], v[56:59], v[200:203]
    v_mfma_f32_16x16x32_bf16 v[228:231], a[244:247], v[60:63], v[228:231]
    buffer_load_dwordx4 a[20:23], v1, s[12:15], s99 offen offset:1024 sc1
    v_mfma_f32_16x16x32_bf16 v[204:207], a[248:251], v[56:59], v[204:207]
    v_mfma_f32_16x16x32_bf16 v[232:235], a[248:251], v[60:63], v[232:235]
    buffer_load_dwordx4 a[24:27], v1, s[12:15], s99 offen offset:2048 sc1
    v_mfma_f32_16x16x32_bf16 v[208:211], a[252:255], v[56:59], v[208:211]
    v_mfma_f32_16x16x32_bf16 v[236:239], a[252:255], v[60:63], v[236:239]
    s_cmp_lg_u32 s64, 2
    s_cbranch_scc1 L_cs3_44
    v_mfma_f32_16x16x32_bf16 a[172:175], a[228:231], v[176:179], a[172:175]
    v_mfma_f32_16x16x32_bf16 a[176:179], a[232:235], v[176:179], a[176:179]
    v_mfma_f32_16x16x32_bf16 a[180:183], a[236:239], v[176:179], a[180:183]
    v_mfma_f32_16x16x32_bf16 a[184:187], a[240:243], v[176:179], a[184:187]
    v_mfma_f32_16x16x32_bf16 a[188:191], a[244:247], v[176:179], a[188:191]
    v_mfma_f32_16x16x32_bf16 a[192:195], a[248:251], v[176:179], a[192:195]
    v_mfma_f32_16x16x32_bf16 a[196:199], a[252:255], v[176:179], a[196:199]
L_cs3_44:
    s_waitcnt lgkmcnt(0)
    v_mfma_f32_16x16x32_bf16 v[184:187], a[200:203], v[64:67], v[184:187]
    ds_read_b128 a[228:231], v11 offset:5120
    v_mfma_f32_16x16x32_bf16 v[212:215], a[200:203], v[68:71], v[212:215]
    ds_read_b128 a[232:235], v11 offset:6144
    v_mfma_f32_16x16x32_bf16 v[188:191], a[204:207], v[64:67], v[188:191]
    ds_read_b128 a[236:239], v11 offset:7168
    v_mfma_f32_16x16x32_bf16 v[216:219], a[204:207], v[68:71], v[216:219]
    ds_read_b128 a[240:243], v11 offset:8192
    v_mfma_f32_16x16x32_bf16 v[192:195], a[208:211], v[64:67], v[192:195]
    ds_read_b128 a[244:247], v11 offset:9216
    v_mfma_f32_16x16x32_bf16 v[220:223], a[208:211], v[68:71], v[220:223]
    ds_read_b128 a[248:251], v11 offset:10240
    v_mfma_f32_16x16x32_bf16 v[196:199], a[212:215], v[64:67], v[196:199]
    ds_read_b128 a[252:255], v11 offset:11264
    s_min_u32 s76, s81, 639
    s_mul_i32 s77, s76, 3277
    s_lshr_b32 s77, s77, 16
    s_lshl_b32 s77, s77, 7
    s_add_u32 s82, s77, 49152
    v_and_b32 v35, 31, v0
    v_lshlrev_b32 v35, 2, v35
    v_mfma_f32_16x16x32_bf16 v[224:227], a[212:215], v[68:71], v[224:227]
    buffer_load_dword v36, v35, s[12:15], s82 offen sc1
    v_mfma_f32_16x16x32_bf16 v[200:203], a[216:219], v[64:67], v[200:203]
    v_mfma_f32_16x16x32_bf16 v[228:231], a[216:219], v[68:71], v[228:231]
    buffer_load_dwordx4 a[28:31], v1, s[12:15], s99 offen offset:3072 sc1
    v_mfma_f32_16x16x32_bf16 v[204:207], a[220:223], v[64:67], v[204:207]
    s_add_u32 s99, s99, 4096
    v_mfma_f32_16x16x32_bf16 v[232:235], a[220:223], v[68:71], v[232:235]
    buffer_load_dwordx4 a[32:35], v1, s[12:15], s99 offen offset:0 sc1
    v_mfma_f32_16x16x32_bf16 v[208:211], a[224:227], v[64:67], v[208:211]
    v_mfma_f32_16x16x32_bf16 v[236:239], a[224:227], v[68:71], v[236:239]
    s_cmp_lg_u32 s64, 3
    s_cbranch_scc1 L_cs3_45
    v_mfma_f32_16x16x32_bf16 a[172:175], a[200:203], v[176:179], a[172:175]
    v_mfma_f32_16x16x32_bf16 a[176:179], a[204:207], v[176:179], a[176:179]
    v_mfma_f32_16x16x32_bf16 a[180:183], a[208:211], v[176:179], a[180:183]
    v_mfma_f32_16x16x32_bf16 a[184:187], a[212:215], v[176:179], a[184:187]
    v_mfma_f32_16x16x32_bf16 a[188:191], a[216:219], v[176:179], a[188:191]
    v_mfma_f32_16x16x32_bf16 a[192:195], a[220:223], v[176:179], a[192:195]
    v_mfma_f32_16x16x32_bf16 a[196:199], a[224:227], v[176:179], a[196:199]
L_cs3_45:
    s_waitcnt vmcnt(14) lgkmcnt(0)
    v_mfma_f32_16x16x32_bf16 v[184:187], a[228:231], v[72:75], v[184:187]
    v_mfma_f32_16x16x32_bf16 v[212:215], a[228:231], v[76:79], v[212:215]
    v_mfma_f32_16x16x32_bf16 v[188:191], a[232:235], v[72:75], v[188:191]
    v_mfma_f32_16x16x32_bf16 v[216:219], a[232:235], v[76:79], v[216:219]
    v_mfma_f32_16x16x32_bf16 v[192:195], a[236:239], v[72:75], v[192:195]
    v_mfma_f32_16x16x32_bf16 v[220:223], a[236:239], v[76:79], v[220:223]
    v_mfma_f32_16x16x32_bf16 v[196:199], a[240:243], v[72:75], v[196:199]
    v_mfma_f32_16x16x32_bf16 v[224:227], a[240:243], v[76:79], v[224:227]
    buffer_load_dwordx4 a[36:39], v1, s[12:15], s99 offen offset:1024 sc1
    v_mfma_f32_16x16x32_bf16 v[200:203], a[244:247], v[72:75], v[200:203]
    v_mfma_f32_16x16x32_bf16 v[228:231], a[244:247], v[76:79], v[228:231]
    v_mfma_f32_16x16x32_bf16 v[204:207], a[248:251], v[72:75], v[204:207]
    v_mfma_f32_16x16x32_bf16 v[232:235], a[248:251], v[76:79], v[232:235]
    v_mfma_f32_16x16x32_bf16 v[208:211], a[252:255], v[72:75], v[208:211]
    v_mfma_f32_16x16x32_bf16 v[236:239], a[252:255], v[76:79], v[236:239]
    s_cmp_lg_u32 s64, 0
    s_cbranch_scc1 L_cs3_46
    v_mfma_f32_16x16x32_bf16 a[172:175], a[228:231], v[176:179], a[172:175]
    v_mfma_f32_16x16x32_bf16 a[176:179], a[232:235], v[176:179], a[176:179]
    v_mfma_f32_16x16x32_bf16 a[180:183], a[236:239], v[176:179], a[180:183]
    v_mfma_f32_16x16x32_bf16 a[184:187], a[240:243], v[176:179], a[184:187]
    v_mfma_f32_16x16x32_bf16 a[188:191], a[244:247], v[176:179], a[188:191]
    v_mfma_f32_16x16x32_bf16 a[192:195], a[248:251], v[176:179], a[192:195]
    v_mfma_f32_16x16x32_bf16 a[196:199], a[252:255], v[176:179], a[196:199]
L_cs3_46:
    s_waitcnt vmcnt(3)
    v_cmp_ne_u32 vcc, 1, v36
    s_cbranch_vccz L_ok_48
    s_mov_b32 s79, 0
L_spin_47:
    s_sleep 1
    buffer_load_dword v36, v35, s[12:15], s82 offen sc1
    s_add_u32 s79, s79, 1
    s_cmp_gt_u32 s79, 200000
    s_cbranch_scc1 L_ok_48
    s_waitcnt vmcnt(0)
    v_cmp_ne_u32 vcc, 1, v36
    s_cbranch_vccnz L_spin_47
L_ok_48:
    s_mov_b32 exec_lo, 0x00010001
    s_mov_b32 exec_hi, 0x00010001
    ds_write_b128 v249, a[172:175] offset:0
    ds_write_b128 v249, a[176:179] offset:64
    ds_write_b128 v249, a[180:183] offset:128
    ds_write_b128 v249, a[184:187] offset:192
    ds_write_b128 v249, a[188:191] offset:256
    ds_write_b128 v249, a[192:195] offset:320
    ds_write_b128 v249, a[196:199] offset:384
    s_mov_b64 exec, -1
    s_waitcnt lgkmcnt(0)
    s_barrier
    ds_read_b128 v[56:59], v250 offset:0
    ds_read_b128 v[60:63], v250 offset:64
    ds_read_b128 v[64:67], v250 offset:128
    ds_read_b128 v[68:71], v250 offset:192
    ds_read_b128 v[72:75], v250 offset:256
    ds_read_b128 v[76:79], v250 offset:320
    ds_read_b128 v[80:83], v250 offset:384
    ds_read_b128 v[84:87], v250 offset:448
    ds_read_b128 v[88:91], v250 offset:512
    ds_read_b128 v[92:95], v250 offset:576
    ds_read_b128 v[96:99], v250 offset:640
    ds_read_b128 v[100:103], v250 offset:704
    ds_read_b128 v[104:107], v250 offset:768
    ds_read_b128 v[108:111], v250 offset:832
    ds_read_b128 v[112:115], v250 offset:896
    ds_read_b128 v[116:119], v250 offset:960
    ds_read_b128 v[120:123], v250 offset:1024
    ds_read_b128 v[124:127], v250 offset:1088
    ds_read_b128 v[128:131], v250 offset:1152
    ds_read_b128 v[132:135], v250 offset:1216
    ds_read_b128 v[136:139], v250 offset:1280
    ds_read_b128 v[140:143], v250 offset:1344
    ds_read_b128 v[144:147], v250 offset:1408
    ds_read_b128 v[148:151], v250 offset:1472
    ds_read_b128 v[152:155], v250 offset:1536
    ds_read_b128 v[156:159], v250 offset:1600
    ds_read_b128 v[160:163], v250 offset:1664
    ds_read_b128 v[164:167], v250 offset:1728
    s_lshl_b32 s76, s3, 4
    s_add_u32 s76, s76, s96
    s_mul_i32 s100, s76, 3584
    s_add_u32 s100, s100, 5570560
    s_add_u32 s101, s100, 57344
    s_mov_b32 s42, s100
    s_min_u32 s83, s81, 639
    s_lshl_b32 s92, s83, 12
    s_lshl_b32 s93, s83, 1
    s_add_u32 s94, s92, 12910592
    s_mul_i32 s95, s64, 13824
    s_mov_b64 s[24:25], s[44:45]
    s_mov_b32 s26, 2621440
    s_mov_b32 s27, 0x20000
    s_mov_b64 s[16:17], s[46:47]
    s_mov_b32 s18, 1280
    s_mov_b32 s19, 0x20000
    s_mov_b64 s[20:21], s[12:13]
    s_cmp_lt_u32 s81, 640
    s_cselect_b32 s26, s26, 0
    s_cselect_b32 s22, s14, 0
    v_add_u32 v169, 2, v1
    v_mov_b32 v170, 0x7ffffff0
    v_add_f32 v240, v240, v242
    buffer_load_dword v172, v38, s[24:27], s92 offen
    buffer_load_ushort v173, v38, s[16:19], s93 offen
    v_add_f32 v241, v241, v243
    s_nop 1
    v_permlane16_swap_b32 v240, v241
    v_add_f32 v240, v240, v241
    v_mov_b32 v242, v240
    s_nop 1
    v_permlane32_swap_b32 v240, v242
    v_add_f32 v240, v240, v242
    v_mov_b32 v241, v240
    s_nop 1
    v_permlane16_swap_b32 v240, v241
    v_mul_f32 v242, s71, v240
    v_mul_f32 v241, s71, v241
    v_fma_f32 v241, -v242, v242, v241
    v_max_f32 v241, 0, v241
    v_add_f32 v243, s72, v241
    s_add_u32 m0, s95, 0
    s_mov_b64 exec, 15
    buffer_load_dwordx4 v170, s[16:19], 0 offen lds
    s_add_u32 m0, s95, 8448
    s_mov_b32 exec_lo, -1
    buffer_load_dwordx4 v170, s[16:19], 0 offen lds
    s_add_u32 m0, s95, 13088
    s_nop 0
    buffer_load_dwordx4 v170, s[16:19], 0 offen lds
    s_mov_b64 exec, -1
    v_rsq_f32 v248, v243
    v_sub_f32 v242, 0, v242
    v_mul_f32 v243, v243, v248
    v_mul_f32 v240, v248, v248
    v_mul_f32 v241, s69, v248
    v_mul_f32 v240, v240, v248
    v_mul_f32 v240, s68, v240
    v_add_f32 v244, v244, v246
    v_add_f32 v245, v245, v247
    s_nop 1
    v_permlane16_swap_b32 v244, v245
    v_add_f32 v244, v244, v245
    v_mov_b32 v246, v244
    s_nop 1
    v_permlane32_swap_b32 v244, v246
    v_add_f32 v244, v244, v246
    v_mov_b32 v245, v244
    s_nop 1
    v_permlane16_swap_b32 v244, v245
    v_mul_f32 v246, s71, v244
    v_mul_f32 v245, s71, v245
    v_fma_f32 v245, -v246, v246, v245
    v_max_f32 v245, 0, v245
    v_add_f32 v247, s72, v245
    v_rsq_f32 v249, v247
    v_sub_f32 v246, 0, v246
    v_mul_f32 v247, v247, v249
    s_add_u32 m0, s95, 64
    v_mul_f32 v244, v249, v249
    buffer_load_dwordx4 v1, s[24:27], s92 offen offset:0  lds
    v_mul_f32 v245, s69, v249
    v_mul_f32 v244, v244, v249
    v_mul_f32 v244, s68, v244
    s_waitcnt lgkmcnt(14)
    v_pk_add_f32 v[56:57], v[56:57], v[84:85]
    v_pk_add_f32 v[58:59], v[58:59], v[86:87]
    v_pk_add_f32 v[60:61], v[60:61], v[88:89]
    v_pk_add_f32 v[62:63], v[62:63], v[90:91]
    v_pk_add_f32 v[64:65], v[64:65], v[92:93]
    v_pk_add_f32 v[66:67], v[66:67], v[94:95]
    v_pk_add_f32 v[68:69], v[68:69], v[96:97]
    v_pk_add_f32 v[70:71], v[70:71], v[98:99]
    v_pk_add_f32 v[72:73], v[72:73], v[100:101]
    v_pk_add_f32 v[74:75], v[74:75], v[102:103]
    v_pk_add_f32 v[76:77], v[76:77], v[104:105]
    v_pk_add_f32 v[78:79], v[78:79], v[106:107]
    v_pk_add_f32 v[80:81], v[80:81], v[108:109]
    v_pk_add_f32 v[82:83], v[82:83], v[110:111]
    s_waitcnt lgkmcnt(0)
    v_pk_add_f32 v[112:113], v[112:113], v[140:141]
    v_pk_add_f32 v[114:115], v[114:115], v[142:143]
    v_pk_add_f32 v[116:117], v[116:117], v[144:145]
    v_pk_add_f32 v[118:119], v[118:119], v[146:147]
    v_pk_add_f32 v[120:121], v[120:121], v[148:149]
    v_pk_add_f32 v[122:123], v[122:123], v[150:151]
    v_pk_add_f32 v[124:125], v[124:125], v[152:153]
    v_pk_add_f32 v[126:127], v[126:127], v[154:155]
    v_pk_add_f32 v[128:129], v[128:129], v[156:157]
    v_pk_add_f32 v[130:131], v[130:131], v[158:159]
    v_pk_add_f32 v[132:133], v[132:133], v[160:161]
    v_pk_add_f32 v[134:135], v[134:135], v[162:163]
    v_pk_add_f32 v[136:137], v[136:137], v[164:165]
    v_pk_add_f32 v[138:139], v[138:139], v[166:167]
    v_pk_add_f32 v[56:57], v[56:57], v[112:113]
    v_pk_add_f32 v[58:59], v[58:59], v[114:115]
    v_pk_add_f32 v[60:61], v[60:61], v[116:117]
    v_pk_add_f32 v[62:63], v[62:63], v[118:119]
    v_pk_add_f32 v[64:65], v[64:65], v[120:121]
    buffer_load_dwordx4 v1, s[24:27], s92 offen offset:1024  lds
    v_pk_add_f32 v[66:67], v[66:67], v[122:123]
    v_pk_add_f32 v[68:69], v[68:69], v[124:125]
    v_pk_add_f32 v[70:71], v[70:71], v[126:127]
    v_pk_add_f32 v[72:73], v[72:73], v[128:129]
    v_pk_add_f32 v[74:75], v[74:75], v[130:131]
    v_pk_add_f32 v[76:77], v[76:77], v[132:133]
    v_pk_add_f32 v[78:79], v[78:79], v[134:135]
    v_pk_add_f32 v[80:81], v[80:81], v[136:137]
    v_pk_add_f32 v[82:83], v[82:83], v[138:139]
    v_pk_fma_f32 v[184:185], v[56:57], v[242:243], v[184:185] op_sel_hi:[1,0,1]
    v_pk_fma_f32 v[186:187], v[58:59], v[242:243], v[186:187] op_sel_hi:[1,0,1]
    v_pk_fma_f32 v[188:189], v[60:61], v[242:243], v[188:189] op_sel_hi:[1,0,1]
    v_pk_fma_f32 v[190:191], v[62:63], v[242:243], v[190:191] op_sel_hi:[1,0,1]
    v_pk_fma_f32 v[192:193], v[64:65], v[242:243], v[192:193] op_sel_hi:[1,0,1]
    v_pk_fma_f32 v[194:195], v[66:67], v[242:243], v[194:195] op_sel_hi:[1,0,1]
    v_pk_fma_f32 v[196:197], v[68:69], v[242:243], v[196:197] op_sel_hi:[1,0,1]
    v_pk_fma_f32 v[198:199], v[70:71], v[242:243], v[198:199] op_sel_hi:[1,0,1]
    v_pk_fma_f32 v[200:201], v[72:73], v[242:243], v[200:201] op_sel_hi:[1,0,1]
    v_pk_fma_f32 v[202:203], v[74:75], v[242:243], v[202:203] op_sel_hi:[1,0,1]
    v_pk_fma_f32 v[204:205], v[76:77], v[242:243], v[204:205] op_sel_hi:[1,0,1]
    v_pk_fma_f32 v[206:207], v[78:79], v[242:243], v[206:207] op_sel_hi:[1,0,1]
    v_pk_fma_f32 v[208:209], v[80:81], v[242:243], v[208:209] op_sel_hi:[1,0,1]
    v_pk_fma_f32 v[210:211], v[82:83], v[242:243], v[210:211] op_sel_hi:[1,0,1]
    v_pk_mul_f32 v[40:41], v[184:185], v[184:185]
    v_pk_mul_f32 v[42:43], v[186:187], v[186:187]
    v_pk_mul_f32 v[44:45], v[188:189], v[188:189]
    v_pk_mul_f32 v[46:47], v[190:191], v[190:191]
    v_pk_fma_f32 v[40:41], v[40:41], v[240:241], v[240:241] op_sel:[0,0,1] op_sel_hi:[1,0,1]
    v_pk_fma_f32 v[42:43], v[42:43], v[240:241], v[240:241] op_sel:[0,0,1] op_sel_hi:[1,0,1]
    v_pk_fma_f32 v[44:45], v[44:45], v[240:241], v[240:241] op_sel:[0,0,1] op_sel_hi:[1,0,1]
    v_pk_fma_f32 v[46:47], v[46:47], v[240:241], v[240:241] op_sel:[0,0,1] op_sel_hi:[1,0,1]
    v_pk_mul_f32 v[40:41], v[40:41], v[184:185]
    v_pk_mul_f32 v[42:43], v[42:43], v[186:187]
    v_pk_mul_f32 v[44:45], v[44:45], v[188:189]
    v_pk_mul_f32 v[46:47], v[46:47], v[190:191]
    v_exp_f32 v40, v40
    buffer_load_dwordx4 v1, s[24:27], s92 offen offset:2048  lds
    v_exp_f32 v41, v41
    v_exp_f32 v42, v42
    v_exp_f32 v43, v43
    v_exp_f32 v44, v44
    v_exp_f32 v45, v45
    v_exp_f32 v46, v46
    v_exp_f32 v47, v47
    v_pk_fma_f32 v[40:41], v[40:41], v[242:243], v[242:243] op_sel:[0,1,1] op_sel_hi:[1,1,1]
    v_pk_fma_f32 v[42:43], v[42:43], v[242:243], v[242:243] op_sel:[0,1,1] op_sel_hi:[1,1,1]
    v_pk_fma_f32 v[44:45], v[44:45], v[242:243], v[242:243] op_sel:[0,1,1] op_sel_hi:[1,1,1]
    v_pk_fma_f32 v[46:47], v[46:47], v[242:243], v[242:243] op_sel:[0,1,1] op_sel_hi:[1,1,1]
    v_rcp_f32 v40, v40
    v_rcp_f32 v41, v41
    v_rcp_f32 v42, v42
    v_rcp_f32 v43, v43
    v_rcp_f32 v44, v44
    v_rcp_f32 v45, v45
    v_rcp_f32 v46, v46
    v_rcp_f32 v47, v47
    v_pk_mul_f32 v[40:41], v[40:41], v[184:185]
    v_pk_mul_f32 v[42:43], v[42:43], v[186:187]
    buffer_load_dwordx4 v1, s[24:27], s92 offen offset:3072  lds
    v_pk_mul_f32 v[44:45], v[44:45], v[188:189]
    v_pk_mul_f32 v[46:47], v[46:47], v[190:191]
    v_cvt_pk_bf16_f32 v88, v40, v41
    v_cvt_pk_bf16_f32 v89, v42, v43
    v_cvt_pk_bf16_f32 v90, v44, v45
    v_cvt_pk_bf16_f32 v91, v46, v47
    buffer_store_dwordx4 v[88:91], v1, s[12:15], s100 offen offset:0 sc1
    v_pk_mul_f32 v[40:41], v[192:193], v[192:193]
    v_pk_mul_f32 v[42:43], v[194:195], v[194:195]
    v_pk_mul_f32 v[44:45], v[196:197], v[196:197]
    v_pk_mul_f32 v[46:47], v[198:199], v[198:199]
    v_pk_fma_f32 v[40:41], v[40:41], v[240:241], v[240:241] op_sel:[0,0,1] op_sel_hi:[1,0,1]
    v_pk_fma_f32 v[42:43], v[42:43], v[240:241], v[240:241] op_sel:[0,0,1] op_sel_hi:[1,0,1]
    v_pk_fma_f32 v[44:45], v[44:45], v[240:241], v[240:241] op_sel:[0,0,1] op_sel_hi:[1,0,1]
    v_pk_fma_f32 v[46:47], v[46:47], v[240:241], v[240:241] op_sel:[0,0,1] op_sel_hi:[1,0,1]
    v_pk_mul_f32 v[40:41], v[40:41], v[192:193]
    v_pk_mul_f32 v[42:43], v[42:43], v[194:195]
    v_pk_mul_f32 v[44:45], v[44:45], v[196:197]
    v_pk_mul_f32 v[46:47], v[46:47], v[198:199]
    v_exp_f32 v40, v40
    v_exp_f32 v41, v41
    v_exp_f32 v42, v42
    v_exp_f32 v43, v43
    v_exp_f32 v44, v44
    v_exp_f32 v45, v45
    v_exp_f32 v46, v46
    v_exp_f32 v47, v47
    s_add_u32 m0, s95, 4352
    v_pk_fma_f32 v[40:41], v[40:41], v[242:243], v[242:243] op_sel:[0,1,1] op_sel_hi:[1,1,1]
    buffer_load_dwordx4 v1, s[20:23], s94 offen offset:0 sc1 lds
    v_pk_fma_f32 v[42:43], v[42:43], v[242:243], v[242:243] op_sel:[0,1,1] op_sel_hi:[1,1,1]
    v_pk_fma_f32 v[44:45], v[44:45], v[242:243], v[242:243] op_sel:[0,1,1] op_sel_hi:[1,1,1]
    v_pk_fma_f32 v[46:47], v[46:47], v[242:243], v[242:243] op_sel:[0,1,1] op_sel_hi:[1,1,1]
    v_rcp_f32 v40, v40
    v_rcp_f32 v41, v41
    v_rcp_f32 v42, v42
    v_rcp_f32 v43, v43
    v_rcp_f32 v44, v44
    v_rcp_f32 v45, v45
    v_rcp_f32 v46, v46
    v_rcp_f32 v47, v47
    v_pk_mul_f32 v[40:41], v[40:41], v[192:193]
    v_pk_mul_f32 v[42:43], v[42:43], v[194:195]
    v_pk_mul_f32 v[44:45], v[44:45], v[196:197]
    v_pk_mul_f32 v[46:47], v[46:47], v[198:199]
    v_cvt_pk_bf16_f32 v92, v40, v41
    v_cvt_pk_bf16_f32 v93, v42, v43
    v_cvt_pk_bf16_f32 v94, v44, v45
    v_cvt_pk_bf16_f32 v95, v46, v47
    buffer_store_dwordx4 v[92:95], v1, s[12:15], s100 offen offset:1024 sc1
    v_pk_mul_f32 v[40:41], v[200:201], v[200:201]
    v_pk_mul_f32 v[42:43], v[202:203], v[202:203]
    v_pk_mul_f32 v[44:45], v[204:205], v[204:205]
    v_pk_mul_f32 v[46:47], v[206:207], v[206:207]
    v_pk_fma_f32 v[40:41], v[40:41], v[240:241], v[240:241] op_sel:[0,0,1] op_sel_hi:[1,0,1]
    v_pk_fma_f32 v[42:43], v[42:43], v[240:241], v[240:241] op_sel:[0,0,1] op_sel_hi:[1,0,1]
    v_pk_fma_f32 v[44:45], v[44:45], v[240:241], v[240:241] op_sel:[0,0,1] op_sel_hi:[1,0,1]
    v_pk_fma_f32 v[46:47], v[46:47], v[240:241], v[240:241] op_sel:[0,0,1] op_sel_hi:[1,0,1]
    buffer_load_dwordx4 v1, s[20:23], s94 offen offset:1024 sc1 lds
    v_pk_mul_f32 v[40:41], v[40:41], v[200:201]
    v_pk_mul_f32 v[42:43], v[42:43], v[202:203]
    v_pk_mul_f32 v[44:45], v[44:45], v[204:205]
    v_pk_mul_f32 v[46:47], v[46:47], v[206:207]
    v_exp_f32 v40, v40
    v_exp_f32 v41, v41
    v_exp_f32 v42, v42
    v_exp_f32 v43, v43
    v_exp_f32 v44, v44
    v_exp_f32 v45, v45
    v_exp_f32 v46, v46
    v_exp_f32 v47, v47
    v_pk_fma_f32 v[40:41], v[40:41], v[242:243], v[242:243] op_sel:[0,1,1] op_sel_hi:[1,1,1]
    v_pk_fma_f32 v[42:43], v[42:43], v[242:243], v[242:243] op_sel:[0,1,1] op_sel_hi:[1,1,1]
    v_pk_fma_f32 v[44:45], v[44:45], v[242:243], v[242:243] op_sel:[0,1,1] op_sel_hi:[1,1,1]
    v_pk_fma_f32 v[46:47], v[46:47], v[242:243], v[242:243] op_sel:[0,1,1] op_sel_hi:[1,1,1]
    v_rcp_f32 v40, v40
    v_rcp_f32 v41, v41
    v_rcp_f32 v42, v42
    v_rcp_f32 v43, v43
    v_rcp_f32 v44, v44
    v_rcp_f32 v45, v45
    v_rcp_f32 v46, v46
    buffer_load_dwordx4 v1, s[20:23], s94 offen offset:2048 sc1 lds
    v_rcp_f32 v47, v47
    v_pk_mul_f32 v[40:41], v[40:41], v[200:201]
    v_pk_mul_f32 v[42:43], v[42:43], v[202:203]
    v_pk_mul_f32 v[44:45], v[44:45], v[204:205]
    v_pk_mul_f32 v[46:47], v[46:47], v[206:207]
    v_cvt_pk_bf16_f32 v96, v40, v41
    v_cvt_pk_bf16_f32 v97, v42, v43
    v_cvt_pk_bf16_f32 v98, v44, v45
    v_cvt_pk_bf16_f32 v99, v46, v47
    buffer_store_dwordx4 v[96:99], v1, s[12:15], s100 offen offset:2048 sc1
    v_pk_mul_f32 v[40:41], v[208:209], v[208:209]
    v_pk_mul_f32 v[42:43], v[210:211], v[210:211]
    v_pk_fma_f32 v[40:41], v[40:41], v[240:241], v[240:241] op_sel:[0,0,1] op_sel_hi:[1,0,1]
    v_pk_fma_f32 v[42:43], v[42:43], v[240:241], v[240:241] op_sel:[0,0,1] op_sel_hi:[1,0,1]
    v_pk_mul_f32 v[40:41], v[40:41], v[208:209]
    v_pk_mul_f32 v[42:43], v[42:43], v[210:211]
    v_exp_f32 v40, v40
    v_exp_f32 v41, v41
    v_exp_f32 v42, v42
    v_exp_f32 v43, v43
    v_pk_fma_f32 v[40:41], v[40:41], v[242:243], v[242:243] op_sel:[0,1,1] op_sel_hi:[1,1,1]
    v_pk_fma_f32 v[42:43], v[42:43], v[242:243], v[242:243] op_sel:[0,1,1] op_sel_hi:[1,1,1]
    v_rcp_f32 v40, v40
    v_rcp_f32 v41, v41
    v_rcp_f32 v42, v42
    v_rcp_f32 v43, v43
    v_pk_mul_f32 v[40:41], v[40:41], v[208:209]
    buffer_load_dwordx4 v1, s[20:23], s94 offen offset:3072 sc1 lds
    v_pk_mul_f32 v[42:43], v[42:43], v[210:211]
    v_cvt_pk_bf16_f32 v100, v40, v41
    v_cvt_pk_bf16_f32 v101, v42, v43
    buffer_store_dwordx2 v[100:101], v3, s[12:15], s100 offen offset:1024 sc1
    v_pk_fma_f32 v[212:213], v[56:57], v[246:247], v[212:213] op_sel_hi:[1,0,1]
    v_pk_fma_f32 v[214:215], v[58:59], v[246:247], v[214:215] op_sel_hi:[1,0,1]
    v_pk_fma_f32 v[216:217], v[60:61], v[246:247], v[216:217] op_sel_hi:[1,0,1]
    v_pk_fma_f32 v[218:219], v[62:63], v[246:247], v[218:219] op_sel_hi:[1,0,1]
    v_pk_fma_f32 v[220:221], v[64:65], v[246:247], v[220:221] op_sel_hi:[1,0,1]
    v_pk_fma_f32 v[222:223], v[66:67], v[246:247], v[222:223] op_sel_hi:[1,0,1]
    v_pk_fma_f32 v[224:225], v[68:69], v[246:247], v[224:225] op_sel_hi:[1,0,1]
    v_pk_fma_f32 v[226:227], v[70:71], v[246:247], v[226:227] op_sel_hi:[1,0,1]
    v_pk_fma_f32 v[228:229], v[72:73], v[246:247], v[228:229] op_sel_hi:[1,0,1]
    v_pk_fma_f32 v[230:231], v[74:75], v[246:247], v[230:231] op_sel_hi:[1,0,1]
    v_pk_fma_f32 v[232:233], v[76:77], v[246:247], v[232:233] op_sel_hi:[1,0,1]
    v_pk_fma_f32 v[234:235], v[78:79], v[246:247], v[234:235] op_sel_hi:[1,0,1]
    v_pk_fma_f32 v[236:237], v[80:81], v[246:247], v[236:237] op_sel_hi:[1,0,1]
    v_pk_fma_f32 v[238:239], v[82:83], v[246:247], v[238:239] op_sel_hi:[1,0,1]
    v_pk_mul_f32 v[40:41], v[212:213], v[212:213]
    v_pk_mul_f32 v[42:43], v[214:215], v[214:215]
    v_pk_mul_f32 v[44:45], v[216:217], v[216:217]
    v_pk_mul_f32 v[46:47], v[218:219], v[218:219]
    v_pk_fma_f32 v[40:41], v[40:41], v[244:245], v[244:245] op_sel:[0,0,1] op_sel_hi:[1,0,1]
    v_pk_fma_f32 v[42:43], v[42:43], v[244:245], v[244:245] op_sel:[0,0,1] op_sel_hi:[1,0,1]
    v_pk_fma_f32 v[44:45], v[44:45], v[244:245], v[244:245] op_sel:[0,0,1] op_sel_hi:[1,0,1]
    v_pk_fma_f32 v[46:47], v[46:47], v[244:245], v[244:245] op_sel:[0,0,1] op_sel_hi:[1,0,1]
    v_pk_mul_f32 v[40:41], v[40:41], v[212:213]
    v_pk_mul_f32 v[42:43], v[42:43], v[214:215]
    v_pk_mul_f32 v[44:45], v[44:45], v[216:217]
    v_pk_mul_f32 v[46:47], v[46:47], v[218:219]
    v_exp_f32 v40, v40
    v_exp_f32 v41, v41
    s_add_u32 m0, s95, 8992
    v_exp_f32 v42, v42
    buffer_load_dwordx4 v169, s[20:23], s94 offen offset:0 sc1 lds
    v_exp_f32 v43, v43
    v_exp_f32 v44, v44
    v_exp_f32 v45, v45
    v_exp_f32 v46, v46
    v_exp_f32 v47, v47
    v_pk_fma_f32 v[40:41], v[40:41], v[246:247], v[246:247] op_sel:[0,1,1] op_sel_hi:[1,1,1]
    v_pk_fma_f32 v[42:43], v[42:43], v[246:247], v[246:247] op_sel:[0,1,1] op_sel_hi:[1,1,1]
    v_pk_fma_f32 v[44:45], v[44:45], v[246:247], v[246:247] op_sel:[0,1,1] op_sel_hi:[1,1,1]
    v_pk_fma_f32 v[46:47], v[46:47], v[246:247], v[246:247] op_sel:[0,1,1] op_sel_hi:[1,1,1]
    v_rcp_f32 v40, v40
    v_rcp_f32 v41, v41
    v_rcp_f32 v42, v42
    v_rcp_f32 v43, v43
    v_rcp_f32 v44, v44
    v_rcp_f32 v45, v45
    v_rcp_f32 v46, v46
    v_rcp_f32 v47, v47
    v_pk_mul_f32 v[40:41], v[40:41], v[212:213]
    v_pk_mul_f32 v[42:43], v[42:43], v[214:215]
    v_pk_mul_f32 v[44:45], v[44:45], v[216:217]
    v_pk_mul_f32 v[46:47], v[46:47], v[218:219]
    v_cvt_pk_bf16_f32 v104, v40, v41
    buffer_load_dwordx4 v169, s[20:23], s94 offen offset:1024 sc1 lds
    v_cvt_pk_bf16_f32 v105, v42, v43
    v_cvt_pk_bf16_f32 v106, v44, v45
    v_cvt_pk_bf16_f32 v107, v46, v47
    buffer_store_dwordx4 v[104:107], v1, s[12:15], s101 offen offset:0 sc1
    v_pk_mul_f32 v[40:41], v[220:221], v[220:221]
    v_pk_mul_f32 v[42:43], v[222:223], v[222:223]
    v_pk_mul_f32 v[44:45], v[224:225], v[224:225]
    v_pk_mul_f32 v[46:47], v[226:227], v[226:227]
    v_pk_fma_f32 v[40:41], v[40:41], v[244:245], v[244:245] op_sel:[0,0,1] op_sel_hi:[1,0,1]
    v_pk_fma_f32 v[42:43], v[42:43], v[244:245], v[244:245] op_sel:[0,0,1] op_sel_hi:[1,0,1]
    v_pk_fma_f32 v[44:45], v[44:45], v[244:245], v[244:245] op_sel:[0,0,1] op_sel_hi:[1,0,1]
    v_pk_fma_f32 v[46:47], v[46:47], v[244:245], v[244:245] op_sel:[0,0,1] op_sel_hi:[1,0,1]
    v_pk_mul_f32 v[40:41], v[40:41], v[220:221]
    v_pk_mul_f32 v[42:43], v[42:43], v[222:223]
    v_pk_mul_f32 v[44:45], v[44:45], v[224:225]
    v_pk_mul_f32 v[46:47], v[46:47], v[226:227]
    v_exp_f32 v40, v40
    v_exp_f32 v41, v41
    v_exp_f32 v42, v42
    v_exp_f32 v43, v43
    v_exp_f32 v44, v44
    v_exp_f32 v45, v45
    v_exp_f32 v46, v46
    v_exp_f32 v47, v47
    v_pk_fma_f32 v[40:41], v[40:41], v[246:247], v[246:247] op_sel:[0,1,1] op_sel_hi:[1,1,1]
    v_pk_fma_f32 v[42:43], v[42:43], v[246:247], v[246:247] op_sel:[0,1,1] op_sel_hi:[1,1,1]
    v_pk_fma_f32 v[44:45], v[44:45], v[246:247], v[246:247] op_sel:[0,1,1] op_sel_hi:[1,1,1]
    v_pk_fma_f32 v[46:47], v[46:47], v[246:247], v[246:247] op_sel:[0,1,1] op_sel_hi:[1,1,1]
    buffer_load_dwordx4 v169, s[20:23], s94 offen offset:2048 sc1 lds
    v_rcp_f32 v40, v40
    v_rcp_f32 v41, v41
    v_rcp_f32 v42, v42
    v_rcp_f32 v43, v43
    v_rcp_f32 v44, v44
    v_rcp_f32 v45, v45
    v_rcp_f32 v46, v46
    v_rcp_f32 v47, v47
    v_pk_mul_f32 v[40:41], v[40:41], v[220:221]
    v_pk_mul_f32 v[42:43], v[42:43], v[222:223]
    v_pk_mul_f32 v[44:45], v[44:45], v[224:225]
    v_pk_mul_f32 v[46:47], v[46:47], v[226:227]
    v_cvt_pk_bf16_f32 v108, v40, v41
    v_cvt_pk_bf16_f32 v109, v42, v43
    v_cvt_pk_bf16_f32 v110, v44, v45
    v_cvt_pk_bf16_f32 v111, v46, v47
    buffer_store_dwordx4 v[108:111], v1, s[12:15], s101 offen offset:1024 sc1
    v_pk_mul_f32 v[40:41], v[228:229], v[228:229]
    v_pk_mul_f32 v[42:43], v[230:231], v[230:231]
    v_pk_mul_f32 v[44:45], v[232:233], v[232:233]
    v_pk_mul_f32 v[46:47], v[234:235], v[234:235]
    v_pk_fma_f32 v[40:41], v[40:41], v[244:245], v[244:245] op_sel:[0,0,1] op_sel_hi:[1,0,1]
    v_pk_fma_f32 v[42:43], v[42:43], v[244:245], v[244:245] op_sel:[0,0,1] op_sel_hi:[1,0,1]
    v_pk_fma_f32 v[44:45], v[44:45], v[244:245], v[244:245] op_sel:[0,0,1] op_sel_hi:[1,0,1]
    v_pk_fma_f32 v[46:47], v[46:47], v[244:245], v[244:245] op_sel:[0,0,1] op_sel_hi:[1,0,1]
    v_pk_mul_f32 v[40:41], v[40:41], v[228:229]
    v_pk_mul_f32 v[42:43], v[42:43], v[230:231]
    v_pk_mul_f32 v[44:45], v[44:45], v[232:233]
    v_pk_mul_f32 v[46:47], v[46:47], v[234:235]
    buffer_load_dwordx4 v169, s[20:23], s94 offen offset:3072 sc1 lds
    v_exp_f32 v40, v40
    v_exp_f32 v41, v41
    v_exp_f32 v42, v42
    v_exp_f32 v43, v43
    v_exp_f32 v44, v44
    v_exp_f32 v45, v45
    v_exp_f32 v46, v46
    v_exp_f32 v47, v47
    v_pk_fma_f32 v[40:41], v[40:41], v[246:247], v[246:247] op_sel:[0,1,1] op_sel_hi:[1,1,1]
    v_pk_fma_f32 v[42:43], v[42:43], v[246:247], v[246:247] op_sel:[0,1,1] op_sel_hi:[1,1,1]
    v_pk_fma_f32 v[44:45], v[44:45], v[246:247], v[246:247] op_sel:[0,1,1] op_sel_hi:[1,1,1]
    v_pk_fma_f32 v[46:47], v[46:47], v[246:247], v[246:247] op_sel:[0,1,1] op_sel_hi:[1,1,1]
    v_rcp_f32 v40, v40
    v_rcp_f32 v41, v41
    v_rcp_f32 v42, v42
    v_rcp_f32 v43, v43
    v_rcp_f32 v44, v44
    v_rcp_f32 v45, v45
    v_rcp_f32 v46, v46
    v_rcp_f32 v47, v47
    v_pk_mul_f32 v[40:41], v[40:41], v[228:229]
    v_pk_mul_f32 v[42:43], v[42:43], v[230:231]
    v_pk_mul_f32 v[44:45], v[44:45], v[232:233]
    v_pk_mul_f32 v[46:47], v[46:47], v[234:235]
    v_cvt_pk_bf16_f32 v112, v40, v41
    v_cvt_pk_bf16_f32 v113, v42, v43
    v_cvt_pk_bf16_f32 v114, v44, v45
    v_cvt_pk_bf16_f32 v115, v46, v47
    buffer_store_dwordx4 v[112:115], v1, s[12:15], s101 offen offset:2048 sc1
    v_pk_mul_f32 v[40:41], v[236:237], v[236:237]
    v_pk_mul_f32 v[42:43], v[238:239], v[238:239]
    v_pk_fma_f32 v[40:41], v[40:41], v[244:245], v[244:245] op_sel:[0,0,1] op_sel_hi:[1,0,1]
    v_pk_fma_f32 v[42:43], v[42:43], v[244:245], v[244:245] op_sel:[0,0,1] op_sel_hi:[1,0,1]
    v_pk_mul_f32 v[40:41], v[40:41], v[236:237]
    v_pk_mul_f32 v[42:43], v[42:43], v[238:239]
    v_exp_f32 v40, v40
    v_exp_f32 v41, v41
    v_exp_f32 v42, v42
    v_exp_f32 v43, v43
    v_pk_fma_f32 v[40:41], v[40:41], v[246:247], v[246:247] op_sel:[0,1,1] op_sel_hi:[1,1,1]
    v_pk_fma_f32 v[42:43], v[42:43], v[246:247], v[246:247] op_sel:[0,1,1] op_sel_hi:[1,1,1]
    v_rcp_f32 v40, v40
    v_rcp_f32 v41, v41
    v_rcp_f32 v42, v42
    v_rcp_f32 v43, v43
    v_pk_mul_f32 v[40:41], v[40:41], v[236:237]
    v_pk_mul_f32 v[42:43], v[42:43], v[238:239]
    v_cvt_pk_bf16_f32 v116, v40, v41
    v_cvt_pk_bf16_f32 v117, v42, v43
    buffer_store_dwordx2 v[116:117], v3, s[12:15], s101 offen offset:1024 sc1
    s_cmp_ge_u32 s81, 640
    s_cbranch_scc1 L_noconv_49
    v_add_u32 v156, 1024, v254
    v_add_u32 v157, 2048, v254
    v_add_u32 v158, 3072, v254
    s_waitcnt vmcnt(2)
    v_lshlrev_b32 v174, 16, v172
    v_lshlrev_b32 v173, 16, v173
    v_add_f32 v174, v174, v173
    v_and_b32 v175, s73, v172
    v_cvt_pk_bf16_f32 v174, v174, v175
    v_mov_b32 v152, s95
    s_mov_b64 exec, 1
    ds_write_b32 v152, v174 offset:64
    ds_write_b16 v152, v38 offset:13086
    s_mov_b64 exec, -1
    ds_read_b128 v[72:75], v255 offset:3584
    ds_read_b128 v[76:79], v255 offset:3072
    ds_read_b128 v[80:83], v255 offset:2560
    ds_read_b128 v[84:87], v255 offset:2048
    ds_read_b128 v[88:91], v255 offset:1536
    ds_read_b128 v[92:95], v255 offset:1024
    ds_read_b128 v[96:99], v255 offset:512
    ds_read_b128 v[100:103], v255 offset:0
    ds_read2_b32 v[136:137], v254 offset0:0 offset1:1
    ds_read2_b32 v[138:139], v254 offset0:2 offset1:3
    ds_read2_b32 v[140:141], v158 offset0:128 offset1:129
    ds_read2_b32 v[142:143], v158 offset0:130 offset1:131
    s_waitcnt lgkmcnt(0)
    v_mfma_f32_16x16x32_bf16 v[40:43], v[72:75], v[136:139], 0
    s_lshr_b32 s76, s64, 1
    ds_read2_b32 v[144:145], v254 offset0:128 offset1:129
    v_mfma_f32_16x16x32_bf16 v[44:47], v[76:79], v[136:139], 0
    s_lshl_b32 s77, s97, 1
    ds_read2_b32 v[146:147], v254 offset0:130 offset1:131
    v_mfma_f32_16x16x32_bf16 v[48:51], v[80:83], v[136:139], 0
    s_add_u32 s76, s76, s77
    ds_read2_b32 v[148:149], v158 offset0:0 offset1:1
    v_mfma_f32_16x16x32_bf16 v[52:55], v[84:87], v[136:139], 0
    s_lshl_b32 s76, s76, 2
    ds_read2_b32 v[150:151], v158 offset0:2 offset1:3
    v_mfma_f32_16x16x32_bf16 v[56:59], v[88:91], v[136:139], 0
    s_lshr_b32 s77, s96, 2
    ds_read_b128 v[104:107], v255 offset:3648
    v_mfma_f32_16x16x32_bf16 v[60:63], v[92:95], v[136:139], 0
    s_add_u32 s76, s76, s77
    ds_read_b128 v[108:111], v255 offset:3136
    v_mfma_f32_16x16x32_bf16 v[64:67], v[96:99], v[136:139], 0
    buffer_load_dwordx4 a[40:43], v1, s[12:15], s99 offen offset:2048 sc1
    v_mfma_f32_16x16x32_bf16 v[68:71], v[100:103], v[136:139], 0
    s_lshl_b32 s76, s76, 7
    s_and_b32 s77, s96, 3
    v_mfma_f32_16x16x32_bf16 v[68:71], v[72:75], v[140:143], v[68:71]
    buffer_load_dwordx4 a[44:47], v1, s[12:15], s99 offen offset:3072 sc1
    s_waitcnt lgkmcnt(2)
    v_mfma_f32_16x16x32_bf16 v[44:47], v[72:75], v[144:147], v[44:47]
    s_lshl_b32 s77, s77, 1
    ds_read2_b32 v[136:137], v156 offset0:0 offset1:1
    v_mfma_f32_16x16x32_bf16 v[48:51], v[76:79], v[144:147], v[48:51]
    s_and_b32 s78, s64, 1
    ds_read2_b32 v[138:139], v156 offset0:2 offset1:3
    v_mfma_f32_16x16x32_bf16 v[52:55], v[80:83], v[144:147], v[52:55]
    s_add_u32 s77, s77, s78
    ds_read2_b32 v[140:141], v157 offset0:128 offset1:129
    v_mfma_f32_16x16x32_bf16 v[56:59], v[84:87], v[144:147], v[56:59]
    s_lshl_b32 s77, s77, 2
    ds_read2_b32 v[142:143], v157 offset0:130 offset1:131
    v_mfma_f32_16x16x32_bf16 v[60:63], v[88:91], v[144:147], v[60:63]
    s_add_u32 s76, s76, s77
    ds_read_b128 v[112:115], v255 offset:2624
    v_mfma_f32_16x16x32_bf16 v[64:67], v[92:95], v[144:147], v[64:67]
    s_add_u32 s101, s76, 32768
    ds_read_b128 v[116:119], v255 offset:2112
    s_add_u32 s99, s99, 4096
    v_mfma_f32_16x16x32_bf16 v[68:71], v[96:99], v[144:147], v[68:71]
    buffer_load_dwordx4 a[48:51], v1, s[12:15], s99 offen offset:0 sc1
    v_mfma_f32_16x16x32_bf16 v[64:67], v[72:75], v[148:151], v[64:67]
    s_add_u32 s100, s98, 32768
    v_and_b32 v35, 7, v0
    v_mfma_f32_16x16x32_bf16 v[68:71], v[76:79], v[148:151], v[68:71]
    buffer_load_dwordx4 a[52:55], v1, s[12:15], s99 offen offset:1024 sc1
    s_waitcnt lgkmcnt(2)
    v_mfma_f32_16x16x32_bf16 v[48:51], v[72:75], v[136:139], v[48:51]
    v_lshlrev_b32 v35, 2, v35
    ds_read2_b32 v[144:145], v156 offset0:128 offset1:129
    v_mfma_f32_16x16x32_bf16 v[52:55], v[76:79], v[136:139], v[52:55]
    s_add_u32 s76, s64, 0
    ds_read2_b32 v[146:147], v156 offset0:130 offset1:131
    v_mfma_f32_16x16x32_bf16 v[56:59], v[80:83], v[136:139], v[56:59]
    s_and_b32 s76, s76, 3
    ds_read2_b32 v[148:149], v157 offset0:0 offset1:1
    v_mfma_f32_16x16x32_bf16 v[60:63], v[84:87], v[136:139], v[60:63]
    s_lshl_b32 s77, s65, 2
    ds_read2_b32 v[150:151], v157 offset0:2 offset1:3
    v_mfma_f32_16x16x32_bf16 v[64:67], v[88:91], v[136:139], v[64:67]
    s_add_u32 s76, s76, s77
    ds_read_b128 v[120:123], v255 offset:1600
    v_mfma_f32_16x16x32_bf16 v[68:71], v[92:95], v[136:139], v[68:71]
    s_lshl_b32 s76, s76, 2
    ds_read_b128 v[124:127], v255 offset:1088
    v_mfma_f32_16x16x32_bf16 v[60:63], v[72:75], v[140:143], v[60:63]
    buffer_load_dwordx4 a[56:59], v1, s[12:15], s99 offen offset:2048 sc1
    v_mfma_f32_16x16x32_bf16 v[64:67], v[76:79], v[140:143], v[64:67]
    s_add_u32 s76, s76, s64
    s_mul_i32 s76, s76, 14336
    v_mfma_f32_16x16x32_bf16 v[68:71], v[80:83], v[140:143], v[68:71]
    buffer_load_dwordx4 a[60:63], v1, s[12:15], s99 offen offset:3072 sc1
    s_waitcnt lgkmcnt(2)
    v_mfma_f32_16x16x32_bf16 v[52:55], v[72:75], v[144:147], v[52:55]
    s_add_u32 s36, s76, 5570560
    ds_read2_b32 v[136:137], v254 offset0:16 offset1:17
    v_mfma_f32_16x16x32_bf16 v[56:59], v[76:79], v[144:147], v[56:59]
    s_add_u32 s76, s64, 1
    ds_read2_b32 v[138:139], v254 offset0:18 offset1:19
    v_mfma_f32_16x16x32_bf16 v[60:63], v[80:83], v[144:147], v[60:63]
    s_and_b32 s76, s76, 3
    ds_read2_b32 v[140:141], v158 offset0:144 offset1:145
    v_mfma_f32_16x16x32_bf16 v[64:67], v[84:87], v[144:147], v[64:67]
    s_lshl_b32 s77, s65, 2
    ds_read2_b32 v[142:143], v158 offset0:146 offset1:147
    v_mfma_f32_16x16x32_bf16 v[68:71], v[88:91], v[144:147], v[68:71]
    s_add_u32 s76, s76, s77
    ds_read_b128 v[128:131], v255 offset:576
    v_mfma_f32_16x16x32_bf16 v[56:59], v[72:75], v[148:151], v[56:59]
    s_lshl_b32 s76, s76, 2
    ds_read_b128 v[132:135], v255 offset:64
    s_add_u32 s99, s99, 4096
    v_mfma_f32_16x16x32_bf16 v[60:63], v[76:79], v[148:151], v[60:63]
    buffer_load_dwordx4 a[64:67], v1, s[12:15], s99 offen offset:0 sc1
    v_mfma_f32_16x16x32_bf16 v[64:67], v[80:83], v[148:151], v[64:67]
    s_add_u32 s76, s76, s64
    s_mul_i32 s76, s76, 14336
    v_mfma_f32_16x16x32_bf16 v[68:71], v[84:87], v[148:151], v[68:71]
    buffer_load_dwordx4 a[68:71], v1, s[12:15], s99 offen offset:1024 sc1
    s_waitcnt lgkmcnt(2)
    v_mfma_f32_16x16x32_bf16 v[40:43], v[104:107], v[136:139], v[40:43]
    s_add_u32 s37, s76, 5570560
    ds_read2_b32 v[144:145], v254 offset0:144 offset1:145
    v_mfma_f32_16x16x32_bf16 v[44:47], v[108:111], v[136:139], v[44:47]
    s_add_u32 s76, s64, 2
    ds_read2_b32 v[146:147], v254 offset0:146 offset1:147
    v_mfma_f32_16x16x32_bf16 v[48:51], v[112:115], v[136:139], v[48:51]
    s_and_b32 s76, s76, 3
    ds_read2_b32 v[148:149], v158 offset0:16 offset1:17
    v_mfma_f32_16x16x32_bf16 v[52:55], v[116:119], v[136:139], v[52:55]
    s_lshl_b32 s77, s65, 2
    ds_read2_b32 v[150:151], v158 offset0:18 offset1:19
    v_mfma_f32_16x16x32_bf16 v[56:59], v[120:123], v[136:139], v[56:59]
    s_add_u32 s76, s76, s77
    ds_read_b128 v[72:75], v255 offset:3712
    v_mfma_f32_16x16x32_bf16 v[60:63], v[124:127], v[136:139], v[60:63]
    s_lshl_b32 s76, s76, 2
    ds_read_b128 v[76:79], v255 offset:3200
    s_waitcnt lgkmcnt(6)
    v_mfma_f32_16x16x32_bf16 v[64:67], v[128:131], v[136:139], v[64:67]
    buffer_load_dwordx4 a[72:75], v1, s[12:15], s99 offen offset:2048 sc1
    v_mfma_f32_16x16x32_bf16 v[68:71], v[132:135], v[136:139], v[68:71]
    s_add_u32 s76, s76, s64
    s_mul_i32 s76, s76, 14336
    v_mfma_f32_16x16x32_bf16 v[68:71], v[104:107], v[140:143], v[68:71]
    buffer_load_dwordx4 a[76:79], v1, s[12:15], s99 offen offset:3072 sc1
    s_waitcnt vmcnt(10)
    s_mov_b64 exec, 1
    buffer_store_dword v34, v38, s[12:15], s101 offen sc1
    s_mov_b64 exec, -1
    s_waitcnt lgkmcnt(2)
    v_mfma_f32_16x16x32_bf16 v[44:47], v[104:107], v[144:147], v[44:47]
    s_add_u32 s38, s76, 5570560
    ds_read2_b32 v[136:137], v156 offset0:16 offset1:17
    v_mfma_f32_16x16x32_bf16 v[48:51], v[108:111], v[144:147], v[48:51]
    s_add_u32 s76, s64, 3
    ds_read2_b32 v[138:139], v156 offset0:18 offset1:19
    v_mfma_f32_16x16x32_bf16 v[52:55], v[112:115], v[144:147], v[52:55]
    s_and_b32 s76, s76, 3
    ds_read2_b32 v[140:141], v157 offset0:144 offset1:145
    v_mfma_f32_16x16x32_bf16 v[56:59], v[116:119], v[144:147], v[56:59]
    s_lshl_b32 s77, s65, 2
    ds_read2_b32 v[142:143], v157 offset0:146 offset1:147
    v_mfma_f32_16x16x32_bf16 v[60:63], v[120:123], v[144:147], v[60:63]
    s_add_u32 s76, s76, s77
    ds_read_b128 v[80:83], v255 offset:2688
    v_mfma_f32_16x16x32_bf16 v[64:67], v[124:127], v[144:147], v[64:67]
    s_lshl_b32 s76, s76, 2
    ds_read_b128 v[84:87], v255 offset:2176
    s_add_u32 s99, s99, 4096
    v_mfma_f32_16x16x32_bf16 v[68:71], v[128:131], v[144:147], v[68:71]
    buffer_load_dwordx4 a[80:83], v1, s[12:15], s99 offen offset:0 sc1
    v_mfma_f32_16x16x32_bf16 v[64:67], v[104:107], v[148:151], v[64:67]
    s_add_u32 s76, s76, s64
    s_mul_i32 s76, s76, 14336
    v_mfma_f32_16x16x32_bf16 v[68:71], v[108:111], v[148:151], v[68:71]
    buffer_load_dwordx4 a[84:87], v1, s[12:15], s99 offen offset:1024 sc1
    s_waitcnt lgkmcnt(2)
    v_mfma_f32_16x16x32_bf16 v[48:51], v[104:107], v[136:139], v[48:51]
    s_add_u32 s39, s76, 5570560
    ds_read2_b32 v[144:145], v156 offset0:144 offset1:145
    v_mfma_f32_16x16x32_bf16 v[52:55], v[108:111], v[136:139], v[52:55]
    ds_read2_b32 v[146:147], v156 offset0:146 offset1:147
    v_mfma_f32_16x16x32_bf16 v[56:59], v[112:115], v[136:139], v[56:59]
    ds_read2_b32 v[148:149], v157 offset0:16 offset1:17
    v_mfma_f32_16x16x32_bf16 v[60:63], v[116:119], v[136:139], v[60:63]
    ds_read2_b32 v[150:151], v157 offset0:18 offset1:19
    v_mfma_f32_16x16x32_bf16 v[64:67], v[120:123], v[136:139], v[64:67]
    ds_read_b128 v[88:91], v255 offset:1664
    v_mfma_f32_16x16x32_bf16 v[68:71], v[124:127], v[136:139], v[68:71]
    ds_read_b128 v[92:95], v255 offset:1152
    v_mfma_f32_16x16x32_bf16 v[60:63], v[104:107], v[140:143], v[60:63]
    buffer_load_dwordx4 a[88:91], v1, s[12:15], s99 offen offset:2048 sc1
    v_mfma_f32_16x16x32_bf16 v[64:67], v[108:111], v[140:143], v[64:67]
    v_mfma_f32_16x16x32_bf16 v[68:71], v[112:115], v[140:143], v[68:71]
    buffer_load_dwordx4 a[92:95], v1, s[12:15], s99 offen offset:3072 sc1
    s_waitcnt lgkmcnt(2)
    v_mfma_f32_16x16x32_bf16 v[52:55], v[104:107], v[144:147], v[52:55]
    ds_read2_b32 v[136:137], v254 offset0:32 offset1:33
    v_mfma_f32_16x16x32_bf16 v[56:59], v[108:111], v[144:147], v[56:59]
    ds_read2_b32 v[138:139], v254 offset0:34 offset1:35
    v_mfma_f32_16x16x32_bf16 v[60:63], v[112:115], v[144:147], v[60:63]
    ds_read2_b32 v[140:141], v158 offset0:160 offset1:161
    v_mfma_f32_16x16x32_bf16 v[64:67], v[116:119], v[144:147], v[64:67]
    ds_read2_b32 v[142:143], v158 offset0:162 offset1:163
    v_mfma_f32_16x16x32_bf16 v[68:71], v[120:123], v[144:147], v[68:71]
    ds_read_b128 v[96:99], v255 offset:640
    v_mfma_f32_16x16x32_bf16 v[56:59], v[104:107], v[148:151], v[56:59]
    ds_read_b128 v[100:103], v255 offset:128
    s_add_u32 s99, s99, 4096
    v_mfma_f32_16x16x32_bf16 v[60:63], v[108:111], v[148:151], v[60:63]
    buffer_load_dwordx4 a[96:99], v1, s[12:15], s99 offen offset:0 sc1
    v_mfma_f32_16x16x32_bf16 v[64:67], v[112:115], v[148:151], v[64:67]
    v_mfma_f32_16x16x32_bf16 v[68:71], v[116:119], v[148:151], v[68:71]
    buffer_load_dwordx4 a[100:103], v1, s[12:15], s99 offen offset:1024 sc1
    s_waitcnt lgkmcnt(2)
    v_mfma_f32_16x16x32_bf16 v[40:43], v[72:75], v[136:139], v[40:43]
    ds_read2_b32 v[144:145], v254 offset0:160 offset1:161
    v_mfma_f32_16x16x32_bf16 v[44:47], v[76:79], v[136:139], v[44:47]
    ds_read2_b32 v[146:147], v254 offset0:162 offset1:163
    v_mfma_f32_16x16x32_bf16 v[48:51], v[80:83], v[136:139], v[48:51]
    ds_read2_b32 v[148:149], v158 offset0:32 offset1:33
    v_mfma_f32_16x16x32_bf16 v[52:55], v[84:87], v[136:139], v[52:55]
    ds_read2_b32 v[150:151], v158 offset0:34 offset1:35
    v_mfma_f32_16x16x32_bf16 v[56:59], v[88:91], v[136:139], v[56:59]
    ds_read_b128 v[104:107], v255 offset:3776
    v_mfma_f32_16x16x32_bf16 v[60:63], v[92:95], v[136:139], v[60:63]
    ds_read_b128 v[108:111], v255 offset:3264
    s_waitcnt lgkmcnt(6)
    v_mfma_f32_16x16x32_bf16 v[64:67], v[96:99], v[136:139], v[64:67]
    buffer_load_dwordx4 a[104:107], v1, s[12:15], s99 offen offset:2048 sc1
    v_mfma_f32_16x16x32_bf16 v[68:71], v[100:103], v[136:139], v[68:71]
    v_mfma_f32_16x16x32_bf16 v[68:71], v[72:75], v[140:143], v[68:71]
    buffer_load_dwordx4 a[108:111], v1, s[12:15], s99 offen offset:3072 sc1
    s_waitcnt lgkmcnt(2)
    v_mfma_f32_16x16x32_bf16 v[44:47], v[72:75], v[144:147], v[44:47]
    ds_read2_b32 v[136:137], v156 offset0:32 offset1:33
    v_mfma_f32_16x16x32_bf16 v[48:51], v[76:79], v[144:147], v[48:51]
    ds_read2_b32 v[138:139], v156 offset0:34 offset1:35
    v_mfma_f32_16x16x32_bf16 v[52:55], v[80:83], v[144:147], v[52:55]
    ds_read2_b32 v[140:141], v157 offset0:160 offset1:161
    v_mfma_f32_16x16x32_bf16 v[56:59], v[84:87], v[144:147], v[56:59]
    ds_read2_b32 v[142:143], v157 offset0:162 offset1:163
    v_mfma_f32_16x16x32_bf16 v[60:63], v[88:91], v[144:147], v[60:63]
    ds_read_b128 v[112:115], v255 offset:2752
    v_mfma_f32_16x16x32_bf16 v[64:67], v[92:95], v[144:147], v[64:67]
    ds_read_b128 v[116:119], v255 offset:2240
    s_add_u32 s99, s99, 4096
    v_mfma_f32_16x16x32_bf16 v[68:71], v[96:99], v[144:147], v[68:71]
    buffer_load_dwordx4 a[112:115], v1, s[12:15], s99 offen offset:0 sc1
    v_mfma_f32_16x16x32_bf16 v[64:67], v[72:75], v[148:151], v[64:67]
    v_mfma_f32_16x16x32_bf16 v[68:71], v[76:79], v[148:151], v[68:71]
    buffer_load_dwordx4 a[116:119], v1, s[12:15], s99 offen offset:1024 sc1
    s_waitcnt lgkmcnt(2)
    v_mfma_f32_16x16x32_bf16 v[48:51], v[72:75], v[136:139], v[48:51]
    ds_read2_b32 v[144:145], v156 offset0:160 offset1:161
    v_mfma_f32_16x16x32_bf16 v[52:55], v[76:79], v[136:139], v[52:55]
    ds_read2_b32 v[146:147], v156 offset0:162 offset1:163
    v_mfma_f32_16x16x32_bf16 v[56:59], v[80:83], v[136:139], v[56:59]
    ds_read2_b32 v[148:149], v157 offset0:32 offset1:33
    v_mfma_f32_16x16x32_bf16 v[60:63], v[84:87], v[136:139], v[60:63]
    ds_read2_b32 v[150:151], v157 offset0:34 offset1:35
    v_mfma_f32_16x16x32_bf16 v[64:67], v[88:91], v[136:139], v[64:67]
    ds_read_b128 v[120:123], v255 offset:1728
    v_mfma_f32_16x16x32_bf16 v[68:71], v[92:95], v[136:139], v[68:71]
    ds_read_b128 v[124:127], v255 offset:1216
    v_mfma_f32_16x16x32_bf16 v[60:63], v[72:75], v[140:143], v[60:63]
    buffer_load_dwordx4 a[120:123], v1, s[12:15], s99 offen offset:2048 sc1
    v_mfma_f32_16x16x32_bf16 v[64:67], v[76:79], v[140:143], v[64:67]
    v_mfma_f32_16x16x32_bf16 v[68:71], v[80:83], v[140:143], v[68:71]
    buffer_load_dwordx4 a[124:127], v1, s[12:15], s99 offen offset:3072 sc1
    s_waitcnt lgkmcnt(2)
    v_mfma_f32_16x16x32_bf16 v[52:55], v[72:75], v[144:147], v[52:55]
    ds_read2_b32 v[136:137], v254 offset0:48 offset1:49
    v_mfma_f32_16x16x32_bf16 v[56:59], v[76:79], v[144:147], v[56:59]
    ds_read2_b32 v[138:139], v254 offset0:50 offset1:51
    v_mfma_f32_16x16x32_bf16 v[60:63], v[80:83], v[144:147], v[60:63]
    ds_read2_b32 v[140:141], v158 offset0:176 offset1:177
    v_mfma_f32_16x16x32_bf16 v[64:67], v[84:87], v[144:147], v[64:67]
    ds_read2_b32 v[142:143], v158 offset0:178 offset1:179
    v_mfma_f32_16x16x32_bf16 v[68:71], v[88:91], v[144:147], v[68:71]
    ds_read_b128 v[128:131], v255 offset:704
    v_mfma_f32_16x16x32_bf16 v[56:59], v[72:75], v[148:151], v[56:59]
    ds_read_b128 v[132:135], v255 offset:192
    s_add_u32 s99, s99, 4096
    v_mfma_f32_16x16x32_bf16 v[60:63], v[76:79], v[148:151], v[60:63]
    buffer_load_dwordx4 a[128:131], v1, s[12:15], s99 offen offset:0 sc1
    v_mfma_f32_16x16x32_bf16 v[64:67], v[80:83], v[148:151], v[64:67]
    v_mfma_f32_16x16x32_bf16 v[68:71], v[84:87], v[148:151], v[68:71]
    buffer_load_dwordx4 a[132:135], v1, s[12:15], s99 offen offset:1024 sc1
    s_waitcnt lgkmcnt(2)
    v_mfma_f32_16x16x32_bf16 v[40:43], v[104:107], v[136:139], v[40:43]
    ds_read2_b32 v[144:145], v254 offset0:176 offset1:177
    v_mfma_f32_16x16x32_bf16 v[44:47], v[108:111], v[136:139], v[44:47]
    ds_read2_b32 v[146:147], v254 offset0:178 offset1:179
    v_mfma_f32_16x16x32_bf16 v[48:51], v[112:115], v[136:139], v[48:51]
    ds_read2_b32 v[148:149], v158 offset0:48 offset1:49
    v_mfma_f32_16x16x32_bf16 v[52:55], v[116:119], v[136:139], v[52:55]
    ds_read2_b32 v[150:151], v158 offset0:50 offset1:51
    v_mfma_f32_16x16x32_bf16 v[56:59], v[120:123], v[136:139], v[56:59]
    ds_read_b128 v[72:75], v255 offset:3840
    v_mfma_f32_16x16x32_bf16 v[60:63], v[124:127], v[136:139], v[60:63]
    ds_read_b128 v[76:79], v255 offset:3328
    s_waitcnt lgkmcnt(6)
    v_mfma_f32_16x16x32_bf16 v[64:67], v[128:131], v[136:139], v[64:67]
    buffer_load_dwordx4 a[136:139], v1, s[12:15], s99 offen offset:2048 sc1
    v_mfma_f32_16x16x32_bf16 v[68:71], v[132:135], v[136:139], v[68:71]
    v_mfma_f32_16x16x32_bf16 v[68:71], v[104:107], v[140:143], v[68:71]
    buffer_load_dwordx4 a[140:143], v1, s[12:15], s99 offen offset:3072 sc1
    s_waitcnt lgkmcnt(2)
    v_mfma_f32_16x16x32_bf16 v[44:47], v[104:107], v[144:147], v[44:47]
    ds_read2_b32 v[136:137], v156 offset0:48 offset1:49
    v_mfma_f32_16x16x32_bf16 v[48:51], v[108:111], v[144:147], v[48:51]
    ds_read2_b32 v[138:139], v156 offset0:50 offset1:51
    v_mfma_f32_16x16x32_bf16 v[52:55], v[112:115], v[144:147], v[52:55]
    ds_read2_b32 v[140:141], v157 offset0:176 offset1:177
    v_mfma_f32_16x16x32_bf16 v[56:59], v[116:119], v[144:147], v[56:59]
    ds_read2_b32 v[142:143], v157 offset0:178 offset1:179
    v_mfma_f32_16x16x32_bf16 v[60:63], v[120:123], v[144:147], v[60:63]
    ds_read_b128 v[80:83], v255 offset:2816
    v_mfma_f32_16x16x32_bf16 v[64:67], v[124:127], v[144:147], v[64:67]
    ds_read_b128 v[84:87], v255 offset:2304
    s_add_u32 s99, s99, 4096
    v_mfma_f32_16x16x32_bf16 v[68:71], v[128:131], v[144:147], v[68:71]
    buffer_load_dwordx4 a[144:147], v1, s[12:15], s99 offen offset:0 sc1
    v_mfma_f32_16x16x32_bf16 v[64:67], v[104:107], v[148:151], v[64:67]
    v_mfma_f32_16x16x32_bf16 v[68:71], v[108:111], v[148:151], v[68:71]
    buffer_load_dwordx4 a[148:151], v1, s[12:15], s99 offen offset:1024 sc1
    s_waitcnt lgkmcnt(2)
    v_mfma_f32_16x16x32_bf16 v[48:51], v[104:107], v[136:139], v[48:51]
    ds_read2_b32 v[144:145], v156 offset0:176 offset1:177
    v_mfma_f32_16x16x32_bf16 v[52:55], v[108:111], v[136:139], v[52:55]
    ds_read2_b32 v[146:147], v156 offset0:178 offset1:179
    v_mfma_f32_16x16x32_bf16 v[56:59], v[112:115], v[136:139], v[56:59]
    ds_read2_b32 v[148:149], v157 offset0:48 offset1:49
    v_mfma_f32_16x16x32_bf16 v[60:63], v[116:119], v[136:139], v[60:63]
    ds_read2_b32 v[150:151], v157 offset0:50 offset1:51
    v_mfma_f32_16x16x32_bf16 v[64:67], v[120:123], v[136:139], v[64:67]
    ds_read_b128 v[88:91], v255 offset:1792
    v_mfma_f32_16x16x32_bf16 v[68:71], v[124:127], v[136:139], v[68:71]
    ds_read_b128 v[92:95], v255 offset:1280
    v_mfma_f32_16x16x32_bf16 v[60:63], v[104:107], v[140:143], v[60:63]
    buffer_load_dwordx4 a[152:155], v1, s[12:15], s99 offen offset:2048 sc1
    v_mfma_f32_16x16x32_bf16 v[64:67], v[108:111], v[140:143], v[64:67]
    v_mfma_f32_16x16x32_bf16 v[68:71], v[112:115], v[140:143], v[68:71]
    buffer_load_dwordx4 a[156:159], v1, s[12:15], s99 offen offset:3072 sc1
    s_waitcnt lgkmcnt(2)
    v_mfma_f32_16x16x32_bf16 v[52:55], v[104:107], v[144:147], v[52:55]
    ds_read2_b32 v[136:137], v254 offset0:64 offset1:65
    v_mfma_f32_16x16x32_bf16 v[56:59], v[108:111], v[144:147], v[56:59]
    ds_read2_b32 v[138:139], v254 offset0:66 offset1:67
    v_mfma_f32_16x16x32_bf16 v[60:63], v[112:115], v[144:147], v[60:63]
    ds_read2_b32 v[140:141], v158 offset0:192 offset1:193
    v_mfma_f32_16x16x32_bf16 v[64:67], v[116:119], v[144:147], v[64:67]
    ds_read2_b32 v[142:143], v158 offset0:194 offset1:195
    v_mfma_f32_16x16x32_bf16 v[68:71], v[120:123], v[144:147], v[68:71]
    ds_read_b128 v[96:99], v255 offset:768
    v_mfma_f32_16x16x32_bf16 v[56:59], v[104:107], v[148:151], v[56:59]
    ds_read_b128 v[100:103], v255 offset:256
    s_add_u32 s99, s99, 4096
    v_mfma_f32_16x16x32_bf16 v[60:63], v[108:111], v[148:151], v[60:63]
    buffer_load_dwordx4 a[160:163], v1, s[12:15], s99 offen offset:0 sc1
    v_mfma_f32_16x16x32_bf16 v[64:67], v[112:115], v[148:151], v[64:67]
    v_mfma_f32_16x16x32_bf16 v[68:71], v[116:119], v[148:151], v[68:71]
    buffer_load_dwordx4 a[164:167], v1, s[12:15], s99 offen offset:1024 sc1
    s_waitcnt lgkmcnt(2)
    v_mfma_f32_16x16x32_bf16 v[40:43], v[72:75], v[136:139], v[40:43]
    ds_read2_b32 v[144:145], v254 offset0:192 offset1:193
    v_mfma_f32_16x16x32_bf16 v[44:47], v[76:79], v[136:139], v[44:47]
    ds_read2_b32 v[146:147], v254 offset0:194 offset1:195
    v_mfma_f32_16x16x32_bf16 v[48:51], v[80:83], v[136:139], v[48:51]
    ds_read2_b32 v[148:149], v158 offset0:64 offset1:65
    v_mfma_f32_16x16x32_bf16 v[52:55], v[84:87], v[136:139], v[52:55]
    ds_read2_b32 v[150:151], v158 offset0:66 offset1:67
    v_mfma_f32_16x16x32_bf16 v[56:59], v[88:91], v[136:139], v[56:59]
    ds_read_b128 v[104:107], v255 offset:3904
    v_mfma_f32_16x16x32_bf16 v[60:63], v[92:95], v[136:139], v[60:63]
    ds_read_b128 v[108:111], v255 offset:3392
    s_waitcnt lgkmcnt(6)
    v_mfma_f32_16x16x32_bf16 v[64:67], v[96:99], v[136:139], v[64:67]
    buffer_load_dwordx4 a[168:171], v1, s[12:15], s99 offen offset:2048 sc1
    v_mfma_f32_16x16x32_bf16 v[68:71], v[100:103], v[136:139], v[68:71]
    v_mfma_f32_16x16x32_bf16 v[68:71], v[72:75], v[140:143], v[68:71]
    buffer_load_dwordx4 a[172:175], v1, s[12:15], s99 offen offset:3072 sc1
    s_waitcnt lgkmcnt(2)
    v_mfma_f32_16x16x32_bf16 v[44:47], v[72:75], v[144:147], v[44:47]
    ds_read2_b32 v[136:137], v156 offset0:64 offset1:65
    v_mfma_f32_16x16x32_bf16 v[48:51], v[76:79], v[144:147], v[48:51]
    ds_read2_b32 v[138:139], v156 offset0:66 offset1:67
    v_mfma_f32_16x16x32_bf16 v[52:55], v[80:83], v[144:147], v[52:55]
    ds_read2_b32 v[140:141], v157 offset0:192 offset1:193
    v_mfma_f32_16x16x32_bf16 v[56:59], v[84:87], v[144:147], v[56:59]
    ds_read2_b32 v[142:143], v157 offset0:194 offset1:195
    v_mfma_f32_16x16x32_bf16 v[60:63], v[88:91], v[144:147], v[60:63]
    ds_read_b128 v[112:115], v255 offset:2880
    v_mfma_f32_16x16x32_bf16 v[64:67], v[92:95], v[144:147], v[64:67]
    ds_read_b128 v[116:119], v255 offset:2368
    s_add_u32 s99, s99, 4096
    v_mfma_f32_16x16x32_bf16 v[68:71], v[96:99], v[144:147], v[68:71]
    buffer_load_dwordx4 a[176:179], v1, s[12:15], s99 offen offset:0 sc1
    v_mfma_f32_16x16x32_bf16 v[64:67], v[72:75], v[148:151], v[64:67]
    v_mfma_f32_16x16x32_bf16 v[68:71], v[76:79], v[148:151], v[68:71]
    buffer_load_dwordx4 a[180:183], v1, s[12:15], s99 offen offset:1024 sc1
    s_waitcnt lgkmcnt(2)
    v_mfma_f32_16x16x32_bf16 v[48:51], v[72:75], v[136:139], v[48:51]
    ds_read2_b32 v[144:145], v156 offset0:192 offset1:193
    v_mfma_f32_16x16x32_bf16 v[52:55], v[76:79], v[136:139], v[52:55]
    ds_read2_b32 v[146:147], v156 offset0:194 offset1:195
    v_mfma_f32_16x16x32_bf16 v[56:59], v[80:83], v[136:139], v[56:59]
    ds_read2_b32 v[148:149], v157 offset0:64 offset1:65
    v_mfma_f32_16x16x32_bf16 v[60:63], v[84:87], v[136:139], v[60:63]
    ds_read2_b32 v[150:151], v157 offset0:66 offset1:67
    v_mfma_f32_16x16x32_bf16 v[64:67], v[88:91], v[136:139], v[64:67]
    ds_read_b128 v[120:123], v255 offset:1856
    v_mfma_f32_16x16x32_bf16 v[68:71], v[92:95], v[136:139], v[68:71]
    ds_read_b128 v[124:127], v255 offset:1344
    v_mfma_f32_16x16x32_bf16 v[60:63], v[72:75], v[140:143], v[60:63]
    buffer_load_dwordx4 a[184:187], v1, s[12:15], s99 offen offset:2048 sc1
    v_mfma_f32_16x16x32_bf16 v[64:67], v[76:79], v[140:143], v[64:67]
    v_mfma_f32_16x16x32_bf16 v[68:71], v[80:83], v[140:143], v[68:71]
    buffer_load_dwordx4 a[188:191], v1, s[12:15], s99 offen offset:3072 sc1
    s_waitcnt lgkmcnt(2)
    v_mfma_f32_16x16x32_bf16 v[52:55], v[72:75], v[144:147], v[52:55]
    ds_read2_b32 v[136:137], v254 offset0:80 offset1:81
    v_mfma_f32_16x16x32_bf16 v[56:59], v[76:79], v[144:147], v[56:59]
    ds_read2_b32 v[138:139], v254 offset0:82 offset1:83
    v_mfma_f32_16x16x32_bf16 v[60:63], v[80:83], v[144:147], v[60:63]
    ds_read2_b32 v[140:141], v158 offset0:208 offset1:209
    v_mfma_f32_16x16x32_bf16 v[64:67], v[84:87], v[144:147], v[64:67]
    ds_read2_b32 v[142:143], v158 offset0:210 offset1:211
    v_mfma_f32_16x16x32_bf16 v[68:71], v[88:91], v[144:147], v[68:71]
    ds_read_b128 v[128:131], v255 offset:832
    v_mfma_f32_16x16x32_bf16 v[56:59], v[72:75], v[148:151], v[56:59]
    ds_read_b128 v[132:135], v255 offset:320
    s_add_u32 s99, s99, 4096
    v_mfma_f32_16x16x32_bf16 v[60:63], v[76:79], v[148:151], v[60:63]
    buffer_load_dwordx4 a[192:195], v1, s[12:15], s99 offen offset:0 sc1
    v_mfma_f32_16x16x32_bf16 v[64:67], v[80:83], v[148:151], v[64:67]
    v_mfma_f32_16x16x32_bf16 v[68:71], v[84:87], v[148:151], v[68:71]
    buffer_load_dwordx4 a[196:199], v1, s[12:15], s99 offen offset:1024 sc1
    s_waitcnt lgkmcnt(2)
    v_mfma_f32_16x16x32_bf16 v[40:43], v[104:107], v[136:139], v[40:43]
    ds_read2_b32 v[144:145], v254 offset0:208 offset1:209
    v_mfma_f32_16x16x32_bf16 v[44:47], v[108:111], v[136:139], v[44:47]
    ds_read2_b32 v[146:147], v254 offset0:210 offset1:211
    v_mfma_f32_16x16x32_bf16 v[48:51], v[112:115], v[136:139], v[48:51]
    ds_read2_b32 v[148:149], v158 offset0:80 offset1:81
    v_mfma_f32_16x16x32_bf16 v[52:55], v[116:119], v[136:139], v[52:55]
    ds_read2_b32 v[150:151], v158 offset0:82 offset1:83
    v_mfma_f32_16x16x32_bf16 v[56:59], v[120:123], v[136:139], v[56:59]
    ds_read_b128 v[72:75], v255 offset:3968
    v_mfma_f32_16x16x32_bf16 v[60:63], v[124:127], v[136:139], v[60:63]
    ds_read_b128 v[76:79], v255 offset:3456
    s_waitcnt lgkmcnt(6)
    v_mfma_f32_16x16x32_bf16 v[64:67], v[128:131], v[136:139], v[64:67]
    buffer_load_dwordx4 a[200:203], v1, s[12:15], s99 offen offset:2048 sc1
    v_mfma_f32_16x16x32_bf16 v[68:71], v[132:135], v[136:139], v[68:71]
    v_mfma_f32_16x16x32_bf16 v[68:71], v[104:107], v[140:143], v[68:71]
    buffer_load_dwordx4 a[204:207], v1, s[12:15], s99 offen offset:3072 sc1
    buffer_load_dword v36, v35, s[12:15], s100 offen sc1
    s_waitcnt lgkmcnt(2)
    v_mfma_f32_16x16x32_bf16 v[44:47], v[104:107], v[144:147], v[44:47]
    ds_read2_b32 v[136:137], v156 offset0:80 offset1:81
    v_mfma_f32_16x16x32_bf16 v[48:51], v[108:111], v[144:147], v[48:51]
    ds_read2_b32 v[138:139], v156 offset0:82 offset1:83
    v_mfma_f32_16x16x32_bf16 v[52:55], v[112:115], v[144:147], v[52:55]
    ds_read2_b32 v[140:141], v157 offset0:208 offset1:209
    v_mfma_f32_16x16x32_bf16 v[56:59], v[116:119], v[144:147], v[56:59]
    ds_read2_b32 v[142:143], v157 offset0:210 offset1:211
    v_mfma_f32_16x16x32_bf16 v[60:63], v[120:123], v[144:147], v[60:63]
    ds_read_b128 v[80:83], v255 offset:2944
    v_mfma_f32_16x16x32_bf16 v[64:67], v[124:127], v[144:147], v[64:67]
    ds_read_b128 v[84:87], v255 offset:2432
    s_add_u32 s99, s99, 4096
    v_mfma_f32_16x16x32_bf16 v[68:71], v[128:131], v[144:147], v[68:71]
    buffer_load_dwordx4 a[208:211], v1, s[12:15], s99 offen offset:0 sc1
    v_mfma_f32_16x16x32_bf16 v[64:67], v[104:107], v[148:151], v[64:67]
    v_mfma_f32_16x16x32_bf16 v[68:71], v[108:111], v[148:151], v[68:71]
    buffer_load_dwordx4 a[212:215], v1, s[12:15], s99 offen offset:1024 sc1
    s_waitcnt lgkmcnt(2)
    v_mfma_f32_16x16x32_bf16 v[48:51], v[104:107], v[136:139], v[48:51]
    ds_read2_b32 v[144:145], v156 offset0:208 offset1:209
    v_mfma_f32_16x16x32_bf16 v[52:55], v[108:111], v[136:139], v[52:55]
    ds_read2_b32 v[146:147], v156 offset0:210 offset1:211
    v_mfma_f32_16x16x32_bf16 v[56:59], v[112:115], v[136:139], v[56:59]
    ds_read2_b32 v[148:149], v157 offset0:80 offset1:81
    v_mfma_f32_16x16x32_bf16 v[60:63], v[116:119], v[136:139], v[60:63]
    ds_read2_b32 v[150:151], v157 offset0:82 offset1:83
    v_mfma_f32_16x16x32_bf16 v[64:67], v[120:123], v[136:139], v[64:67]
    ds_read_b128 v[88:91], v255 offset:1920
    v_mfma_f32_16x16x32_bf16 v[68:71], v[124:127], v[136:139], v[68:71]
    ds_read_b128 v[92:95], v255 offset:1408
    v_mfma_f32_16x16x32_bf16 v[60:63], v[104:107], v[140:143], v[60:63]
    buffer_load_dwordx4 a[216:219], v1, s[12:15], s99 offen offset:2048 sc1
    v_mfma_f32_16x16x32_bf16 v[64:67], v[108:111], v[140:143], v[64:67]
    v_mfma_f32_16x16x32_bf16 v[68:71], v[112:115], v[140:143], v[68:71]
    buffer_load_dwordx4 a[220:223], v1, s[12:15], s99 offen offset:3072 sc1
    s_waitcnt vmcnt(4)
    v_cmp_ne_u32 vcc, 1, v36
    s_cbranch_vccz L_ok_54
    s_mov_b32 s79, 0
L_spin_53:
    s_sleep 1
    buffer_load_dword v36, v35, s[12:15], s100 offen sc1
    s_add_u32 s79, s79, 1
    s_cmp_gt_u32 s79, 200000
    s_cbranch_scc1 L_ok_54
    s_waitcnt vmcnt(0)
    v_cmp_ne_u32 vcc, 1, v36
    s_cbranch_vccnz L_spin_53
L_ok_54:
    s_waitcnt lgkmcnt(2)
    v_mfma_f32_16x16x32_bf16 v[52:55], v[104:107], v[144:147], v[52:55]
    ds_read2_b32 v[136:137], v254 offset0:96 offset1:97
    v_mfma_f32_16x16x32_bf16 v[56:59], v[108:111], v[144:147], v[56:59]
    ds_read2_b32 v[138:139], v254 offset0:98 offset1:99
    v_mfma_f32_16x16x32_bf16 v[60:63], v[112:115], v[144:147], v[60:63]
    ds_read2_b32 v[140:141], v158 offset0:224 offset1:225
    v_mfma_f32_16x16x32_bf16 v[64:67], v[116:119], v[144:147], v[64:67]
    ds_read2_b32 v[142:143], v158 offset0:226 offset1:227
    v_mfma_f32_16x16x32_bf16 v[68:71], v[120:123], v[144:147], v[68:71]
    ds_read_b128 v[96:99], v255 offset:896
    v_mfma_f32_16x16x32_bf16 v[56:59], v[104:107], v[148:151], v[56:59]
    ds_read_b128 v[100:103], v255 offset:384
    s_add_u32 s82, s36, 0
    v_mfma_f32_16x16x32_bf16 v[60:63], v[108:111], v[148:151], v[60:63]
    buffer_load_dwordx4 v[160:163], v1, s[12:15], s82 offen offset:0 sc1
    s_add_u32 s82, s37, 0
    v_mfma_f32_16x16x32_bf16 v[64:67], v[112:115], v[148:151], v[64:67]
    buffer_load_dwordx4 v[164:167], v1, s[12:15], s82 offen offset:0 sc1
    s_add_u32 s82, s38, 0
    v_mfma_f32_16x16x32_bf16 v[68:71], v[116:119], v[148:151], v[68:71]
    buffer_load_dwordx4 v[168:171], v1, s[12:15], s82 offen offset:0 sc1
    s_waitcnt lgkmcnt(2)
    v_mfma_f32_16x16x32_bf16 v[40:43], v[72:75], v[136:139], v[40:43]
    ds_read2_b32 v[144:145], v254 offset0:224 offset1:225
    v_mfma_f32_16x16x32_bf16 v[44:47], v[76:79], v[136:139], v[44:47]
    ds_read2_b32 v[146:147], v254 offset0:226 offset1:227
    v_mfma_f32_16x16x32_bf16 v[48:51], v[80:83], v[136:139], v[48:51]
    ds_read2_b32 v[148:149], v158 offset0:96 offset1:97
    v_mfma_f32_16x16x32_bf16 v[52:55], v[84:87], v[136:139], v[52:55]
    ds_read2_b32 v[150:151], v158 offset0:98 offset1:99
    v_mfma_f32_16x16x32_bf16 v[56:59], v[88:91], v[136:139], v[56:59]
    ds_read_b128 v[104:107], v255 offset:4032
    v_mfma_f32_16x16x32_bf16 v[60:63], v[92:95], v[136:139], v[60:63]
    ds_read_b128 v[108:111], v255 offset:3520
    s_waitcnt lgkmcnt(6)
    s_add_u32 s82, s39, 0
    v_mfma_f32_16x16x32_bf16 v[64:67], v[96:99], v[136:139], v[64:67]
    buffer_load_dwordx4 v[172:175], v1, s[12:15], s82 offen offset:0 sc1
    s_add_u32 s82, s36, 0
    v_mfma_f32_16x16x32_bf16 v[68:71], v[100:103], v[136:139], v[68:71]
    buffer_load_dwordx4 v[176:179], v1, s[12:15], s82 offen offset:1024 sc1
    s_add_u32 s82, s37, 0
    v_mfma_f32_16x16x32_bf16 v[68:71], v[72:75], v[140:143], v[68:71]
    buffer_load_dwordx4 v[180:183], v1, s[12:15], s82 offen offset:1024 sc1
    s_waitcnt lgkmcnt(2)
    v_mfma_f32_16x16x32_bf16 v[44:47], v[72:75], v[144:147], v[44:47]
    ds_read2_b32 v[136:137], v156 offset0:96 offset1:97
    v_mfma_f32_16x16x32_bf16 v[48:51], v[76:79], v[144:147], v[48:51]
    ds_read2_b32 v[138:139], v156 offset0:98 offset1:99
    v_mfma_f32_16x16x32_bf16 v[52:55], v[80:83], v[144:147], v[52:55]
    ds_read2_b32 v[140:141], v157 offset0:224 offset1:225
    v_mfma_f32_16x16x32_bf16 v[56:59], v[84:87], v[144:147], v[56:59]
    ds_read2_b32 v[142:143], v157 offset0:226 offset1:227
    v_mfma_f32_16x16x32_bf16 v[60:63], v[88:91], v[144:147], v[60:63]
    ds_read_b128 v[112:115], v255 offset:3008
    v_mfma_f32_16x16x32_bf16 v[64:67], v[92:95], v[144:147], v[64:67]
    ds_read_b128 v[116:119], v255 offset:2496
    s_add_u32 s82, s38, 0
    v_mfma_f32_16x16x32_bf16 v[68:71], v[96:99], v[144:147], v[68:71]
    buffer_load_dwordx4 v[184:187], v1, s[12:15], s82 offen offset:1024 sc1
    s_add_u32 s82, s39, 0
    v_mfma_f32_16x16x32_bf16 v[64:67], v[72:75], v[148:151], v[64:67]
    buffer_load_dwordx4 v[188:191], v1, s[12:15], s82 offen offset:1024 sc1
    s_add_u32 s82, s36, 0
    v_mfma_f32_16x16x32_bf16 v[68:71], v[76:79], v[148:151], v[68:71]
    buffer_load_dwordx4 v[192:195], v1, s[12:15], s82 offen offset:2048 sc1
    s_waitcnt lgkmcnt(2)
    v_mfma_f32_16x16x32_bf16 v[48:51], v[72:75], v[136:139], v[48:51]
    ds_read2_b32 v[144:145], v156 offset0:224 offset1:225
    v_mfma_f32_16x16x32_bf16 v[52:55], v[76:79], v[136:139], v[52:55]
    ds_read2_b32 v[146:147], v156 offset0:226 offset1:227
    v_mfma_f32_16x16x32_bf16 v[56:59], v[80:83], v[136:139], v[56:59]
    ds_read2_b32 v[148:149], v157 offset0:96 offset1:97
    v_mfma_f32_16x16x32_bf16 v[60:63], v[84:87], v[136:139], v[60:63]
    ds_read2_b32 v[150:151], v157 offset0:98 offset1:99
    v_mfma_f32_16x16x32_bf16 v[64:67], v[88:91], v[136:139], v[64:67]
    ds_read_b128 v[120:123], v255 offset:1984
    v_mfma_f32_16x16x32_bf16 v[68:71], v[92:95], v[136:139], v[68:71]
    ds_read_b128 v[124:127], v255 offset:1472
    s_add_u32 s82, s37, 0
    v_mfma_f32_16x16x32_bf16 v[60:63], v[72:75], v[140:143], v[60:63]
    buffer_load_dwordx4 v[196:199], v1, s[12:15], s82 offen offset:2048 sc1
    s_add_u32 s82, s38, 0
    v_mfma_f32_16x16x32_bf16 v[64:67], v[76:79], v[140:143], v[64:67]
    buffer_load_dwordx4 v[200:203], v1, s[12:15], s82 offen offset:2048 sc1
    s_add_u32 s82, s39, 0
    v_mfma_f32_16x16x32_bf16 v[68:71], v[80:83], v[140:143], v[68:71]
    buffer_load_dwordx4 v[204:207], v1, s[12:15], s82 offen offset:2048 sc1
    s_waitcnt lgkmcnt(2)
    v_mfma_f32_16x16x32_bf16 v[52:55], v[72:75], v[144:147], v[52:55]
    ds_read2_b32 v[136:137], v254 offset0:112 offset1:113
    v_mfma_f32_16x16x32_bf16 v[56:59], v[76:79], v[144:147], v[56:59]
    ds_read2_b32 v[138:139], v254 offset0:114 offset1:115
    v_mfma_f32_16x16x32_bf16 v[60:63], v[80:83], v[144:147], v[60:63]
    ds_read2_b32 v[140:141], v158 offset0:240 offset1:241
    v_mfma_f32_16x16x32_bf16 v[64:67], v[84:87], v[144:147], v[64:67]
    ds_read2_b32 v[142:143], v158 offset0:242 offset1:243
    v_mfma_f32_16x16x32_bf16 v[68:71], v[88:91], v[144:147], v[68:71]
    ds_read_b128 v[128:131], v255 offset:960
    v_mfma_f32_16x16x32_bf16 v[56:59], v[72:75], v[148:151], v[56:59]
    ds_read_b128 v[132:135], v255 offset:448
    s_add_u32 s82, s36, 3584
    v_mfma_f32_16x16x32_bf16 v[60:63], v[76:79], v[148:151], v[60:63]
    buffer_load_dwordx4 v[208:211], v1, s[12:15], s82 offen offset:0 sc1
    s_add_u32 s82, s37, 3584
    v_mfma_f32_16x16x32_bf16 v[64:67], v[80:83], v[148:151], v[64:67]
    buffer_load_dwordx4 v[212:215], v1, s[12:15], s82 offen offset:0 sc1
    s_add_u32 s82, s38, 3584
    v_mfma_f32_16x16x32_bf16 v[68:71], v[84:87], v[148:151], v[68:71]
    buffer_load_dwordx4 v[216:219], v1, s[12:15], s82 offen offset:0 sc1
    s_waitcnt lgkmcnt(2)
    v_mfma_f32_16x16x32_bf16 v[40:43], v[104:107], v[136:139], v[40:43]
    ds_read2_b32 v[144:145], v254 offset0:240 offset1:241
    v_mfma_f32_16x16x32_bf16 v[44:47], v[108:111], v[136:139], v[44:47]
    ds_read2_b32 v[146:147], v254 offset0:242 offset1:243
    v_mfma_f32_16x16x32_bf16 v[48:51], v[112:115], v[136:139], v[48:51]
    ds_read2_b32 v[148:149], v158 offset0:112 offset1:113
    v_mfma_f32_16x16x32_bf16 v[52:55], v[116:119], v[136:139], v[52:55]
    ds_read2_b32 v[150:151], v158 offset0:114 offset1:115
    v_mfma_f32_16x16x32_bf16 v[56:59], v[120:123], v[136:139], v[56:59]
    v_mfma_f32_16x16x32_bf16 v[60:63], v[124:127], v[136:139], v[60:63]
    s_waitcnt lgkmcnt(4)
    s_add_u32 s82, s39, 3584
    v_mfma_f32_16x16x32_bf16 v[64:67], v[128:131], v[136:139], v[64:67]
    buffer_load_dwordx4 v[220:223], v1, s[12:15], s82 offen offset:0 sc1
    s_add_u32 s82, s36, 3584
    v_mfma_f32_16x16x32_bf16 v[68:71], v[132:135], v[136:139], v[68:71]
    buffer_load_dwordx4 v[224:227], v1, s[12:15], s82 offen offset:1024 sc1
    s_add_u32 s82, s37, 3584
    v_mfma_f32_16x16x32_bf16 v[68:71], v[104:107], v[140:143], v[68:71]
    buffer_load_dwordx4 v[228:231], v1, s[12:15], s82 offen offset:1024 sc1
    s_waitcnt lgkmcnt(0)
    v_mfma_f32_16x16x32_bf16 v[44:47], v[104:107], v[144:147], v[44:47]
    ds_read2_b32 v[136:137], v156 offset0:112 offset1:113
    v_mfma_f32_16x16x32_bf16 v[48:51], v[108:111], v[144:147], v[48:51]
    ds_read2_b32 v[138:139], v156 offset0:114 offset1:115
    v_mfma_f32_16x16x32_bf16 v[52:55], v[112:115], v[144:147], v[52:55]
    ds_read2_b32 v[140:141], v157 offset0:240 offset1:241
    v_mfma_f32_16x16x32_bf16 v[56:59], v[116:119], v[144:147], v[56:59]
    ds_read2_b32 v[142:143], v157 offset0:242 offset1:243
    v_mfma_f32_16x16x32_bf16 v[60:63], v[120:123], v[144:147], v[60:63]
    v_mfma_f32_16x16x32_bf16 v[64:67], v[124:127], v[144:147], v[64:67]
    v_mfma_f32_16x16x32_bf16 v[68:71], v[128:131], v[144:147], v[68:71]
    v_mfma_f32_16x16x32_bf16 v[64:67], v[104:107], v[148:151], v[64:67]
    v_mfma_f32_16x16x32_bf16 v[68:71], v[108:111], v[148:151], v[68:71]
    s_waitcnt lgkmcnt(0)
    v_mfma_f32_16x16x32_bf16 v[48:51], v[104:107], v[136:139], v[48:51]
    ds_read2_b32 v[144:145], v156 offset0:240 offset1:241
    v_mfma_f32_16x16x32_bf16 v[52:55], v[108:111], v[136:139], v[52:55]
    ds_read2_b32 v[146:147], v156 offset0:242 offset1:243
    v_mfma_f32_16x16x32_bf16 v[56:59], v[112:115], v[136:139], v[56:59]
    ds_read2_b32 v[148:149], v157 offset0:112 offset1:113
    v_mfma_f32_16x16x32_bf16 v[60:63], v[116:119], v[136:139], v[60:63]
    ds_read2_b32 v[150:151], v157 offset0:114 offset1:115
    v_mfma_f32_16x16x32_bf16 v[64:67], v[120:123], v[136:139], v[64:67]
    v_mfma_f32_16x16x32_bf16 v[68:71], v[124:127], v[136:139], v[68:71]
    v_mfma_f32_16x16x32_bf16 v[60:63], v[104:107], v[140:143], v[60:63]
    v_mfma_f32_16x16x32_bf16 v[64:67], v[108:111], v[140:143], v[64:67]
    v_mfma_f32_16x16x32_bf16 v[68:71], v[112:115], v[140:143], v[68:71]
    s_waitcnt lgkmcnt(0)
    v_mfma_f32_16x16x32_bf16 v[52:55], v[104:107], v[144:147], v[52:55]
    v_mfma_f32_16x16x32_bf16 v[56:59], v[108:111], v[144:147], v[56:59]
    v_mfma_f32_16x16x32_bf16 v[60:63], v[112:115], v[144:147], v[60:63]
    v_mfma_f32_16x16x32_bf16 v[64:67], v[116:119], v[144:147], v[64:67]
    v_mfma_f32_16x16x32_bf16 v[68:71], v[120:123], v[144:147], v[68:71]
    v_mfma_f32_16x16x32_bf16 v[56:59], v[104:107], v[148:151], v[56:59]
    v_mfma_f32_16x16x32_bf16 v[60:63], v[108:111], v[148:151], v[60:63]
    v_mfma_f32_16x16x32_bf16 v[64:67], v[112:115], v[148:151], v[64:67]
    v_mfma_f32_16x16x32_bf16 v[68:71], v[116:119], v[148:151], v[68:71]
    s_mov_b32 m0, s95
    v_cvt_pk_bf16_f32 v72, v40, v41
    v_cvt_pk_bf16_f32 v73, v42, v43
    v_cvt_pk_bf16_f32 v74, v44, v45
    v_cvt_pk_bf16_f32 v75, v46, v47
    v_cvt_pk_bf16_f32 v76, v48, v49
    v_cvt_pk_bf16_f32 v77, v50, v51
    v_cvt_pk_bf16_f32 v78, v52, v53
    v_cvt_pk_bf16_f32 v79, v54, v55
    v_cvt_pk_bf16_f32 v80, v56, v57
    v_cvt_pk_bf16_f32 v81, v58, v59
    v_cvt_pk_bf16_f32 v82, v60, v61
    v_cvt_pk_bf16_f32 v83, v62, v63
    v_cvt_pk_bf16_f32 v84, v64, v65
    v_cvt_pk_bf16_f32 v85, v66, v67
    v_cvt_pk_bf16_f32 v86, v68, v69
    v_cvt_pk_bf16_f32 v87, v70, v71
    ds_write_addtid_b32 v72 offset:0
    ds_write_addtid_b32 v73 offset:256
    ds_write_addtid_b32 v74 offset:512
    ds_write_addtid_b32 v75 offset:768
    ds_write_addtid_b32 v76 offset:1024
    ds_write_addtid_b32 v77 offset:1280
    ds_write_addtid_b32 v78 offset:1536
    ds_write_addtid_b32 v79 offset:1792
    ds_write_addtid_b32 v80 offset:2048
    ds_write_addtid_b32 v81 offset:2304
    ds_write_addtid_b32 v82 offset:2560
    ds_write_addtid_b32 v83 offset:2816
    ds_write_addtid_b32 v84 offset:3072
    ds_write_addtid_b32 v85 offset:3328
    ds_write_addtid_b32 v86 offset:3584
    ds_write_addtid_b32 v87 offset:3840
    v_add_u32 v152, s95, v1
    ds_read_b128 v[88:91], v152 offset:0
    ds_read_b128 v[92:95], v152 offset:1024
    ds_read_b128 v[96:99], v152 offset:2048
    ds_read_b128 v[100:103], v152 offset:3072
    v_lshrrev_b32 v153, 5, v0
    v_lshlrev_b32 v153, 9, v153
    v_bfe_u32 v154, v0, 2, 2
    v_lshl_add_u32 v153, v154, 7, v153
    v_bfe_u32 v154, v0, 4, 1
    v_lshl_add_u32 v153, v154, 6, v153
    v_and_b32 v154, 3, v0
    v_lshl_add_u32 v153, v154, 4, v153
    s_add_u32 s94, s92, 15597568
    s_waitcnt lgkmcnt(3)
    buffer_store_dwordx4 v[88:91], v153, s[12:15], s94 offen offset:0 sc1
    s_waitcnt lgkmcnt(2)
    buffer_store_dwordx4 v[92:95], v153, s[12:15], s94 offen offset:1024 sc1
    s_waitcnt lgkmcnt(1)
    buffer_store_dwordx4 v[96:99], v153, s[12:15], s94 offen offset:2048 sc1
    s_waitcnt lgkmcnt(0)
    buffer_store_dwordx4 v[100:103], v153, s[12:15], s94 offen offset:3072 sc1
    s_waitcnt lgkmcnt(0)
    s_branch L_join_50
L_noconv_49:
    s_lshr_b32 s76, s64, 1
    s_lshl_b32 s77, s97, 1
    s_add_u32 s76, s76, s77
    s_lshl_b32 s76, s76, 2
    s_lshr_b32 s77, s96, 2
    s_add_u32 s76, s76, s77
    s_lshl_b32 s76, s76, 7
    s_and_b32 s77, s96, 3
    s_lshl_b32 s77, s77, 1
    s_and_b32 s78, s64, 1
    s_add_u32 s77, s77, s78
    s_lshl_b32 s77, s77, 2
    s_add_u32 s76, s76, s77
    s_add_u32 s101, s76, 32768
    s_add_u32 s100, s98, 32768
    v_and_b32 v35, 7, v0
    v_lshlrev_b32 v35, 2, v35
    s_add_u32 s76, s64, 0
    s_and_b32 s76, s76, 3
    s_lshl_b32 s77, s65, 2
    s_add_u32 s76, s76, s77
    s_lshl_b32 s76, s76, 2
    s_add_u32 s76, s76, s64
    s_mul_i32 s76, s76, 14336
    s_add_u32 s36, s76, 5570560
    s_add_u32 s76, s64, 1
    s_and_b32 s76, s76, 3
    s_lshl_b32 s77, s65, 2
    s_add_u32 s76, s76, s77
    s_lshl_b32 s76, s76, 2
    s_add_u32 s76, s76, s64
    s_mul_i32 s76, s76, 14336
    s_add_u32 s37, s76, 5570560
    s_add_u32 s76, s64, 2
    s_and_b32 s76, s76, 3
    s_lshl_b32 s77, s65, 2
    s_add_u32 s76, s76, s77
    s_lshl_b32 s76, s76, 2
    s_add_u32 s76, s76, s64
    s_mul_i32 s76, s76, 14336
    s_add_u32 s38, s76, 5570560
    s_add_u32 s76, s64, 3
    s_and_b32 s76, s76, 3
    s_lshl_b32 s77, s65, 2
    s_add_u32 s76, s76, s77
    s_lshl_b32 s76, s76, 2
    s_add_u32 s76, s76, s64
    s_mul_i32 s76, s76, 14336
    s_add_u32 s39, s76, 5570560
    buffer_load_dwordx4 a[40:43], v1, s[12:15], s99 offen offset:2048 sc1
    buffer_load_dwordx4 a[44:47], v1, s[12:15], s99 offen offset:3072 sc1
    s_add_u32 s99, s99, 4096
    buffer_load_dwordx4 a[48:51], v1, s[12:15], s99 offen offset:0 sc1
    buffer_load_dwordx4 a[52:55], v1, s[12:15], s99 offen offset:1024 sc1
    buffer_load_dwordx4 a[56:59], v1, s[12:15], s99 offen offset:2048 sc1
    buffer_load_dwordx4 a[60:63], v1, s[12:15], s99 offen offset:3072 sc1
    s_add_u32 s99, s99, 4096
    buffer_load_dwordx4 a[64:67], v1, s[12:15], s99 offen offset:0 sc1
    buffer_load_dwordx4 a[68:71], v1, s[12:15], s99 offen offset:1024 sc1
    s_waitcnt vmcnt(8)
    s_mov_b64 exec, 1
    buffer_store_dword v34, v38, s[12:15], s101 offen sc1
    s_mov_b64 exec, -1
    buffer_load_dwordx4 a[72:75], v1, s[12:15], s99 offen offset:2048 sc1
    buffer_load_dwordx4 a[76:79], v1, s[12:15], s99 offen offset:3072 sc1
    s_add_u32 s99, s99, 4096
    buffer_load_dwordx4 a[80:83], v1, s[12:15], s99 offen offset:0 sc1
    buffer_load_dwordx4 a[84:87], v1, s[12:15], s99 offen offset:1024 sc1
    buffer_load_dwordx4 a[88:91], v1, s[12:15], s99 offen offset:2048 sc1
    buffer_load_dwordx4 a[92:95], v1, s[12:15], s99 offen offset:3072 sc1
    s_add_u32 s99, s99, 4096
    buffer_load_dwordx4 a[96:99], v1, s[12:15], s99 offen offset:0 sc1
    buffer_load_dwordx4 a[100:103], v1, s[12:15], s99 offen offset:1024 sc1
    buffer_load_dwordx4 a[104:107], v1, s[12:15], s99 offen offset:2048 sc1
    buffer_load_dwordx4 a[108:111], v1, s[12:15], s99 offen offset:3072 sc1
    s_add_u32 s99, s99, 4096
    buffer_load_dwordx4 a[112:115], v1, s[12:15], s99 offen offset:0 sc1
    buffer_load_dwordx4 a[116:119], v1, s[12:15], s99 offen offset:1024 sc1
    buffer_load_dwordx4 a[120:123], v1, s[12:15], s99 offen offset:2048 sc1
    buffer_load_dwordx4 a[124:127], v1, s[12:15], s99 offen offset:3072 sc1
    s_add_u32 s99, s99, 4096
    buffer_load_dwordx4 a[128:131], v1, s[12:15], s99 offen offset:0 sc1
    buffer_load_dwordx4 a[132:135], v1, s[12:15], s99 offen offset:1024 sc1
    buffer_load_dwordx4 a[136:139], v1, s[12:15], s99 offen offset:2048 sc1
    buffer_load_dwordx4 a[140:143], v1, s[12:15], s99 offen offset:3072 sc1
    s_add_u32 s99, s99, 4096
    buffer_load_dwordx4 a[144:147], v1, s[12:15], s99 offen offset:0 sc1
    buffer_load_dwordx4 a[148:151], v1, s[12:15], s99 offen offset:1024 sc1
    buffer_load_dwordx4 a[152:155], v1, s[12:15], s99 offen offset:2048 sc1
    buffer_load_dwordx4 a[156:159], v1, s[12:15], s99 offen offset:3072 sc1
    s_add_u32 s99, s99, 4096
    buffer_load_dwordx4 a[160:163], v1, s[12:15], s99 offen offset:0 sc1
    buffer_load_dwordx4 a[164:167], v1, s[12:15], s99 offen offset:1024 sc1
    buffer_load_dwordx4 a[168:171], v1, s[12:15], s99 offen offset:2048 sc1
    buffer_load_dwordx4 a[172:175], v1, s[12:15], s99 offen offset:3072 sc1
    s_add_u32 s99, s99, 4096
    buffer_load_dwordx4 a[176:179], v1, s[12:15], s99 offen offset:0 sc1
    buffer_load_dwordx4 a[180:183], v1, s[12:15], s99 offen offset:1024 sc1
    buffer_load_dwordx4 a[184:187], v1, s[12:15], s99 offen offset:2048 sc1
    buffer_load_dwordx4 a[188:191], v1, s[12:15], s99 offen offset:3072 sc1
    s_add_u32 s99, s99, 4096
    buffer_load_dwordx4 a[192:195], v1, s[12:15], s99 offen offset:0 sc1
    buffer_load_dwordx4 a[196:199], v1, s[12:15], s99 offen offset:1024 sc1
    buffer_load_dword v36, v35, s[12:15], s100 offen sc1
    buffer_load_dwordx4 a[200:203], v1, s[12:15], s99 offen offset:2048 sc1
    buffer_load_dwordx4 a[204:207], v1, s[12:15], s99 offen offset:3072 sc1
    s_add_u32 s99, s99, 4096
    buffer_load_dwordx4 a[208:211], v1, s[12:15], s99 offen offset:0 sc1
    buffer_load_dwordx4 a[212:215], v1, s[12:15], s99 offen offset:1024 sc1
    buffer_load_dwordx4 a[216:219], v1, s[12:15], s99 offen offset:2048 sc1
    buffer_load_dwordx4 a[220:223], v1, s[12:15], s99 offen offset:3072 sc1
    s_waitcnt vmcnt(6)
    v_cmp_ne_u32 vcc, 1, v36
    s_cbranch_vccz L_ok_52
    s_mov_b32 s79, 0
L_spin_51:
    s_sleep 1
    buffer_load_dword v36, v35, s[12:15], s100 offen sc1
    s_add_u32 s79, s79, 1
    s_cmp_gt_u32 s79, 200000
    s_cbranch_scc1 L_ok_52
    s_waitcnt vmcnt(0)
    v_cmp_ne_u32 vcc, 1, v36
    s_cbranch_vccnz L_spin_51
L_ok_52:
    s_add_u32 s82, s36, 0
    buffer_load_dwordx4 v[160:163], v1, s[12:15], s82 offen offset:0 sc1
    s_add_u32 s82, s37, 0
    buffer_load_dwordx4 v[164:167], v1, s[12:15], s82 offen offset:0 sc1
    s_add_u32 s82, s38, 0
    buffer_load_dwordx4 v[168:171], v1, s[12:15], s82 offen offset:0 sc1
    s_add_u32 s82, s39, 0
    buffer_load_dwordx4 v[172:175], v1, s[12:15], s82 offen offset:0 sc1
    s_add_u32 s82, s36, 0
    buffer_load_dwordx4 v[176:179], v1, s[12:15], s82 offen offset:1024 sc1
    s_add_u32 s82, s37, 0
    buffer_load_dwordx4 v[180:183], v1, s[12:15], s82 offen offset:1024 sc1
    s_add_u32 s82, s38, 0
    buffer_load_dwordx4 v[184:187], v1, s[12:15], s82 offen offset:1024 sc1
    s_add_u32 s82, s39, 0
    buffer_load_dwordx4 v[188:191], v1, s[12:15], s82 offen offset:1024 sc1
    s_add_u32 s82, s36, 0
    buffer_load_dwordx4 v[192:195], v1, s[12:15], s82 offen offset:2048 sc1
    s_add_u32 s82, s37, 0
    buffer_load_dwordx4 v[196:199], v1, s[12:15], s82 offen offset:2048 sc1
    s_add_u32 s82, s38, 0
    buffer_load_dwordx4 v[200:203], v1, s[12:15], s82 offen offset:2048 sc1
    s_add_u32 s82, s39, 0
    buffer_load_dwordx4 v[204:207], v1, s[12:15], s82 offen offset:2048 sc1
    s_add_u32 s82, s36, 3584
    buffer_load_dwordx4 v[208:211], v1, s[12:15], s82 offen offset:0 sc1
    s_add_u32 s82, s37, 3584
    buffer_load_dwordx4 v[212:215], v1, s[12:15], s82 offen offset:0 sc1
    s_add_u32 s82, s38, 3584
    buffer_load_dwordx4 v[216:219], v1, s[12:15], s82 offen offset:0 sc1
    s_add_u32 s82, s39, 3584
    buffer_load_dwordx4 v[220:223], v1, s[12:15], s82 offen offset:0 sc1
    s_add_u32 s82, s36, 3584
    buffer_load_dwordx4 v[224:227], v1, s[12:15], s82 offen offset:1024 sc1
    s_add_u32 s82, s37, 3584
    buffer_load_dwordx4 v[228:231], v1, s[12:15], s82 offen offset:1024 sc1
L_join_50:
    s_waitcnt lgkmcnt(0)
    s_waitcnt vmcnt(17)
    v_mfma_f32_16x16x32_bf16 v[40:43], a[0:3], v[160:163], 0
    s_mul_i32 s77, s64, 15360
    s_add_u32 s77, s77, 73728
    s_add_u32 s82, s38, 3584
    v_mfma_f32_16x16x32_bf16 v[44:47], a[4:7], v[160:163], 0
    buffer_load_dwordx4 v[120:123], v1, s[12:15], s82 offen offset:1024 sc1
    v_mfma_f32_16x16x32_bf16 v[48:51], a[8:11], v[160:163], 0
    v_add_u32 v247, s77, v1
    s_add_u32 s76, s64, 1
    s_add_u32 s99, s99, 4096
    v_mfma_f32_16x16x32_bf16 v[52:55], a[12:15], v[160:163], 0
    buffer_load_dwordx4 a[224:227], v1, s[12:15], s99 offen offset:0 sc1
    v_mfma_f32_16x16x32_bf16 v[56:59], a[16:19], v[160:163], 0
    s_and_b32 s76, s76, 3
    s_mul_i32 s76, s76, 15360
    s_waitcnt vmcnt(18)
    v_mfma_f32_16x16x32_bf16 v[60:63], a[0:3], v[164:167], 0
    s_add_u32 s76, s76, 73728
    v_add_u32 v248, s76, v1
    s_add_u32 s82, s39, 3584
    v_mfma_f32_16x16x32_bf16 v[64:67], a[4:7], v[164:167], 0
    buffer_load_dwordx4 v[124:127], v1, s[12:15], s82 offen offset:1024 sc1
    v_mfma_f32_16x16x32_bf16 v[68:71], a[8:11], v[164:167], 0
    s_add_u32 s76, s64, 2
    s_and_b32 s76, s76, 3
    v_mfma_f32_16x16x32_bf16 v[72:75], a[12:15], v[164:167], 0
    s_mul_i32 s76, s76, 15360
    s_add_u32 s76, s76, 78848
    v_mfma_f32_16x16x32_bf16 v[76:79], a[16:19], v[164:167], 0
    v_add_u32 v249, s76, v1
    s_add_u32 s76, s64, 3
    s_waitcnt vmcnt(18)
    v_mfma_f32_16x16x32_bf16 v[80:83], a[0:3], v[168:171], 0
    s_and_b32 s76, s76, 3
    s_mul_i32 s76, s76, 15360
    s_add_u32 s82, s36, 3584
    v_mfma_f32_16x16x32_bf16 v[84:87], a[4:7], v[168:171], 0
    buffer_load_dwordx4 v[128:131], v1, s[12:15], s82 offen offset:2048 sc1
    v_mfma_f32_16x16x32_bf16 v[88:91], a[8:11], v[168:171], 0
    s_add_u32 s76, s76, 83968
    v_add_u32 v250, s76, v1
    v_mfma_f32_16x16x32_bf16 v[92:95], a[12:15], v[168:171], 0
    buffer_load_dwordx4 a[228:231], v1, s[12:15], s99 offen offset:1024 sc1
    v_mfma_f32_16x16x32_bf16 v[96:99], a[16:19], v[168:171], 0
    v_min_u32 v35, 19, v0
    v_lshlrev_b32 v35, 2, v35
    s_waitcnt vmcnt(19)
    v_mfma_f32_16x16x32_bf16 v[100:103], a[0:3], v[172:175], 0
    s_lshl_b32 s100, s66, 2
    s_add_u32 s100, s100, s64
    s_add_u32 s82, s37, 3584
    v_mfma_f32_16x16x32_bf16 v[104:107], a[4:7], v[172:175], 0
    buffer_load_dwordx4 v[132:135], v1, s[12:15], s82 offen offset:2048 sc1
    v_mfma_f32_16x16x32_bf16 v[108:111], a[8:11], v[172:175], 0
    s_lshl_b32 s100, s100, 7
    s_add_u32 s100, s100, 57344
    v_mfma_f32_16x16x32_bf16 v[112:115], a[12:15], v[172:175], 0
    v_lshrrev_b32 v251, 3, v0
    v_and_b32 v252, 7, v0
    v_mfma_f32_16x16x32_bf16 v[116:119], a[16:19], v[172:175], 0
    v_lshlrev_b32 v252, 4, v252
    v_lshl_add_u32 v251, v251, 12, v252
    s_waitcnt vmcnt(19)
    v_mfma_f32_16x16x32_bf16 v[40:43], a[20:23], v[176:179], v[40:43]
    s_mul_i32 s101, s66, 80
    s_mul_i32 s77, s64, 20
    s_add_u32 s82, s38, 3584
    v_mfma_f32_16x16x32_bf16 v[44:47], a[24:27], v[176:179], v[44:47]
    buffer_load_dwordx4 v[136:139], v1, s[12:15], s82 offen offset:2048 sc1
    v_mfma_f32_16x16x32_bf16 v[48:51], a[28:31], v[176:179], v[48:51]
    s_add_u32 s101, s101, s77
    s_lshl_b32 s101, s101, 12
    v_mfma_f32_16x16x32_bf16 v[52:55], a[32:35], v[176:179], v[52:55]
    buffer_load_dwordx4 a[232:235], v1, s[12:15], s99 offen offset:2048 sc1
    v_mfma_f32_16x16x32_bf16 v[56:59], a[36:39], v[176:179], v[56:59]
    s_lshl_b32 s77, s65, 7
    s_add_u32 s101, s101, s77
    s_waitcnt vmcnt(20)
    v_mfma_f32_16x16x32_bf16 v[60:63], a[20:23], v[180:183], v[60:63]
    s_add_u32 s101, s101, 15597568
    s_mul_i32 s60, s64, 2560
    s_add_u32 s82, s39, 3584
    v_mfma_f32_16x16x32_bf16 v[64:67], a[24:27], v[180:183], v[64:67]
    buffer_load_dwordx4 v[140:143], v1, s[12:15], s82 offen offset:2048 sc1
    v_mfma_f32_16x16x32_bf16 v[68:71], a[28:31], v[180:183], v[68:71]
    s_mul_i32 s77, s81, 3277
    s_lshr_b32 s77, s77, 16
    v_mfma_f32_16x16x32_bf16 v[72:75], a[32:35], v[180:183], v[72:75]
    s_mul_i32 s78, s77, 20
    s_sub_u32 s76, s81, s78
    v_mfma_f32_16x16x32_bf16 v[76:79], a[36:39], v[180:183], v[76:79]
    s_lshl_b32 s76, s76, 2
    s_lshl_b32 s77, s77, 7
    s_waitcnt vmcnt(20)
    v_mfma_f32_16x16x32_bf16 v[80:83], a[20:23], v[184:187], v[80:83]
    s_add_u32 s76, s76, s77
    s_add_u32 s59, s76, 57344
    s_add_u32 s82, s36, 7168
    v_mfma_f32_16x16x32_bf16 v[84:87], a[24:27], v[184:187], v[84:87]
    buffer_load_dwordx4 v[144:147], v1, s[12:15], s82 offen offset:0 sc1
    v_mfma_f32_16x16x32_bf16 v[88:91], a[28:31], v[184:187], v[88:91]
    v_lshrrev_b32 v246, 2, v0
    v_lshlrev_b32 v246, 7, v246
    v_mfma_f32_16x16x32_bf16 v[92:95], a[32:35], v[184:187], v[92:95]
    buffer_load_dwordx4 a[236:239], v1, s[12:15], s99 offen offset:3072 sc1
    v_mfma_f32_16x16x32_bf16 v[96:99], a[36:39], v[184:187], v[96:99]
    v_and_b32 v252, 3, v0
    v_lshl_add_u32 v246, v252, 3, v246
    s_waitcnt vmcnt(21)
    v_mfma_f32_16x16x32_bf16 v[100:103], a[20:23], v[188:191], v[100:103]
    s_lshl_b32 s76, s64, 5
    s_add_u32 s76, s76, 143360
    s_add_u32 s82, s37, 7168
    v_mfma_f32_16x16x32_bf16 v[104:107], a[24:27], v[188:191], v[104:107]
    buffer_load_dwordx4 v[148:151], v1, s[12:15], s82 offen offset:0 sc1
    v_mfma_f32_16x16x32_bf16 v[108:111], a[28:31], v[188:191], v[108:111]
    v_add_u32 v246, s76, v246
    v_mfma_f32_16x16x32_bf16 v[112:115], a[32:35], v[188:191], v[112:115]
    v_mfma_f32_16x16x32_bf16 v[116:119], a[36:39], v[188:191], v[116:119]
    s_waitcnt vmcnt(21)
    v_mfma_f32_16x16x32_bf16 v[40:43], a[40:43], v[192:195], v[40:43]
    s_add_u32 s82, s38, 7168
    v_mfma_f32_16x16x32_bf16 v[44:47], a[44:47], v[192:195], v[44:47]
    buffer_load_dwordx4 v[152:155], v1, s[12:15], s82 offen offset:0 sc1
    v_mfma_f32_16x16x32_bf16 v[48:51], a[48:51], v[192:195], v[48:51]
    s_add_u32 s99, s99, 4096
    v_mfma_f32_16x16x32_bf16 v[52:55], a[52:55], v[192:195], v[52:55]
    buffer_load_dwordx4 a[240:243], v1, s[12:15], s99 offen offset:0 sc1
    v_mfma_f32_16x16x32_bf16 v[56:59], a[56:59], v[192:195], v[56:59]
    s_waitcnt vmcnt(22)
    v_mfma_f32_16x16x32_bf16 v[60:63], a[40:43], v[196:199], v[60:63]
    s_add_u32 s82, s39, 7168
    v_mfma_f32_16x16x32_bf16 v[64:67], a[44:47], v[196:199], v[64:67]
    buffer_load_dwordx4 v[156:159], v1, s[12:15], s82 offen offset:0 sc1
    v_mfma_f32_16x16x32_bf16 v[68:71], a[48:51], v[196:199], v[68:71]
    v_mfma_f32_16x16x32_bf16 v[72:75], a[52:55], v[196:199], v[72:75]
    v_mfma_f32_16x16x32_bf16 v[76:79], a[56:59], v[196:199], v[76:79]
    s_waitcnt vmcnt(22)
    v_mfma_f32_16x16x32_bf16 v[80:83], a[40:43], v[200:203], v[80:83]
    s_add_u32 s82, s36, 7168
    v_mfma_f32_16x16x32_bf16 v[84:87], a[44:47], v[200:203], v[84:87]
    buffer_load_dwordx4 v[160:163], v1, s[12:15], s82 offen offset:1024 sc1
    v_mfma_f32_16x16x32_bf16 v[88:91], a[48:51], v[200:203], v[88:91]
    v_mfma_f32_16x16x32_bf16 v[92:95], a[52:55], v[200:203], v[92:95]
    buffer_load_dwordx4 a[244:247], v1, s[12:15], s99 offen offset:1024 sc1
    v_mfma_f32_16x16x32_bf16 v[96:99], a[56:59], v[200:203], v[96:99]
    s_waitcnt vmcnt(23)
    v_mfma_f32_16x16x32_bf16 v[100:103], a[40:43], v[204:207], v[100:103]
    s_add_u32 s82, s37, 7168
    v_mfma_f32_16x16x32_bf16 v[104:107], a[44:47], v[204:207], v[104:107]
    buffer_load_dwordx4 v[164:167], v1, s[12:15], s82 offen offset:1024 sc1
    v_mfma_f32_16x16x32_bf16 v[108:111], a[48:51], v[204:207], v[108:111]
    v_mfma_f32_16x16x32_bf16 v[112:115], a[52:55], v[204:207], v[112:115]
    v_mfma_f32_16x16x32_bf16 v[116:119], a[56:59], v[204:207], v[116:119]
    s_cmp_ge_u32 s81, 640
    s_cbranch_scc1 L_noy_55
    s_waitcnt vmcnt(18)
    s_mov_b64 exec, 1
    buffer_store_dword v34, v38, s[12:15], s59 offen sc1
    s_mov_b64 exec, -1
L_noy_55:
    s_waitcnt vmcnt(23)
    v_mfma_f32_16x16x32_bf16 v[40:43], a[60:63], v[208:211], v[40:43]
    s_add_u32 s82, s38, 7168
    v_mfma_f32_16x16x32_bf16 v[44:47], a[64:67], v[208:211], v[44:47]
    buffer_load_dwordx4 v[168:171], v1, s[12:15], s82 offen offset:1024 sc1
    v_mfma_f32_16x16x32_bf16 v[48:51], a[68:71], v[208:211], v[48:51]
    v_mfma_f32_16x16x32_bf16 v[52:55], a[72:75], v[208:211], v[52:55]
    buffer_load_dwordx4 a[248:251], v1, s[12:15], s99 offen offset:2048 sc1
    v_mfma_f32_16x16x32_bf16 v[56:59], a[76:79], v[208:211], v[56:59]
    s_waitcnt vmcnt(24)
    v_mfma_f32_16x16x32_bf16 v[60:63], a[60:63], v[212:215], v[60:63]
    s_add_u32 s82, s39, 7168
    v_mfma_f32_16x16x32_bf16 v[64:67], a[64:67], v[212:215], v[64:67]
    buffer_load_dwordx4 v[172:175], v1, s[12:15], s82 offen offset:1024 sc1
    v_mfma_f32_16x16x32_bf16 v[68:71], a[68:71], v[212:215], v[68:71]
    v_mfma_f32_16x16x32_bf16 v[72:75], a[72:75], v[212:215], v[72:75]
    v_mfma_f32_16x16x32_bf16 v[76:79], a[76:79], v[212:215], v[76:79]
    s_waitcnt vmcnt(24)
    v_mfma_f32_16x16x32_bf16 v[80:83], a[60:63], v[216:219], v[80:83]
    s_add_u32 s82, s36, 7168
    v_mfma_f32_16x16x32_bf16 v[84:87], a[64:67], v[216:219], v[84:87]
    buffer_load_dwordx4 v[176:179], v1, s[12:15], s82 offen offset:2048 sc1
    v_mfma_f32_16x16x32_bf16 v[88:91], a[68:71], v[216:219], v[88:91]
    v_mfma_f32_16x16x32_bf16 v[92:95], a[72:75], v[216:219], v[92:95]
    buffer_load_dwordx4 a[252:255], v1, s[12:15], s99 offen offset:3072 sc1
    v_mfma_f32_16x16x32_bf16 v[96:99], a[76:79], v[216:219], v[96:99]
    s_waitcnt vmcnt(25)
    v_mfma_f32_16x16x32_bf16 v[100:103], a[60:63], v[220:223], v[100:103]
    s_add_u32 s82, s37, 7168
    v_mfma_f32_16x16x32_bf16 v[104:107], a[64:67], v[220:223], v[104:107]
    buffer_load_dwordx4 v[180:183], v1, s[12:15], s82 offen offset:2048 sc1
    v_mfma_f32_16x16x32_bf16 v[108:111], a[68:71], v[220:223], v[108:111]
    v_mfma_f32_16x16x32_bf16 v[112:115], a[72:75], v[220:223], v[112:115]
    v_mfma_f32_16x16x32_bf16 v[116:119], a[76:79], v[220:223], v[116:119]
    s_waitcnt vmcnt(25)
    v_mfma_f32_16x16x32_bf16 v[40:43], a[80:83], v[224:227], v[40:43]
    s_add_u32 s82, s38, 7168
    v_mfma_f32_16x16x32_bf16 v[44:47], a[84:87], v[224:227], v[44:47]
    buffer_load_dwordx4 v[184:187], v1, s[12:15], s82 offen offset:2048 sc1
    v_mfma_f32_16x16x32_bf16 v[48:51], a[88:91], v[224:227], v[48:51]
    s_add_u32 s99, s99, 4096
    v_mfma_f32_16x16x32_bf16 v[52:55], a[92:95], v[224:227], v[52:55]
    buffer_load_dwordx4 v[232:235], v1, s[12:15], s99 offen offset:0 sc1
    v_mfma_f32_16x16x32_bf16 v[56:59], a[96:99], v[224:227], v[56:59]
    s_waitcnt vmcnt(26)
    v_mfma_f32_16x16x32_bf16 v[60:63], a[80:83], v[228:231], v[60:63]
    s_add_u32 s82, s39, 7168
    v_mfma_f32_16x16x32_bf16 v[64:67], a[84:87], v[228:231], v[64:67]
    buffer_load_dwordx4 v[188:191], v1, s[12:15], s82 offen offset:2048 sc1
    v_mfma_f32_16x16x32_bf16 v[68:71], a[88:91], v[228:231], v[68:71]
    v_mfma_f32_16x16x32_bf16 v[72:75], a[92:95], v[228:231], v[72:75]
    v_mfma_f32_16x16x32_bf16 v[76:79], a[96:99], v[228:231], v[76:79]
    s_waitcnt vmcnt(26)
    v_mfma_f32_16x16x32_bf16 v[80:83], a[80:83], v[120:123], v[80:83]
    s_add_u32 s82, s36, 10752
    v_mfma_f32_16x16x32_bf16 v[84:87], a[84:87], v[120:123], v[84:87]
    buffer_load_dwordx4 v[192:195], v1, s[12:15], s82 offen offset:0 sc1
    v_mfma_f32_16x16x32_bf16 v[88:91], a[88:91], v[120:123], v[88:91]
    s_lshl_b32 s99, s66, 1
    s_lshr_b32 s43, s64, 1
    s_add_u32 s99, s99, s43
    s_mul_i32 s99, s99, 5120
    s_and_b32 s43, s64, 1
    s_lshl_b32 s43, s43, 3
    s_add_u32 s99, s99, s43
    s_add_u32 s99, s99, 20512768
    v_mfma_f32_16x16x32_bf16 v[92:95], a[92:95], v[120:123], v[92:95]
    buffer_load_dwordx2 v[236:237], v1, s[12:15], s99 offen offset:0 sc1
    v_mfma_f32_16x16x32_bf16 v[96:99], a[96:99], v[120:123], v[96:99]
    s_waitcnt vmcnt(26)
    v_mfma_f32_16x16x32_bf16 v[100:103], a[80:83], v[124:127], v[100:103]
    s_add_u32 s82, s37, 10752
    v_mfma_f32_16x16x32_bf16 v[104:107], a[84:87], v[124:127], v[104:107]
    buffer_load_dwordx4 v[196:199], v1, s[12:15], s82 offen offset:0 sc1
    v_mfma_f32_16x16x32_bf16 v[108:111], a[88:91], v[124:127], v[108:111]
    v_mfma_f32_16x16x32_bf16 v[112:115], a[92:95], v[124:127], v[112:115]
    v_mfma_f32_16x16x32_bf16 v[116:119], a[96:99], v[124:127], v[116:119]
    s_waitcnt vmcnt(26)
    v_mfma_f32_16x16x32_bf16 v[40:43], a[100:103], v[128:131], v[40:43]
    s_add_u32 s82, s38, 10752
    v_mfma_f32_16x16x32_bf16 v[44:47], a[104:107], v[128:131], v[44:47]
    buffer_load_dwordx4 v[200:203], v1, s[12:15], s82 offen offset:0 sc1
    v_mfma_f32_16x16x32_bf16 v[48:51], a[108:111], v[128:131], v[48:51]
    v_mfma_f32_16x16x32_bf16 v[52:55], a[112:115], v[128:131], v[52:55]
    buffer_load_dwordx2 v[238:239], v1, s[12:15], s99 offen offset:1024 sc1
    v_mfma_f32_16x16x32_bf16 v[56:59], a[116:119], v[128:131], v[56:59]
    s_waitcnt vmcnt(26)
    v_mfma_f32_16x16x32_bf16 v[60:63], a[100:103], v[132:135], v[60:63]
    s_add_u32 s82, s39, 10752
    v_mfma_f32_16x16x32_bf16 v[64:67], a[104:107], v[132:135], v[64:67]
    buffer_load_dwordx4 v[204:207], v1, s[12:15], s82 offen offset:0 sc1
    v_mfma_f32_16x16x32_bf16 v[68:71], a[108:111], v[132:135], v[68:71]
    v_mfma_f32_16x16x32_bf16 v[72:75], a[112:115], v[132:135], v[72:75]
    v_mfma_f32_16x16x32_bf16 v[76:79], a[116:119], v[132:135], v[76:79]
    s_waitcnt vmcnt(26)
    v_mfma_f32_16x16x32_bf16 v[80:83], a[100:103], v[136:139], v[80:83]
    s_add_u32 s82, s36, 10752
    v_mfma_f32_16x16x32_bf16 v[84:87], a[104:107], v[136:139], v[84:87]
    buffer_load_dwordx4 v[208:211], v1, s[12:15], s82 offen offset:1024 sc1
    v_mfma_f32_16x16x32_bf16 v[88:91], a[108:111], v[136:139], v[88:91]
    v_mfma_f32_16x16x32_bf16 v[92:95], a[112:115], v[136:139], v[92:95]
    buffer_load_dwordx2 v[240:241], v1, s[12:15], s99 offen offset:2048 sc1
    v_mfma_f32_16x16x32_bf16 v[96:99], a[116:119], v[136:139], v[96:99]
    s_waitcnt vmcnt(26)
    v_mfma_f32_16x16x32_bf16 v[100:103], a[100:103], v[140:143], v[100:103]
    s_add_u32 s82, s37, 10752
    v_mfma_f32_16x16x32_bf16 v[104:107], a[104:107], v[140:143], v[104:107]
    buffer_load_dwordx4 v[212:215], v1, s[12:15], s82 offen offset:1024 sc1
    v_mfma_f32_16x16x32_bf16 v[108:111], a[108:111], v[140:143], v[108:111]
    v_mfma_f32_16x16x32_bf16 v[112:115], a[112:115], v[140:143], v[112:115]
    v_mfma_f32_16x16x32_bf16 v[116:119], a[116:119], v[140:143], v[116:119]
    s_waitcnt vmcnt(26)
    v_mfma_f32_16x16x32_bf16 v[40:43], a[120:123], v[144:147], v[40:43]
    s_add_u32 s82, s38, 10752
    v_mfma_f32_16x16x32_bf16 v[44:47], a[124:127], v[144:147], v[44:47]
    buffer_load_dwordx4 v[216:219], v1, s[12:15], s82 offen offset:1024 sc1
    v_mfma_f32_16x16x32_bf16 v[48:51], a[128:131], v[144:147], v[48:51]
    v_mfma_f32_16x16x32_bf16 v[52:55], a[132:135], v[144:147], v[52:55]
    buffer_load_dwordx2 v[242:243], v1, s[12:15], s99 offen offset:3072 sc1
    v_mfma_f32_16x16x32_bf16 v[56:59], a[136:139], v[144:147], v[56:59]
    s_waitcnt vmcnt(26)
    v_mfma_f32_16x16x32_bf16 v[60:63], a[120:123], v[148:151], v[60:63]
    s_add_u32 s82, s39, 10752
    v_mfma_f32_16x16x32_bf16 v[64:67], a[124:127], v[148:151], v[64:67]
    buffer_load_dwordx4 v[220:223], v1, s[12:15], s82 offen offset:1024 sc1
    v_mfma_f32_16x16x32_bf16 v[68:71], a[128:131], v[148:151], v[68:71]
    v_mfma_f32_16x16x32_bf16 v[72:75], a[132:135], v[148:151], v[72:75]
    v_mfma_f32_16x16x32_bf16 v[76:79], a[136:139], v[148:151], v[76:79]
    s_waitcnt vmcnt(26)
    v_mfma_f32_16x16x32_bf16 v[80:83], a[120:123], v[152:155], v[80:83]
    s_add_u32 s82, s37, 10752
    v_mfma_f32_16x16x32_bf16 v[84:87], a[124:127], v[152:155], v[84:87]
    buffer_load_dwordx4 v[224:227], v1, s[12:15], s82 offen offset:2048 sc1
    v_mfma_f32_16x16x32_bf16 v[88:91], a[128:131], v[152:155], v[88:91]
    s_add_u32 s99, s99, 4096
    v_mfma_f32_16x16x32_bf16 v[92:95], a[132:135], v[152:155], v[92:95]
    buffer_load_dwordx2 v[244:245], v1, s[12:15], s99 offen offset:0 sc1
    v_mfma_f32_16x16x32_bf16 v[96:99], a[136:139], v[152:155], v[96:99]
    s_waitcnt vmcnt(26)
    v_mfma_f32_16x16x32_bf16 v[100:103], a[120:123], v[156:159], v[100:103]
    s_add_u32 s82, s37, 3584
    v_mfma_f32_16x16x32_bf16 v[104:107], a[124:127], v[156:159], v[104:107]
    buffer_load_dwordx2 v[228:229], v3, s[12:15], s37 offen offset:1024 sc1
    buffer_load_dwordx2 v[230:231], v3, s[12:15], s82 offen offset:1024 sc1
    v_mfma_f32_16x16x32_bf16 v[108:111], a[128:131], v[156:159], v[108:111]
    v_mfma_f32_16x16x32_bf16 v[112:115], a[132:135], v[156:159], v[112:115]
    v_mfma_f32_16x16x32_bf16 v[116:119], a[136:139], v[156:159], v[116:119]
    s_waitcnt vmcnt(27)
    v_mfma_f32_16x16x32_bf16 v[40:43], a[140:143], v[160:163], v[40:43]
    s_add_u32 s82, s37, 7168
    v_mfma_f32_16x16x32_bf16 v[44:47], a[144:147], v[160:163], v[44:47]
    buffer_load_dwordx2 v[120:121], v3, s[12:15], s82 offen offset:1024 sc1
    v_mfma_f32_16x16x32_bf16 v[48:51], a[148:151], v[160:163], v[48:51]
    v_mfma_f32_16x16x32_bf16 v[52:55], a[152:155], v[160:163], v[52:55]
    v_mfma_f32_16x16x32_bf16 v[56:59], a[156:159], v[160:163], v[56:59]
    s_waitcnt vmcnt(26)
    v_mfma_f32_16x16x32_bf16 v[60:63], a[140:143], v[164:167], v[60:63]
    s_add_u32 s82, s38, 10752
    v_mfma_f32_16x16x32_bf16 v[64:67], a[144:147], v[164:167], v[64:67]
    buffer_load_dwordx4 v[124:127], v1, s[12:15], s82 offen offset:2048 sc1
    v_mfma_f32_16x16x32_bf16 v[68:71], a[148:151], v[164:167], v[68:71]
    v_mfma_f32_16x16x32_bf16 v[72:75], a[152:155], v[164:167], v[72:75]
    v_mfma_f32_16x16x32_bf16 v[76:79], a[156:159], v[164:167], v[76:79]
    s_waitcnt vmcnt(26)
    v_mfma_f32_16x16x32_bf16 v[80:83], a[140:143], v[168:171], v[80:83]
    s_add_u32 s82, s38, 3584
    v_mfma_f32_16x16x32_bf16 v[84:87], a[144:147], v[168:171], v[84:87]
    buffer_load_dwordx2 v[128:129], v3, s[12:15], s38 offen offset:1024 sc1
    buffer_load_dwordx2 v[130:131], v3, s[12:15], s82 offen offset:1024 sc1
    v_mfma_f32_16x16x32_bf16 v[88:91], a[148:151], v[168:171], v[88:91]
    v_mfma_f32_16x16x32_bf16 v[92:95], a[152:155], v[168:171], v[92:95]
    v_mfma_f32_16x16x32_bf16 v[96:99], a[156:159], v[168:171], v[96:99]
    s_waitcnt vmcnt(26)
    v_mfma_f32_16x16x32_bf16 v[100:103], a[140:143], v[172:175], v[100:103]
    s_add_u32 s82, s38, 7168
    v_mfma_f32_16x16x32_bf16 v[104:107], a[144:147], v[172:175], v[104:107]
    buffer_load_dwordx2 v[132:133], v3, s[12:15], s82 offen offset:1024 sc1
    v_mfma_f32_16x16x32_bf16 v[108:111], a[148:151], v[172:175], v[108:111]
    v_mfma_f32_16x16x32_bf16 v[112:115], a[152:155], v[172:175], v[112:115]
    v_mfma_f32_16x16x32_bf16 v[116:119], a[156:159], v[172:175], v[116:119]
    s_waitcnt vmcnt(26)
    v_mfma_f32_16x16x32_bf16 v[40:43], a[160:163], v[176:179], v[40:43]
    s_add_u32 s82, s39, 10752
    v_mfma_f32_16x16x32_bf16 v[44:47], a[164:167], v[176:179], v[44:47]
    buffer_load_dwordx4 v[136:139], v1, s[12:15], s82 offen offset:2048 sc1
    v_mfma_f32_16x16x32_bf16 v[48:51], a[168:171], v[176:179], v[48:51]
    v_mfma_f32_16x16x32_bf16 v[52:55], a[172:175], v[176:179], v[52:55]
    v_mfma_f32_16x16x32_bf16 v[56:59], a[176:179], v[176:179], v[56:59]
    buffer_load_dword v253, v35, s[12:15], s100 offen sc1
    s_waitcnt vmcnt(26)
    v_mfma_f32_16x16x32_bf16 v[60:63], a[160:163], v[180:183], v[60:63]
    v_lshlrev_b32 v160, 16, v12
    v_and_b32 v161, s73, v12
    s_add_u32 s82, s39, 3584
    v_mfma_f32_16x16x32_bf16 v[64:67], a[164:167], v[180:183], v[64:67]
    buffer_load_dwordx2 v[140:141], v3, s[12:15], s39 offen offset:1024 sc1
    buffer_load_dwordx2 v[142:143], v3, s[12:15], s82 offen offset:1024 sc1
    v_mfma_f32_16x16x32_bf16 v[68:71], a[168:171], v[180:183], v[68:71]
    v_lshlrev_b32 v162, 16, v13
    v_and_b32 v163, s73, v13
    v_mfma_f32_16x16x32_bf16 v[72:75], a[172:175], v[180:183], v[72:75]
    v_lshlrev_b32 v164, 16, v14
    v_and_b32 v165, s73, v14
    v_mfma_f32_16x16x32_bf16 v[76:79], a[176:179], v[180:183], v[76:79]
    v_lshlrev_b32 v166, 16, v15
    s_waitcnt vmcnt(27)
    v_mfma_f32_16x16x32_bf16 v[80:83], a[160:163], v[184:187], v[80:83]
    v_and_b32 v167, s73, v15
    v_lshlrev_b32 v168, 16, v16
    s_add_u32 s82, s39, 7168
    v_mfma_f32_16x16x32_bf16 v[84:87], a[164:167], v[184:187], v[84:87]
    buffer_load_dwordx2 v[144:145], v3, s[12:15], s82 offen offset:1024 sc1
    v_mfma_f32_16x16x32_bf16 v[88:91], a[168:171], v[184:187], v[88:91]
    v_and_b32 v169, s73, v16
    v_lshlrev_b32 v170, 16, v17
    v_mfma_f32_16x16x32_bf16 v[92:95], a[172:175], v[184:187], v[92:95]
    v_and_b32 v171, s73, v17
    v_lshlrev_b32 v172, 16, v18
    v_mfma_f32_16x16x32_bf16 v[96:99], a[176:179], v[184:187], v[96:99]
    v_and_b32 v173, s73, v18
    s_waitcnt vmcnt(26)
    v_mfma_f32_16x16x32_bf16 v[100:103], a[160:163], v[188:191], v[100:103]
    v_lshlrev_b32 v174, 16, v19
    v_and_b32 v175, s73, v19
    s_add_u32 s82, s36, 10752
    v_mfma_f32_16x16x32_bf16 v[104:107], a[164:167], v[188:191], v[104:107]
    buffer_load_dwordx4 v[148:151], v1, s[12:15], s82 offen offset:2048 sc1
    v_mfma_f32_16x16x32_bf16 v[108:111], a[168:171], v[188:191], v[108:111]
    v_lshlrev_b32 v176, 16, v20
    v_and_b32 v177, s73, v20
    v_mfma_f32_16x16x32_bf16 v[112:115], a[172:175], v[188:191], v[112:115]
    v_lshlrev_b32 v178, 16, v21
    v_and_b32 v179, s73, v21
    v_mfma_f32_16x16x32_bf16 v[116:119], a[176:179], v[188:191], v[116:119]
    s_waitcnt vmcnt(26)
    v_mfma_f32_16x16x32_bf16 v[40:43], a[180:183], v[192:195], v[40:43]
    s_add_u32 s82, s36, 3584
    v_mfma_f32_16x16x32_bf16 v[44:47], a[184:187], v[192:195], v[44:47]
    buffer_load_dwordx2 v[152:153], v3, s[12:15], s36 offen offset:1024 sc1
    buffer_load_dwordx2 v[154:155], v3, s[12:15], s82 offen offset:1024 sc1
    v_mfma_f32_16x16x32_bf16 v[48:51], a[188:191], v[192:195], v[48:51]
    v_mfma_f32_16x16x32_bf16 v[52:55], a[192:195], v[192:195], v[52:55]
    v_mfma_f32_16x16x32_bf16 v[56:59], a[196:199], v[192:195], v[56:59]
    s_waitcnt vmcnt(26)
    v_mfma_f32_16x16x32_bf16 v[60:63], a[180:183], v[196:199], v[60:63]
    s_add_u32 s82, s36, 7168
    v_mfma_f32_16x16x32_bf16 v[64:67], a[184:187], v[196:199], v[64:67]
    buffer_load_dwordx2 v[156:157], v3, s[12:15], s82 offen offset:1024 sc1
    v_mfma_f32_16x16x32_bf16 v[68:71], a[188:191], v[196:199], v[68:71]
    v_mfma_f32_16x16x32_bf16 v[72:75], a[192:195], v[196:199], v[72:75]
    v_mfma_f32_16x16x32_bf16 v[76:79], a[196:199], v[196:199], v[76:79]
    s_waitcnt vmcnt(26)
    v_mfma_f32_16x16x32_bf16 v[80:83], a[180:183], v[200:203], v[80:83]
    v_fma_f32 v180, v160, v33, v32
    v_fma_f32 v181, v161, v33, v32
    v_mfma_f32_16x16x32_bf16 v[84:87], a[184:187], v[200:203], v[84:87]
    v_fma_f32 v182, v162, v33, v32
    v_fma_f32 v183, v163, v33, v32
    v_mfma_f32_16x16x32_bf16 v[88:91], a[188:191], v[200:203], v[88:91]
    v_fma_f32 v184, v164, v33, v32
    v_fma_f32 v185, v165, v33, v32
    v_mfma_f32_16x16x32_bf16 v[92:95], a[192:195], v[200:203], v[92:95]
    v_fma_f32 v186, v166, v33, v32
    v_fma_f32 v187, v167, v33, v32
    v_mfma_f32_16x16x32_bf16 v[96:99], a[196:199], v[200:203], v[96:99]
    v_fma_f32 v188, v168, v33, v32
    s_waitcnt vmcnt(24)
    v_mfma_f32_16x16x32_bf16 v[100:103], a[180:183], v[204:207], v[100:103]
    v_fma_f32 v189, v169, v33, v32
    v_fma_f32 v190, v170, v33, v32
    v_mfma_f32_16x16x32_bf16 v[104:107], a[184:187], v[204:207], v[104:107]
    v_fma_f32 v191, v171, v33, v32
    v_fma_f32 v192, v172, v33, v32
    v_mfma_f32_16x16x32_bf16 v[108:111], a[188:191], v[204:207], v[108:111]
    v_fma_f32 v193, v173, v33, v32
    v_fma_f32 v194, v174, v33, v32
    v_mfma_f32_16x16x32_bf16 v[112:115], a[192:195], v[204:207], v[112:115]
    v_fma_f32 v195, v175, v33, v32
    v_fma_f32 v196, v176, v33, v32
    v_mfma_f32_16x16x32_bf16 v[116:119], a[196:199], v[204:207], v[116:119]
    v_fma_f32 v197, v177, v33, v32
    s_waitcnt vmcnt(7)
    v_cmp_ne_u32 vcc, 1, v253
    s_cbranch_vccz L_ok_57
    s_mov_b32 s79, 0
L_spin_56:
    s_sleep 16
    buffer_load_dword v253, v35, s[12:15], s100 offen sc1
    s_add_u32 s79, s79, 1
    s_cmp_gt_u32 s79, 200000
    s_cbranch_scc1 L_ok_57
    s_waitcnt vmcnt(0)
    v_cmp_ne_u32 vcc, 1, v253
    s_cbranch_vccnz L_spin_56
L_ok_57:
    s_add_u32 m0, s60, 143360
    s_nop 0
    buffer_load_dwordx4 v251, s[12:15], s101 offen sc1 lds
    s_add_u32 s101, s101, 32768
    s_add_u32 m0, s60, 144384
    s_nop 0
    buffer_load_dwordx4 v251, s[12:15], s101 offen sc1 lds
    s_add_u32 s101, s101, 32768
    s_add_u32 m0, s60, 145408
    s_mov_b32 exec_hi, 0
    buffer_load_dwordx4 v251, s[12:15], s101 offen sc1 lds
    s_mov_b64 exec, -1
    v_mfma_f32_16x16x32_bf16 v[40:43], a[200:203], v[208:211], v[40:43]
    v_fma_f32 v198, v178, v33, v32
    v_fma_f32 v199, v179, v33, v32
    v_mfma_f32_16x16x32_bf16 v[44:47], a[204:207], v[208:211], v[44:47]
    v_mfma_f32_16x16x32_bf16 v[48:51], a[208:211], v[208:211], v[48:51]
    v_mfma_f32_16x16x32_bf16 v[52:55], a[212:215], v[208:211], v[52:55]
    v_mfma_f32_16x16x32_bf16 v[56:59], a[216:219], v[208:211], v[56:59]
    v_mfma_f32_16x16x32_bf16 v[60:63], a[200:203], v[212:215], v[60:63]
    v_mfma_f32_16x16x32_bf16 v[64:67], a[204:207], v[212:215], v[64:67]
    v_mfma_f32_16x16x32_bf16 v[68:71], a[208:211], v[212:215], v[68:71]
    v_mfma_f32_16x16x32_bf16 v[72:75], a[212:215], v[212:215], v[72:75]
    v_mfma_f32_16x16x32_bf16 v[76:79], a[216:219], v[212:215], v[76:79]
    v_mfma_f32_16x16x32_bf16 v[80:83], a[200:203], v[216:219], v[80:83]
    v_mfma_f32_16x16x32_bf16 v[84:87], a[204:207], v[216:219], v[84:87]
    v_mfma_f32_16x16x32_bf16 v[88:91], a[208:211], v[216:219], v[88:91]
    v_mfma_f32_16x16x32_bf16 v[92:95], a[212:215], v[216:219], v[92:95]
    v_mfma_f32_16x16x32_bf16 v[96:99], a[216:219], v[216:219], v[96:99]
    v_mfma_f32_16x16x32_bf16 v[100:103], a[200:203], v[220:223], v[100:103]
    v_lshlrev_b32 v200, 16, v22
    v_and_b32 v201, s73, v22
    v_mfma_f32_16x16x32_bf16 v[104:107], a[204:207], v[220:223], v[104:107]
    v_lshlrev_b32 v202, 16, v23
    v_and_b32 v203, s73, v23
    v_mfma_f32_16x16x32_bf16 v[108:111], a[208:211], v[220:223], v[108:111]
    v_lshlrev_b32 v204, 16, v24
    v_and_b32 v205, s73, v24
    v_mfma_f32_16x16x32_bf16 v[112:115], a[212:215], v[220:223], v[112:115]
    v_lshlrev_b32 v206, 16, v25
    v_and_b32 v207, s73, v25
    v_mfma_f32_16x16x32_bf16 v[116:119], a[216:219], v[220:223], v[116:119]
    v_lshlrev_b32 v208, 16, v26
    v_mfma_f32_16x16x32_bf16 v[60:63], a[220:223], v[224:227], v[60:63]
    v_and_b32 v209, s73, v26
    v_lshlrev_b32 v210, 16, v27
    v_mfma_f32_16x16x32_bf16 v[64:67], a[224:227], v[224:227], v[64:67]
    v_and_b32 v211, s73, v27
    v_lshlrev_b32 v212, 16, v28
    v_mfma_f32_16x16x32_bf16 v[68:71], a[228:231], v[224:227], v[68:71]
    v_and_b32 v213, s73, v28
    v_lshlrev_b32 v214, 16, v29
    v_mfma_f32_16x16x32_bf16 v[72:75], a[232:235], v[224:227], v[72:75]
    v_and_b32 v215, s73, v29
    v_lshlrev_b32 v216, 16, v30
    v_mfma_f32_16x16x32_bf16 v[76:79], a[236:239], v[224:227], v[76:79]
    v_and_b32 v217, s73, v30
    v_mfma_f32_16x16x32_bf16 v[60:63], a[240:243], v[228:231], v[60:63]
    v_lshlrev_b32 v218, 16, v31
    v_and_b32 v219, s73, v31
    v_mfma_f32_16x16x32_bf16 v[64:67], a[244:247], v[228:231], v[64:67]
    v_mfma_f32_16x16x32_bf16 v[68:71], a[248:251], v[228:231], v[68:71]
    v_mfma_f32_16x16x32_bf16 v[72:75], a[252:255], v[228:231], v[72:75]
    v_mfma_f32_16x16x32_bf16 v[76:79], v[232:235], v[228:231], v[76:79]
    v_mfma_f32_16x16x16_bf16 v[60:63], v[236:237], v[120:121], v[60:63]
    v_mfma_f32_16x16x16_bf16 v[64:67], v[238:239], v[120:121], v[64:67]
    v_mfma_f32_16x16x16_bf16 v[68:71], v[240:241], v[120:121], v[68:71]
    v_mfma_f32_16x16x16_bf16 v[72:75], v[242:243], v[120:121], v[72:75]
    v_mfma_f32_16x16x16_bf16 v[76:79], v[244:245], v[120:121], v[76:79]
    s_waitcnt vmcnt(0)
    s_barrier
    ds_read_b64_tr_b16 v[12:13], v246 offset:0
    ds_read_b64_tr_b16 v[14:15], v246 offset:2048
    ds_read_b64_tr_b16 v[16:17], v246 offset:4096
    ds_read_b64_tr_b16 v[18:19], v246 offset:6144
    ds_read_b64_tr_b16 v[20:21], v246 offset:8192
    v_mfma_f32_16x16x32_bf16 v[80:83], a[220:223], v[124:127], v[80:83]
    v_mfma_f32_16x16x32_bf16 v[84:87], a[224:227], v[124:127], v[84:87]
    v_mfma_f32_16x16x32_bf16 v[88:91], a[228:231], v[124:127], v[88:91]
    ds_write_b128 v248, v[60:63] offset:0
    v_mfma_f32_16x16x32_bf16 v[92:95], a[232:235], v[124:127], v[92:95]
    v_mfma_f32_16x16x32_bf16 v[96:99], a[236:239], v[124:127], v[96:99]
    ds_write_b128 v248, v[64:67] offset:1024
    v_mfma_f32_16x16x32_bf16 v[80:83], a[240:243], v[128:131], v[80:83]
    v_mfma_f32_16x16x32_bf16 v[84:87], a[244:247], v[128:131], v[84:87]
    v_mfma_f32_16x16x32_bf16 v[88:91], a[248:251], v[128:131], v[88:91]
    ds_write_b128 v248, v[68:71] offset:2048
    v_mfma_f32_16x16x32_bf16 v[92:95], a[252:255], v[128:131], v[92:95]
    v_mfma_f32_16x16x32_bf16 v[96:99], v[232:235], v[128:131], v[96:99]
    ds_write_b128 v248, v[72:75] offset:3072
    v_mfma_f32_16x16x16_bf16 v[80:83], v[236:237], v[132:133], v[80:83]
    s_waitcnt lgkmcnt(4)
    v_lshlrev_b32 v22, 16, v12
    v_and_b32 v23, s73, v12
    v_mfma_f32_16x16x16_bf16 v[84:87], v[238:239], v[132:133], v[84:87]
    v_mul_f32 v180, v180, v22
    v_mul_f32 v181, v181, v23
    v_mfma_f32_16x16x16_bf16 v[88:91], v[240:241], v[132:133], v[88:91]
    ds_write_b128 v248, v[76:79] offset:4096
    v_mfma_f32_16x16x16_bf16 v[92:95], v[242:243], v[132:133], v[92:95]
    v_lshlrev_b32 v22, 16, v13
    v_and_b32 v23, s73, v13
    v_mfma_f32_16x16x16_bf16 v[96:99], v[244:245], v[132:133], v[96:99]
    v_mul_f32 v182, v182, v22
    v_mfma_f32_16x16x32_bf16 v[100:103], a[220:223], v[136:139], v[100:103]
    v_mul_f32 v183, v183, v23
    v_lshlrev_b32 v22, 16, v14
    v_mfma_f32_16x16x32_bf16 v[104:107], a[224:227], v[136:139], v[104:107]
    v_and_b32 v23, s73, v14
    v_mul_f32 v184, v184, v22
    v_mfma_f32_16x16x32_bf16 v[108:111], a[228:231], v[136:139], v[108:111]
    ds_write_b128 v249, v[80:83] offset:0
    v_mfma_f32_16x16x32_bf16 v[112:115], a[232:235], v[136:139], v[112:115]
    v_mul_f32 v185, v185, v23
    v_lshlrev_b32 v22, 16, v15
    v_mfma_f32_16x16x32_bf16 v[116:119], a[236:239], v[136:139], v[116:119]
    ds_write_b128 v249, v[84:87] offset:1024
    v_mfma_f32_16x16x32_bf16 v[100:103], a[240:243], v[140:143], v[100:103]
    v_and_b32 v23, s73, v15
    v_mul_f32 v186, v186, v22
    v_mfma_f32_16x16x32_bf16 v[104:107], a[244:247], v[140:143], v[104:107]
    v_mul_f32 v187, v187, v23
    v_lshlrev_b32 v22, 16, v16
    v_mfma_f32_16x16x32_bf16 v[108:111], a[248:251], v[140:143], v[108:111]
    ds_write_b128 v249, v[88:91] offset:2048
    v_mfma_f32_16x16x32_bf16 v[112:115], a[252:255], v[140:143], v[112:115]
    v_and_b32 v23, s73, v16
    v_mul_f32 v188, v188, v22
    v_mfma_f32_16x16x32_bf16 v[116:119], v[232:235], v[140:143], v[116:119]
    ds_write_b128 v249, v[92:95] offset:3072
    v_mfma_f32_16x16x16_bf16 v[100:103], v[236:237], v[144:145], v[100:103]
    v_mul_f32 v189, v189, v23
    v_lshlrev_b32 v22, 16, v17
    v_mfma_f32_16x16x16_bf16 v[104:107], v[238:239], v[144:145], v[104:107]
    v_and_b32 v23, s73, v17
    v_mul_f32 v190, v190, v22
    v_mfma_f32_16x16x16_bf16 v[108:111], v[240:241], v[144:145], v[108:111]
    ds_write_b128 v249, v[96:99] offset:4096
    v_mfma_f32_16x16x16_bf16 v[112:115], v[242:243], v[144:145], v[112:115]
    v_mul_f32 v191, v191, v23
    v_lshlrev_b32 v22, 16, v18
    v_mfma_f32_16x16x16_bf16 v[116:119], v[244:245], v[144:145], v[116:119]
    v_and_b32 v23, s73, v18
    v_mfma_f32_16x16x32_bf16 v[40:43], a[220:223], v[148:151], v[40:43]
    v_mul_f32 v192, v192, v22
    v_mul_f32 v193, v193, v23
    v_mfma_f32_16x16x32_bf16 v[44:47], a[224:227], v[148:151], v[44:47]
    v_lshlrev_b32 v22, 16, v19
    v_and_b32 v23, s73, v19
    v_mfma_f32_16x16x32_bf16 v[48:51], a[228:231], v[148:151], v[48:51]
    ds_write_b128 v250, v[100:103] offset:0
    v_mfma_f32_16x16x32_bf16 v[52:55], a[232:235], v[148:151], v[52:55]
    v_mul_f32 v194, v194, v22
    v_mul_f32 v195, v195, v23
    v_mfma_f32_16x16x32_bf16 v[56:59], a[236:239], v[148:151], v[56:59]
    ds_write_b128 v250, v[104:107] offset:1024
    v_mfma_f32_16x16x32_bf16 v[40:43], a[240:243], v[152:155], v[40:43]
    v_lshlrev_b32 v22, 16, v20
    v_and_b32 v23, s73, v20
    v_mfma_f32_16x16x32_bf16 v[44:47], a[244:247], v[152:155], v[44:47]
    v_mul_f32 v196, v196, v22
    v_mul_f32 v197, v197, v23
    v_mfma_f32_16x16x32_bf16 v[48:51], a[248:251], v[152:155], v[48:51]
    ds_write_b128 v250, v[108:111] offset:2048
    v_mfma_f32_16x16x32_bf16 v[52:55], a[252:255], v[152:155], v[52:55]
    v_lshlrev_b32 v22, 16, v21
    v_and_b32 v23, s73, v21
    v_mfma_f32_16x16x32_bf16 v[56:59], v[232:235], v[152:155], v[56:59]
    ds_write_b128 v250, v[112:115] offset:3072
    v_mfma_f32_16x16x16_bf16 v[40:43], v[236:237], v[156:157], v[40:43]
    v_mul_f32 v198, v198, v22
    v_mul_f32 v199, v199, v23
    v_mfma_f32_16x16x16_bf16 v[44:47], v[238:239], v[156:157], v[44:47]
    v_mfma_f32_16x16x16_bf16 v[48:51], v[240:241], v[156:157], v[48:51]
    ds_write_b128 v250, v[116:119] offset:4096
    v_mfma_f32_16x16x16_bf16 v[52:55], v[242:243], v[156:157], v[52:55]
    v_mfma_f32_16x16x16_bf16 v[56:59], v[244:245], v[156:157], v[56:59]
    s_waitcnt lgkmcnt(0)
    s_barrier
    ds_read_b128 v[60:63], v247 offset:0
    ds_read_b128 v[64:67], v247 offset:1024
    ds_read_b128 v[68:71], v247 offset:2048
    ds_read_b128 v[72:75], v247 offset:3072
    ds_read_b128 v[76:79], v247 offset:4096
    ds_read_b128 v[80:83], v247 offset:5120
    ds_read_b128 v[84:87], v247 offset:6144
    ds_read_b128 v[88:91], v247 offset:7168
    ds_read_b128 v[92:95], v247 offset:8192
    ds_read_b128 v[96:99], v247 offset:9216
    ds_read_b128 v[100:103], v247 offset:10240
    ds_read_b128 v[104:107], v247 offset:11264
    ds_read_b128 v[108:111], v247 offset:12288
    ds_read_b128 v[112:115], v247 offset:13312
    ds_read_b128 v[116:119], v247 offset:14336
    v_pk_add_f32 v[40:41], v[40:41], v[200:201]
    v_pk_add_f32 v[42:43], v[42:43], v[202:203]
    v_pk_add_f32 v[44:45], v[44:45], v[204:205]
    v_pk_add_f32 v[46:47], v[46:47], v[206:207]
    v_pk_add_f32 v[48:49], v[48:49], v[208:209]
    v_pk_add_f32 v[50:51], v[50:51], v[210:211]
    v_pk_add_f32 v[52:53], v[52:53], v[212:213]
    v_pk_add_f32 v[54:55], v[54:55], v[214:215]
    v_pk_add_f32 v[56:57], v[56:57], v[216:217]
    v_pk_add_f32 v[58:59], v[58:59], v[218:219]
    v_mul_u32_u24 v248, 160, v2
    v_lshl_add_u32 v248, v37, 3, v248
    s_add_u32 s60, s60, 153600
    v_add_u32 v248, s60, v248
    v_add_u32 v249, s60, v1
    s_mul_i32 s76, s67, 1280
    s_add_u32 s76, s76, s75
    s_waitcnt lgkmcnt(10)
    v_pk_add_f32 v[40:41], v[40:41], v[60:61]
    v_pk_add_f32 v[42:43], v[42:43], v[62:63]
    v_pk_add_f32 v[44:45], v[44:45], v[64:65]
    v_pk_add_f32 v[46:47], v[46:47], v[66:67]
    v_pk_add_f32 v[48:49], v[48:49], v[68:69]
    v_pk_add_f32 v[50:51], v[50:51], v[70:71]
    v_pk_add_f32 v[52:53], v[52:53], v[72:73]
    v_pk_add_f32 v[54:55], v[54:55], v[74:75]
    v_pk_add_f32 v[56:57], v[56:57], v[76:77]
    v_pk_add_f32 v[58:59], v[58:59], v[78:79]
    s_waitcnt lgkmcnt(5)
    v_pk_add_f32 v[40:41], v[40:41], v[80:81]
    v_pk_add_f32 v[42:43], v[42:43], v[82:83]
    v_pk_add_f32 v[44:45], v[44:45], v[84:85]
    v_pk_add_f32 v[46:47], v[46:47], v[86:87]
    v_pk_add_f32 v[48:49], v[48:49], v[88:89]
    v_pk_add_f32 v[50:51], v[50:51], v[90:91]
    v_pk_add_f32 v[52:53], v[52:53], v[92:93]
    v_pk_add_f32 v[54:55], v[54:55], v[94:95]
    v_pk_add_f32 v[56:57], v[56:57], v[96:97]
    v_pk_add_f32 v[58:59], v[58:59], v[98:99]
    s_waitcnt lgkmcnt(0)
    v_pk_add_f32 v[40:41], v[40:41], v[100:101]
    v_pk_add_f32 v[42:43], v[42:43], v[102:103]
    v_pk_add_f32 v[44:45], v[44:45], v[104:105]
    v_pk_add_f32 v[46:47], v[46:47], v[106:107]
    v_pk_add_f32 v[48:49], v[48:49], v[108:109]
    v_pk_add_f32 v[50:51], v[50:51], v[110:111]
    v_pk_add_f32 v[52:53], v[52:53], v[112:113]
    v_pk_add_f32 v[54:55], v[54:55], v[114:115]
    v_pk_add_f32 v[56:57], v[56:57], v[116:117]
    v_pk_add_f32 v[58:59], v[58:59], v[118:119]
    v_pk_mul_f32 v[120:121], v[40:41], s[70:71] op_sel_hi:[1,0]
    v_pk_mul_f32 v[122:123], v[42:43], s[70:71] op_sel_hi:[1,0]
    v_pk_mul_f32 v[124:125], v[44:45], s[70:71] op_sel_hi:[1,0]
    v_pk_mul_f32 v[126:127], v[46:47], s[70:71] op_sel_hi:[1,0]
    v_pk_mul_f32 v[128:129], v[48:49], s[70:71] op_sel_hi:[1,0]
    v_pk_mul_f32 v[130:131], v[50:51], s[70:71] op_sel_hi:[1,0]
    v_pk_mul_f32 v[132:133], v[52:53], s[70:71] op_sel_hi:[1,0]
    v_pk_mul_f32 v[134:135], v[54:55], s[70:71] op_sel_hi:[1,0]
    v_pk_mul_f32 v[136:137], v[56:57], s[70:71] op_sel_hi:[1,0]
    v_pk_mul_f32 v[138:139], v[58:59], s[70:71] op_sel_hi:[1,0]
    v_exp_f32 v120, v120
    v_exp_f32 v121, v121
    v_exp_f32 v122, v122
    v_exp_f32 v123, v123
    v_exp_f32 v124, v124
    v_exp_f32 v125, v125
    v_exp_f32 v126, v126
    v_exp_f32 v127, v127
    v_exp_f32 v128, v128
    v_exp_f32 v129, v129
    v_exp_f32 v130, v130
    v_exp_f32 v131, v131
    v_exp_f32 v132, v132
    v_exp_f32 v133, v133
    v_exp_f32 v134, v134
    v_exp_f32 v135, v135
    v_exp_f32 v136, v136
    v_exp_f32 v137, v137
    v_exp_f32 v138, v138
    v_exp_f32 v139, v139
    v_pk_mul_f32 v[40:41], v[40:41], v[180:181]
    v_pk_add_f32 v[120:121], v[120:121], 1.0 op_sel_hi:[1,0]
    v_pk_mul_f32 v[42:43], v[42:43], v[182:183]
    v_pk_add_f32 v[122:123], v[122:123], 1.0 op_sel_hi:[1,0]
    v_pk_mul_f32 v[44:45], v[44:45], v[184:185]
    v_pk_add_f32 v[124:125], v[124:125], 1.0 op_sel_hi:[1,0]
    v_pk_mul_f32 v[46:47], v[46:47], v[186:187]
    v_pk_add_f32 v[126:127], v[126:127], 1.0 op_sel_hi:[1,0]
    v_pk_mul_f32 v[48:49], v[48:49], v[188:189]
    v_pk_add_f32 v[128:129], v[128:129], 1.0 op_sel_hi:[1,0]
    v_pk_mul_f32 v[50:51], v[50:51], v[190:191]
    v_pk_add_f32 v[130:131], v[130:131], 1.0 op_sel_hi:[1,0]
    v_pk_mul_f32 v[52:53], v[52:53], v[192:193]
    v_pk_add_f32 v[132:133], v[132:133], 1.0 op_sel_hi:[1,0]
    v_pk_mul_f32 v[54:55], v[54:55], v[194:195]
    v_pk_add_f32 v[134:135], v[134:135], 1.0 op_sel_hi:[1,0]
    v_pk_mul_f32 v[56:57], v[56:57], v[196:197]
    v_pk_add_f32 v[136:137], v[136:137], 1.0 op_sel_hi:[1,0]
    v_pk_mul_f32 v[58:59], v[58:59], v[198:199]
    v_pk_add_f32 v[138:139], v[138:139], 1.0 op_sel_hi:[1,0]
    v_rcp_f32 v120, v120
    v_rcp_f32 v121, v121
    v_rcp_f32 v122, v122
    v_rcp_f32 v123, v123
    v_rcp_f32 v124, v124
    v_rcp_f32 v125, v125
    v_rcp_f32 v126, v126
    v_rcp_f32 v127, v127
    v_rcp_f32 v128, v128
    v_rcp_f32 v129, v129
    v_rcp_f32 v130, v130
    v_rcp_f32 v131, v131
    v_rcp_f32 v132, v132
    v_rcp_f32 v133, v133
    v_rcp_f32 v134, v134
    v_rcp_f32 v135, v135
    v_rcp_f32 v136, v136
    v_rcp_f32 v137, v137
    v_rcp_f32 v138, v138
    v_rcp_f32 v139, v139
    v_pk_fma_f32 v[120:121], v[120:121], v[40:41], v[160:161]
    v_pk_fma_f32 v[122:123], v[122:123], v[42:43], v[162:163]
    v_pk_fma_f32 v[124:125], v[124:125], v[44:45], v[164:165]
    v_pk_fma_f32 v[126:127], v[126:127], v[46:47], v[166:167]
    v_pk_fma_f32 v[128:129], v[128:129], v[48:49], v[168:169]
    v_pk_fma_f32 v[130:131], v[130:131], v[50:51], v[170:171]
    v_pk_fma_f32 v[132:133], v[132:133], v[52:53], v[172:173]
    v_pk_fma_f32 v[134:135], v[134:135], v[54:55], v[174:175]
    v_pk_fma_f32 v[136:137], v[136:137], v[56:57], v[176:177]
    v_pk_fma_f32 v[138:139], v[138:139], v[58:59], v[178:179]
    v_cvt_pk_bf16_f32 v100, v120, v121
    v_cvt_pk_bf16_f32 v101, v122, v123
    ds_write_b64 v248, v[100:101] offset:0
    v_cvt_pk_bf16_f32 v102, v124, v125
    v_cvt_pk_bf16_f32 v103, v126, v127
    ds_write_b64 v248, v[102:103] offset:32
    v_cvt_pk_bf16_f32 v104, v128, v129
    v_cvt_pk_bf16_f32 v105, v130, v131
    ds_write_b64 v248, v[104:105] offset:64
    v_cvt_pk_bf16_f32 v106, v132, v133
    v_cvt_pk_bf16_f32 v107, v134, v135
    ds_write_b64 v248, v[106:107] offset:96
    v_cvt_pk_bf16_f32 v108, v136, v137
    v_cvt_pk_bf16_f32 v109, v138, v139
    ds_write_b64 v248, v[108:109] offset:128
    ds_read_b128 v[140:143], v249 offset:0
    ds_read_b128 v[144:147], v249 offset:1024
    s_mov_b32 exec_hi, 0
    ds_read_b128 v[148:151], v249 offset:2048
    s_mov_b64 exec, -1
    s_waitcnt lgkmcnt(2)
    buffer_store_dwordx4 v[140:143], v4, s[28:31], s76 offen
    s_waitcnt lgkmcnt(1)
    buffer_store_dwordx4 v[144:147], v5, s[28:31], s76 offen
    s_waitcnt lgkmcnt(0)
    s_mov_b32 exec_hi, 0
    buffer_store_dwordx4 v[148:151], v6, s[28:31], s76 offen
    s_mov_b64 exec, -1
L_end:
    s_endpgm
.p2align 7
.type pp_table,@object
pp_table:
.long 0x1,0xd800,0x1480000,0x1480400,0x1480800,0x1480c00,0xffff01e8,0xffffffff
.long 0x81,0xd880,0x1481000,0x1481400,0x1481800,0x14a3000,0x1e901e8,0xffffffff
.long 0x101,0xd900,0x14a3400,0x14a3800,0x14a3c00,0x14a4000,0xffff01e9,0xffffffff
.long 0x181,0xd980,0x14a4400,0x14a4800,0x14c6000,0x14c6400,0x1ea01e9,0xffffffff
.long 0x201,0xda00,0x14c6800,0x14c6c00,0x14c7000,0x14c7400,0xffff01ea,0xffffffff
.long 0x281,0xda80,0x14c7800,0x14e9000,0x14e9400,0x14e9800,0x1eb01ea,0xffffffff
.long 0x301,0xdb00,0x14e9c00,0x14ea000,0x14ea400,0x150c000,0x1ec01eb,0xffffffff
.long 0x381,0xdb80,0x150c400,0x150c800,0x150cc00,0x150d000,0xffff01ec,0xffffffff
.long 0x401,0xdc00,0x150d400,0x150d800,0x152f000,0x152f400,0x1ed01ec,0xffffffff
.long 0x481,0xdc80,0x152f800,0x152fc00,0x1530000,0x1530400,0xffff01ed,0xffffffff
.long 0x501,0xdd00,0x1530800,0x1552000,0x1552400,0x1552800,0x1ee01ed,0xffffffff
.long 0x581,0xdd80,0x1552c00,0x1553000,0x1553400,0x1553800,0xffff01ee,0xffffffff
.long 0x601,0xde00,0x1575000,0x1575400,0x1575800,0x1575c00,0xffff01ef,0xffffffff
.long 0x681,0xde80,0x1576000,0x1576400,0x1598000,0x1598400,0x1f001ef,0xffffffff
.long 0x701,0xdf00,0x1598800,0x1598c00,0x1599000,0x1599400,0xffff01f0,0xffffffff
.long 0x781,0xdf80,0x1599800,0x15bb000,0x15bb400,0x15bb800,0x1f101f0,0xffffffff
.long 0x801,0xe000,0x15bbc00,0x15bc000,0x15bc400,0x15bc800,0xffff01f1,0xffffffff
.long 0x881,0xe080,0x15de000,0x15de400,0x15de800,0x15dec00,0xffff01f2,0xffffffff
.long 0x901,0xe100,0x15df000,0x15df400,0x15df800,0x1601000,0x1f301f2,0xffffffff
.long 0x981,0xe180,0x1601400,0x1601800,0x1601c00,0x1602000,0xffff01f3,0xffffffff
.long 0xa01,0xe200,0x1602400,0x1624000,0x1624400,0x1624800,0x1f401f3,0xffffffff
.long 0xa81,0xe280,0x1624c00,0x1625000,0x1625400,0x1625800,0xffff01f4,0xffffffff
.long 0xb01,0xe300,0x1647000,0x1647400,0x1647800,0x1647c00,0xffff01f5,0xffffffff
.long 0xb81,0xe380,0x1648000,0x1648400,0x1648800,0x166a000,0x1f601f5,0xffffffff
.long 0xc01,0xe400,0x166a400,0x166a800,0x166ac00,0x166b000,0xffff01f6,0xffffffff
.long 0xc81,0xe480,0x166b400,0x166b800,0x168d000,0x168d400,0x1f701f6,0xffffffff
.long 0xd01,0xe500,0x168d800,0x168dc00,0x168e000,0x168e400,0xffff01f7,0xffffffff
.long 0x1b001,0x28800,0x1481c00,0x1482000,0x1482400,0x1482800,0xffff01e8,0xffffffff
.long 0x1b081,0x28880,0x1482c00,0x1483000,0x1483400,0x14a4c00,0x1e901e8,0xffffffff
.long 0x1b101,0x28900,0x14a5000,0x14a5400,0x14a5800,0x14a5c00,0xffff01e9,0xffffffff
.long 0x1b181,0x28980,0x14a6000,0x14a6400,0x14c7c00,0x14c8000,0x1ea01e9,0xffffffff
.long 0x1b201,0x28a00,0x14c8400,0x14c8800,0x14c8c00,0x14c9000,0xffff01ea,0xffffffff
.long 0x1b281,0x28a80,0x14c9400,0x14eac00,0x14eb000,0x14eb400,0x1eb01ea,0xffffffff
.long 0x1b301,0x28b00,0x14eb800,0x14ebc00,0x14ec000,0x150dc00,0x1ec01eb,0xffffffff
.long 0x1b381,0x28b80,0x150e000,0x150e400,0x150e800,0x150ec00,0xffff01ec,0xffffffff
.long 0x1b401,0x28c00,0x150f000,0x150f400,0x1530c00,0x1531000,0x1ed01ec,0xffffffff
.long 0x1b481,0x28c80,0x1531400,0x1531800,0x1531c00,0x1532000,0xffff01ed,0xffffffff
.long 0x1b501,0x28d00,0x1532400,0x1553c00,0x1554000,0x1554400,0x1ee01ed,0xffffffff
.long 0x1b581,0x28d80,0x1554800,0x1554c00,0x1555000,0x1555400,0xffff01ee,0xffffffff
.long 0x1b601,0x28e00,0x1576c00,0x1577000,0x1577400,0x1577800,0xffff01ef,0xffffffff
.long 0x1b681,0x28e80,0x1577c00,0x1578000,0x1599c00,0x159a000,0x1f001ef,0xffffffff
.long 0x1b701,0x28f00,0x159a400,0x159a800,0x159ac00,0x159b000,0xffff01f0,0xffffffff
.long 0x1b781,0x28f80,0x159b400,0x15bcc00,0x15bd000,0x15bd400,0x1f101f0,0xffffffff
.long 0x1b801,0x29000,0x15bd800,0x15bdc00,0x15be000,0x15be400,0xffff01f1,0xffffffff
.long 0x1b881,0x29080,0x15dfc00,0x15e0000,0x15e0400,0x15e0800,0xffff01f2,0xffffffff
.long 0x1b901,0x29100,0x15e0c00,0x15e1000,0x15e1400,0x1602c00,0x1f301f2,0xffffffff
.long 0x1b981,0x29180,0x1603000,0x1603400,0x1603800,0x1603c00,0xffff01f3,0xffffffff
.long 0x1ba01,0x29200,0x1604000,0x1625c00,0x1626000,0x1626400,0x1f401f3,0xffffffff
.long 0x1ba81,0x29280,0x1626800,0x1626c00,0x1627000,0x1627400,0xffff01f4,0xffffffff
.long 0x1bb01,0x29300,0x1648c00,0x1649000,0x1649400,0x1649800,0xffff01f5,0xffffffff
.long 0x1bb81,0x29380,0x1649c00,0x164a000,0x164a400,0x166bc00,0x1f601f5,0xffffffff
.long 0x1bc01,0x29400,0x166c000,0x166c400,0x166c800,0x166cc00,0xffff01f6,0xffffffff
.long 0x1bc81,0x29480,0x166d000,0x166d400,0x168ec00,0x168f000,0x1f701f6,0xffffffff
.long 0x1bd01,0x29500,0x168f400,0x168f800,0x168fc00,0x1690000,0xffff01f7,0xffffffff
.long 0x43801,0x51000,0x1483800,0x1483c00,0x1484000,0x1484400,0xffff01e8,0xffffffff
.long 0x43881,0x51080,0x1484800,0x1484c00,0x1485000,0x14a6800,0x1e901e8,0xffffffff
.long 0x43901,0x51100,0x14a6c00,0x14a7000,0x14a7400,0x14a7800,0xffff01e9,0xffffffff
.long 0x43981,0x51180,0x14a7c00,0x14a8000,0x14c9800,0x14c9c00,0x1ea01e9,0xffffffff
.long 0x43a01,0x51200,0x14ca000,0x14ca400,0x14ca800,0x14cac00,0xffff01ea,0xffffffff
.long 0x43a81,0x51280,0x14cb000,0x14ec800,0x14ecc00,0x14ed000,0x1eb01ea,0xffffffff
.long 0x43b01,0x51300,0x14ed400,0x14ed800,0x14edc00,0x150f800,0x1ec01eb,0xffffffff
.long 0x43b81,0x51380,0x150fc00,0x1510000,0x1510400,0x1510800,0xffff01ec,0xffffffff
.long 0x43c01,0x51400,0x1510c00,0x1511000,0x1532800,0x1532c00,0x1ed01ec,0xffffffff
.long 0x43c81,0x51480,0x1533000,0x1533400,0x1533800,0x1533c00,0xffff01ed,0xffffffff
.long 0x43d01,0x51500,0x1534000,0x1555800,0x1555c00,0x1556000,0x1ee01ed,0xffffffff
.long 0x43d81,0x51580,0x1556400,0x1556800,0x1556c00,0x1557000,0xffff01ee,0xffffffff
.long 0x43e01,0x51600,0x1578800,0x1578c00,0x1579000,0x1579400,0xffff01ef,0xffffffff
.long 0x43e81,0x51680,0x1579800,0x1579c00,0x159b800,0x159bc00,0x1f001ef,0xffffffff
.long 0x43f01,0x51700,0x159c000,0x159c400,0x159c800,0x159cc00,0xffff01f0,0xffffffff
.long 0x43f81,0x51780,0x159d000,0x15be800,0x15bec00,0x15bf000,0x1f101f0,0xffffffff
.long 0x44001,0x51800,0x15bf400,0x15bf800,0x15bfc00,0x15c0000,0xffff01f1,0xffffffff
.long 0x44081,0x51880,0x15e1800,0x15e1c00,0x15e2000,0x15e2400,0xffff01f2,0xffffffff
.long 0x44101,0x51900,0x15e2800,0x15e2c00,0x15e3000,0x1604800,0x1f301f2,0xffffffff
.long 0x44181,0x51980,0x1604c00,0x1605000,0x1605400,0x1605800,0xffff01f3,0xffffffff
.long 0x44201,0x51a00,0x1605c00,0x1627800,0x1627c00,0x1628000,0x1f401f3,0xffffffff
.long 0x44281,0x51a80,0x1628400,0x1628800,0x1628c00,0x1629000,0xffff01f4,0xffffffff
.long 0x44301,0x51b00,0x164a800,0x164ac00,0x164b000,0x164b400,0xffff01f5,0xffffffff
.long 0x44381,0x51b80,0x164b800,0x164bc00,0x164c000,0x166d800,0x1f601f5,0xffffffff
.long 0x44401,0x51c00,0x166dc00,0x166e000,0x166e400,0x166e800,0xffff01f6,0xffffffff
.long 0x44481,0x51c80,0x166ec00,0x166f000,0x1690800,0x1690c00,0x1f701f6,0xffffffff
.long 0x44501,0x51d00,0x1691000,0x1691400,0x1691800,0x1691c00,0xffff01f7,0xffffffff
.long 0x5e801,0x6c000,0x1485400,0x1485800,0x1485c00,0x1486000,0xffff01e8,0xffffffff
.long 0x5e881,0x6c080,0x1486400,0x1486800,0x1486c00,0x14a8400,0x1e901e8,0xffffffff
.long 0x5e901,0x6c100,0x14a8800,0x14a8c00,0x14a9000,0x14a9400,0xffff01e9,0xffffffff
.long 0x5e981,0x6c180,0x14a9800,0x14a9c00,0x14cb400,0x14cb800,0x1ea01e9,0xffffffff
.long 0x5ea01,0x6c200,0x14cbc00,0x14cc000,0x14cc400,0x14cc800,0xffff01ea,0xffffffff
.long 0x5ea81,0x6c280,0x14ccc00,0x14ee400,0x14ee800,0x14eec00,0x1eb01ea,0xffffffff
.long 0x5eb01,0x6c300,0x14ef000,0x14ef400,0x14ef800,0x1511400,0x1ec01eb,0xffffffff
.long 0x5eb81,0x6c380,0x1511800,0x1511c00,0x1512000,0x1512400,0xffff01ec,0xffffffff
.long 0x5ec01,0x6c400,0x1512800,0x1512c00,0x1534400,0x1534800,0x1ed01ec,0xffffffff
.long 0x5ec81,0x6c480,0x1534c00,0x1535000,0x1535400,0x1535800,0xffff01ed,0xffffffff
.long 0x5ed01,0x6c500,0x1535c00,0x1557400,0x1557800,0x1557c00,0x1ee01ed,0xffffffff
.long 0x5ed81,0x6c580,0x1558000,0x1558400,0x1558800,0x1558c00,0xffff01ee,0xffffffff
.long 0x5ee01,0x6c600,0x157a400,0x157a800,0x157ac00,0x157b000,0xffff01ef,0xffffffff
.long 0x5ee81,0x6c680,0x157b400,0x157b800,0x159d400,0x159d800,0x1f001ef,0xffffffff
.long 0x5ef01,0x6c700,0x159dc00,0x159e000,0x159e400,0x159e800,0xffff01f0,0xffffffff
.long 0x5ef81,0x6c780,0x159ec00,0x15c0400,0x15c0800,0x15c0c00,0x1f101f0,0xffffffff
.long 0x5f001,0x6c800,0x15c1000,0x15c1400,0x15c1800,0x15c1c00,0xffff01f1,0xffffffff
.long 0x5f081,0x6c880,0x15e3400,0x15e3800,0x15e3c00,0x15e4000,0xffff01f2,0xffffffff
.long 0x5f101,0x6c900,0x15e4400,0x15e4800,0x15e4c00,0x1606400,0x1f301f2,0xffffffff
.long 0x5f181,0x6c980,0x1606800,0x1606c00,0x1607000,0x1607400,0xffff01f3,0xffffffff
.long 0x5f201,0x6ca00,0x1607800,0x1629400,0x1629800,0x1629c00,0x1f401f3,0xffffffff
.long 0x5f281,0x6ca80,0x162a000,0x162a400,0x162a800,0x162ac00,0xffff01f4,0xffffffff
.long 0x5f301,0x6cb00,0x164c400,0x164c800,0x164cc00,0x164d000,0xffff01f5,0xffffffff
.long 0x5f381,0x6cb80,0x164d400,0x164d800,0x164dc00,0x166f400,0x1f601f5,0xffffffff
.long 0x5f401,0x6cc00,0x166f800,0x166fc00,0x1670000,0x1670400,0xffff01f6,0xffffffff
.long 0x5f481,0x6cc80,0x1670800,0x1670c00,0x1692400,0x1692800,0x1f701f6,0xffffffff
.long 0x5f501,0x6cd00,0x1692c00,0x1693000,0x1693400,0x1693800,0xffff01f7,0xffffffff
.long 0x36001,0x79800,0x1487000,0x1487400,0x1487800,0x1487c00,0xffff01e8,0xffffffff
.long 0x36081,0x79880,0x1488000,0x1488400,0x1488800,0x14aa000,0x1e901e8,0xffffffff
.long 0x36101,0x79900,0x14aa400,0x14aa800,0x14aac00,0x14ab000,0xffff01e9,0xffffffff
.long 0x36181,0x79980,0x14ab400,0x14ab800,0x14cd000,0x14cd400,0x1ea01e9,0xffffffff
.long 0x36201,0x79a00,0x14cd800,0x14cdc00,0x14ce000,0x14ce400,0xffff01ea,0xffffffff
.long 0x36281,0x79a80,0x14ce800,0x14f0000,0x14f0400,0x14f0800,0x1eb01ea,0xffffffff
.long 0x36301,0x79b00,0x14f0c00,0x14f1000,0x14f1400,0x1513000,0x1ec01eb,0xffffffff
.long 0x36381,0x79b80,0x1513400,0x1513800,0x1513c00,0x1514000,0xffff01ec,0xffffffff
.long 0x36401,0x79c00,0x1514400,0x1514800,0x1536000,0x1536400,0x1ed01ec,0xffffffff
.long 0x36481,0x79c80,0x1536800,0x1536c00,0x1537000,0x1537400,0xffff01ed,0xffffffff
.long 0x36501,0x79d00,0x1537800,0x1559000,0x1559400,0x1559800,0x1ee01ed,0xffffffff
.long 0x36581,0x79d80,0x1559c00,0x155a000,0x155a400,0x155a800,0xffff01ee,0xffffffff
.long 0x36601,0x79e00,0x157c000,0x157c400,0x157c800,0x157cc00,0xffff01ef,0xffffffff
.long 0x36681,0x79e80,0x157d000,0x157d400,0x159f000,0x159f400,0x1f001ef,0xffffffff
.long 0x36701,0x79f00,0x159f800,0x159fc00,0x15a0000,0x15a0400,0xffff01f0,0xffffffff
.long 0x36781,0x79f80,0x15a0800,0x15c2000,0x15c2400,0x15c2800,0x1f101f0,0xffffffff
.long 0x36801,0x7a000,0x15c2c00,0x15c3000,0x15c3400,0x15c3800,0xffff01f1,0xffffffff
.long 0x36881,0x7a080,0x15e5000,0x15e5400,0x15e5800,0x15e5c00,0xffff01f2,0xffffffff
.long 0x36901,0x7a100,0x15e6000,0x15e6400,0x15e6800,0x1608000,0x1f301f2,0xffffffff
.long 0x36981,0x7a180,0x1608400,0x1608800,0x1608c00,0x1609000,0xffff01f3,0xffffffff
.long 0x36a01,0x7a200,0x1609400,0x162b000,0x162b400,0x162b800,0x1f401f3,0xffffffff
.long 0x36a81,0x7a280,0x162bc00,0x162c000,0x162c400,0x162c800,0xffff01f4,0xffffffff
.long 0x36b01,0x7a300,0x164e000,0x164e400,0x164e800,0x164ec00,0xffff01f5,0xffffffff
.long 0x36b81,0x7a380,0x164f000,0x164f400,0x164f800,0x1671000,0x1f601f5,0xffffffff
.long 0x36c01,0x7a400,0x1671400,0x1671800,0x1671c00,0x1672000,0xffff01f6,0xffffffff
.long 0x36c81,0x7a480,0x1672400,0x1672800,0x1694000,0x1694400,0x1f701f6,0xffffffff
.long 0x36d01,0x7a500,0x1694800,0x1694c00,0x1695000,0x1695400,0xffff01f7,0xffffffff
.long 0x87001,0x94800,0x1488c00,0x1489000,0x1489400,0x1489800,0xffff01e8,0xffffffff
.long 0x87081,0x94880,0x1489c00,0x148a000,0x148a400,0x14abc00,0x1e901e8,0xffffffff
.long 0x87101,0x94900,0x14ac000,0x14ac400,0x14ac800,0x14acc00,0xffff01e9,0xffffffff
.long 0x87181,0x94980,0x14ad000,0x14ad400,0x14cec00,0x14cf000,0x1ea01e9,0xffffffff
.long 0x87201,0x94a00,0x14cf400,0x14cf800,0x14cfc00,0x14d0000,0xffff01ea,0xffffffff
.long 0x87281,0x94a80,0x14d0400,0x14f1c00,0x14f2000,0x14f2400,0x1eb01ea,0xffffffff
.long 0x87301,0x94b00,0x14f2800,0x14f2c00,0x14f3000,0x1514c00,0x1ec01eb,0xffffffff
.long 0x87381,0x94b80,0x1515000,0x1515400,0x1515800,0x1515c00,0xffff01ec,0xffffffff
.long 0x87401,0x94c00,0x1516000,0x1516400,0x1537c00,0x1538000,0x1ed01ec,0xffffffff
.long 0x87481,0x94c80,0x1538400,0x1538800,0x1538c00,0x1539000,0xffff01ed,0xffffffff
.long 0x87501,0x94d00,0x1539400,0x155ac00,0x155b000,0x155b400,0x1ee01ed,0xffffffff
.long 0x87581,0x94d80,0x155b800,0x155bc00,0x155c000,0x155c400,0xffff01ee,0xffffffff
.long 0x87601,0x94e00,0x157dc00,0x157e000,0x157e400,0x157e800,0xffff01ef,0xffffffff
.long 0x87681,0x94e80,0x157ec00,0x157f000,0x15a0c00,0x15a1000,0x1f001ef,0xffffffff
.long 0x87701,0x94f00,0x15a1400,0x15a1800,0x15a1c00,0x15a2000,0xffff01f0,0xffffffff
.long 0x87781,0x94f80,0x15a2400,0x15c3c00,0x15c4000,0x15c4400,0x1f101f0,0xffffffff
.long 0x87801,0x95000,0x15c4800,0x15c4c00,0x15c5000,0x15c5400,0xffff01f1,0xffffffff
.long 0x87881,0x95080,0x15e6c00,0x15e7000,0x15e7400,0x15e7800,0xffff01f2,0xffffffff
.long 0x87901,0x95100,0x15e7c00,0x15e8000,0x15e8400,0x1609c00,0x1f301f2,0xffffffff
.long 0x87981,0x95180,0x160a000,0x160a400,0x160a800,0x160ac00,0xffff01f3,0xffffffff
.long 0x87a01,0x95200,0x160b000,0x162cc00,0x162d000,0x162d400,0x1f401f3,0xffffffff
.long 0x87a81,0x95280,0x162d800,0x162dc00,0x162e000,0x162e400,0xffff01f4,0xffffffff
.long 0x87b01,0x95300,0x164fc00,0x1650000,0x1650400,0x1650800,0xffff01f5,0xffffffff
.long 0x87b81,0x95380,0x1650c00,0x1651000,0x1651400,0x1672c00,0x1f601f5,0xffffffff
.long 0x87c01,0x95400,0x1673000,0x1673400,0x1673800,0x1673c00,0xffff01f6,0xffffffff
.long 0x87c81,0x95480,0x1674000,0x1674400,0x1695c00,0x1696000,0x1f701f6,0xffffffff
.long 0x87d01,0x95500,0x1696400,0x1696800,0x1696c00,0x1697000,0xffff01f7,0xffffffff
.long 0xa2001,0xaf800,0x148a800,0x148ac00,0x148b000,0x148b400,0xffff01e8,0xffffffff
.long 0xa2081,0xaf880,0x148b800,0x148bc00,0x148c000,0x14ad800,0x1e901e8,0xffffffff
.long 0xa2101,0xaf900,0x14adc00,0x14ae000,0x14ae400,0x14ae800,0xffff01e9,0xffffffff
.long 0xa2181,0xaf980,0x14aec00,0x14af000,0x14d0800,0x14d0c00,0x1ea01e9,0xffffffff
.long 0xa2201,0xafa00,0x14d1000,0x14d1400,0x14d1800,0x14d1c00,0xffff01ea,0xffffffff
.long 0xa2281,0xafa80,0x14d2000,0x14f3800,0x14f3c00,0x14f4000,0x1eb01ea,0xffffffff
.long 0xa2301,0xafb00,0x14f4400,0x14f4800,0x14f4c00,0x1516800,0x1ec01eb,0xffffffff
.long 0xa2381,0xafb80,0x1516c00,0x1517000,0x1517400,0x1517800,0xffff01ec,0xffffffff
.long 0xa2401,0xafc00,0x1517c00,0x1518000,0x1539800,0x1539c00,0x1ed01ec,0xffffffff
.long 0xa2481,0xafc80,0x153a000,0x153a400,0x153a800,0x153ac00,0xffff01ed,0xffffffff
.long 0xa2501,0xafd00,0x153b000,0x155c800,0x155cc00,0x155d000,0x1ee01ed,0xffffffff
.long 0xa2581,0xafd80,0x155d400,0x155d800,0x155dc00,0x155e000,0xffff01ee,0xffffffff
.long 0xa2601,0xafe00,0x157f800,0x157fc00,0x1580000,0x1580400,0xffff01ef,0xffffffff
.long 0xa2681,0xafe80,0x1580800,0x1580c00,0x15a2800,0x15a2c00,0x1f001ef,0xffffffff
.long 0xa2701,0xaff00,0x15a3000,0x15a3400,0x15a3800,0x15a3c00,0xffff01f0,0xffffffff
.long 0xa2781,0xaff80,0x15a4000,0x15c5800,0x15c5c00,0x15c6000,0x1f101f0,0xffffffff
.long 0xa2801,0xb0000,0x15c6400,0x15c6800,0x15c6c00,0x15c7000,0xffff01f1,0xffffffff
.long 0xa2881,0xb0080,0x15e8800,0x15e8c00,0x15e9000,0x15e9400,0xffff01f2,0xffffffff
.long 0xa2901,0xb0100,0x15e9800,0x15e9c00,0x15ea000,0x160b800,0x1f301f2,0xffffffff
.long 0xa2981,0xb0180,0x160bc00,0x160c000,0x160c400,0x160c800,0xffff01f3,0xffffffff
.long 0xa2a01,0xb0200,0x160cc00,0x162e800,0x162ec00,0x162f000,0x1f401f3,0xffffffff
.long 0xa2a81,0xb0280,0x162f400,0x162f800,0x162fc00,0x1630000,0xffff01f4,0xffffffff
.long 0xa2b01,0xb0300,0x1651800,0x1651c00,0x1652000,0x1652400,0xffff01f5,0xffffffff
.long 0xa2b81,0xb0380,0x1652800,0x1652c00,0x1653000,0x1674800,0x1f601f5,0xffffffff
.long 0xa2c01,0xb0400,0x1674c00,0x1675000,0x1675400,0x1675800,0xffff01f6,0xffffffff
.long 0xa2c81,0xb0480,0x1675c00,0x1676000,0x1697800,0x1697c00,0x1f701f6,0xffffffff
.long 0xa2d01,0xb0500,0x1698000,0x1698400,0x1698800,0x1698c00,0xffff01f7,0xffffffff
.long 0xca801,0xd8000,0x148c400,0x148c800,0x148cc00,0x148d000,0xffff01e8,0xffffffff
.long 0xca881,0xd8080,0x148d400,0x148d800,0x148dc00,0x14af400,0x1e901e8,0xffffffff
.long 0xca901,0xd8100,0x14af800,0x14afc00,0x14b0000,0x14b0400,0xffff01e9,0xffffffff
.long 0xca981,0xd8180,0x14b0800,0x14b0c00,0x14d2400,0x14d2800,0x1ea01e9,0xffffffff
.long 0xcaa01,0xd8200,0x14d2c00,0x14d3000,0x14d3400,0x14d3800,0xffff01ea,0xffffffff
.long 0xcaa81,0xd8280,0x14d3c00,0x14f5400,0x14f5800,0x14f5c00,0x1eb01ea,0xffffffff
.long 0xcab01,0xd8300,0x14f6000,0x14f6400,0x14f6800,0x1518400,0x1ec01eb,0xffffffff
.long 0xcab81,0xd8380,0x1518800,0x1518c00,0x1519000,0x1519400,0xffff01ec,0xffffffff
.long 0xcac01,0xd8400,0x1519800,0x1519c00,0x153b400,0x153b800,0x1ed01ec,0xffffffff
.long 0xcac81,0xd8480,0x153bc00,0x153c000,0x153c400,0x153c800,0xffff01ed,0xffffffff
.long 0xcad01,0xd8500,0x153cc00,0x155e400,0x155e800,0x155ec00,0x1ee01ed,0xffffffff
.long 0xcad81,0xd8580,0x155f000,0x155f400,0x155f800,0x155fc00,0xffff01ee,0xffffffff
.long 0xcae01,0xd8600,0x1581400,0x1581800,0x1581c00,0x1582000,0xffff01ef,0xffffffff
.long 0xcae81,0xd8680,0x1582400,0x1582800,0x15a4400,0x15a4800,0x1f001ef,0xffffffff
.long 0xcaf01,0xd8700,0x15a4c00,0x15a5000,0x15a5400,0x15a5800,0xffff01f0,0xffffffff
.long 0xcaf81,0xd8780,0x15a5c00,0x15c7400,0x15c7800,0x15c7c00,0x1f101f0,0xffffffff
.long 0xcb001,0xd8800,0x15c8000,0x15c8400,0x15c8800,0x15c8c00,0xffff01f1,0xffffffff
.long 0xcb081,0xd8880,0x15ea400,0x15ea800,0x15eac00,0x15eb000,0xffff01f2,0xffffffff
.long 0xcb101,0xd8900,0x15eb400,0x15eb800,0x15ebc00,0x160d400,0x1f301f2,0xffffffff
.long 0xcb181,0xd8980,0x160d800,0x160dc00,0x160e000,0x160e400,0xffff01f3,0xffffffff
.long 0xcb201,0xd8a00,0x160e800,0x1630400,0x1630800,0x1630c00,0x1f401f3,0xffffffff
.long 0xcb281,0xd8a80,0x1631000,0x1631400,0x1631800,0x1631c00,0xffff01f4,0xffffffff
.long 0xcb301,0xd8b00,0x1653400,0x1653800,0x1653c00,0x1654000,0xffff01f5,0xffffffff
.long 0xcb381,0xd8b80,0x1654400,0x1654800,0x1654c00,0x1676400,0x1f601f5,0xffffffff
.long 0xcb401,0xd8c00,0x1676800,0x1676c00,0x1677000,0x1677400,0xffff01f6,0xffffffff
.long 0xcb481,0xd8c80,0x1677800,0x1677c00,0x1699400,0x1699800,0x1f701f6,0xffffffff
.long 0xcb501,0xd8d00,0x1699c00,0x169a000,0x169a400,0x169a800,0xffff01f7,0xffffffff
.long 0xe5801,0xf3000,0x148e000,0x148e400,0x148e800,0x148ec00,0xffff01e8,0xffffffff
.long 0xe5881,0xf3080,0x148f000,0x148f400,0x148f800,0x14b1000,0x1e901e8,0xffffffff
.long 0xe5901,0xf3100,0x14b1400,0x14b1800,0x14b1c00,0x14b2000,0xffff01e9,0xffffffff
.long 0xe5981,0xf3180,0x14b2400,0x14b2800,0x14d4000,0x14d4400,0x1ea01e9,0xffffffff
.long 0xe5a01,0xf3200,0x14d4800,0x14d4c00,0x14d5000,0x14d5400,0xffff01ea,0xffffffff
.long 0xe5a81,0xf3280,0x14d5800,0x14f7000,0x14f7400,0x14f7800,0x1eb01ea,0xffffffff
.long 0xe5b01,0xf3300,0x14f7c00,0x14f8000,0x14f8400,0x151a000,0x1ec01eb,0xffffffff
.long 0xe5b81,0xf3380,0x151a400,0x151a800,0x151ac00,0x151b000,0xffff01ec,0xffffffff
.long 0xe5c01,0xf3400,0x151b400,0x151b800,0x153d000,0x153d400,0x1ed01ec,0xffffffff
.long 0xe5c81,0xf3480,0x153d800,0x153dc00,0x153e000,0x153e400,0xffff01ed,0xffffffff
.long 0xe5d01,0xf3500,0x153e800,0x1560000,0x1560400,0x1560800,0x1ee01ed,0xffffffff
.long 0xe5d81,0xf3580,0x1560c00,0x1561000,0x1561400,0x1561800,0xffff01ee,0xffffffff
.long 0xe5e01,0xf3600,0x1583000,0x1583400,0x1583800,0x1583c00,0xffff01ef,0xffffffff
.long 0xe5e81,0xf3680,0x1584000,0x1584400,0x15a6000,0x15a6400,0x1f001ef,0xffffffff
.long 0xe5f01,0xf3700,0x15a6800,0x15a6c00,0x15a7000,0x15a7400,0xffff01f0,0xffffffff
.long 0xe5f81,0xf3780,0x15a7800,0x15c9000,0x15c9400,0x15c9800,0x1f101f0,0xffffffff
.long 0xe6001,0xf3800,0x15c9c00,0x15ca000,0x15ca400,0x15ca800,0xffff01f1,0xffffffff
.long 0xe6081,0xf3880,0x15ec000,0x15ec400,0x15ec800,0x15ecc00,0xffff01f2,0xffffffff
.long 0xe6101,0xf3900,0x15ed000,0x15ed400,0x15ed800,0x160f000,0x1f301f2,0xffffffff
.long 0xe6181,0xf3980,0x160f400,0x160f800,0x160fc00,0x1610000,0xffff01f3,0xffffffff
.long 0xe6201,0xf3a00,0x1610400,0x1632000,0x1632400,0x1632800,0x1f401f3,0xffffffff
.long 0xe6281,0xf3a80,0x1632c00,0x1633000,0x1633400,0x1633800,0xffff01f4,0xffffffff
.long 0xe6301,0xf3b00,0x1655000,0x1655400,0x1655800,0x1655c00,0xffff01f5,0xffffffff
.long 0xe6381,0xf3b80,0x1656000,0x1656400,0x1656800,0x1678000,0x1f601f5,0xffffffff
.long 0xe6401,0xf3c00,0x1678400,0x1678800,0x1678c00,0x1679000,0xffff01f6,0xffffffff
.long 0xe6481,0xf3c80,0x1679400,0x1679800,0x169b000,0x169b400,0x1f701f6,0xffffffff
.long 0xe6501,0xf3d00,0x169b800,0x169bc00,0x169c000,0x169c400,0xffff01f7,0xffffffff
.long 0xbd001,0x100800,0x148fc00,0x1490000,0x1490400,0x1490800,0xffff01e8,0xffffffff
.long 0xbd081,0x100880,0x1490c00,0x1491000,0x1491400,0x14b2c00,0x1e901e8,0xffffffff
.long 0xbd101,0x100900,0x14b3000,0x14b3400,0x14b3800,0x14b3c00,0xffff01e9,0xffffffff
.long 0xbd181,0x100980,0x14b4000,0x14b4400,0x14d5c00,0x14d6000,0x1ea01e9,0xffffffff
.long 0xbd201,0x100a00,0x14d6400,0x14d6800,0x14d6c00,0x14d7000,0xffff01ea,0xffffffff
.long 0xbd281,0x100a80,0x14d7400,0x14f8c00,0x14f9000,0x14f9400,0x1eb01ea,0xffffffff
.long 0xbd301,0x100b00,0x14f9800,0x14f9c00,0x14fa000,0x151bc00,0x1ec01eb,0xffffffff
.long 0xbd381,0x100b80,0x151c000,0x151c400,0x151c800,0x151cc00,0xffff01ec,0xffffffff
.long 0xbd401,0x100c00,0x151d000,0x151d400,0x153ec00,0x153f000,0x1ed01ec,0xffffffff
.long 0xbd481,0x100c80,0x153f400,0x153f800,0x153fc00,0x1540000,0xffff01ed,0xffffffff
.long 0xbd501,0x100d00,0x1540400,0x1561c00,0x1562000,0x1562400,0x1ee01ed,0xffffffff
.long 0xbd581,0x100d80,0x1562800,0x1562c00,0x1563000,0x1563400,0xffff01ee,0xffffffff
.long 0xbd601,0x100e00,0x1584c00,0x1585000,0x1585400,0x1585800,0xffff01ef,0xffffffff
.long 0xbd681,0x100e80,0x1585c00,0x1586000,0x15a7c00,0x15a8000,0x1f001ef,0xffffffff
.long 0xbd701,0x100f00,0x15a8400,0x15a8800,0x15a8c00,0x15a9000,0xffff01f0,0xffffffff
.long 0xbd781,0x100f80,0x15a9400,0x15cac00,0x15cb000,0x15cb400,0x1f101f0,0xffffffff
.long 0xbd801,0x101000,0x15cb800,0x15cbc00,0x15cc000,0x15cc400,0xffff01f1,0xffffffff
.long 0xbd881,0x101080,0x15edc00,0x15ee000,0x15ee400,0x15ee800,0xffff01f2,0xffffffff
.long 0xbd901,0x101100,0x15eec00,0x15ef000,0x15ef400,0x1610c00,0x1f301f2,0xffffffff
.long 0xbd981,0x101180,0x1611000,0x1611400,0x1611800,0x1611c00,0xffff01f3,0xffffffff
.long 0xbda01,0x101200,0x1612000,0x1633c00,0x1634000,0x1634400,0x1f401f3,0xffffffff
.long 0xbda81,0x101280,0x1634800,0x1634c00,0x1635000,0x1635400,0xffff01f4,0xffffffff
.long 0xbdb01,0x101300,0x1656c00,0x1657000,0x1657400,0x1657800,0xffff01f5,0xffffffff
.long 0xbdb81,0x101380,0x1657c00,0x1658000,0x1658400,0x1679c00,0x1f601f5,0xffffffff
.long 0xbdc01,0x101400,0x167a000,0x167a400,0x167a800,0x167ac00,0xffff01f6,0xffffffff
.long 0xbdc81,0x101480,0x167b000,0x167b400,0x169cc00,0x169d000,0x1f701f6,0xffffffff
.long 0xbdd01,0x101500,0x169d400,0x169d800,0x169dc00,0x169e000,0xffff01f7,0xffffffff
.long 0x10e001,0x11b800,0x1491800,0x1491c00,0x1492000,0x1492400,0xffff01e8,0xffffffff
.long 0x10e081,0x11b880,0x1492800,0x1492c00,0x1493000,0x14b4800,0x1e901e8,0xffffffff
.long 0x10e101,0x11b900,0x14b4c00,0x14b5000,0x14b5400,0x14b5800,0xffff01e9,0xffffffff
.long 0x10e181,0x11b980,0x14b5c00,0x14b6000,0x14d7800,0x14d7c00,0x1ea01e9,0xffffffff
.long 0x10e201,0x11ba00,0x14d8000,0x14d8400,0x14d8800,0x14d8c00,0xffff01ea,0xffffffff
.long 0x10e281,0x11ba80,0x14d9000,0x14fa800,0x14fac00,0x14fb000,0x1eb01ea,0xffffffff
.long 0x10e301,0x11bb00,0x14fb400,0x14fb800,0x14fbc00,0x151d800,0x1ec01eb,0xffffffff
.long 0x10e381,0x11bb80,0x151dc00,0x151e000,0x151e400,0x151e800,0xffff01ec,0xffffffff
.long 0x10e401,0x11bc00,0x151ec00,0x151f000,0x1540800,0x1540c00,0x1ed01ec,0xffffffff
.long 0x10e481,0x11bc80,0x1541000,0x1541400,0x1541800,0x1541c00,0xffff01ed,0xffffffff
.long 0x10e501,0x11bd00,0x1542000,0x1563800,0x1563c00,0x1564000,0x1ee01ed,0xffffffff
.long 0x10e581,0x11bd80,0x1564400,0x1564800,0x1564c00,0x1565000,0xffff01ee,0xffffffff
.long 0x10e601,0x11be00,0x1586800,0x1586c00,0x1587000,0x1587400,0xffff01ef,0xffffffff
.long 0x10e681,0x11be80,0x1587800,0x1587c00,0x15a9800,0x15a9c00,0x1f001ef,0xffffffff
.long 0x10e701,0x11bf00,0x15aa000,0x15aa400,0x15aa800,0x15aac00,0xffff01f0,0xffffffff
.long 0x10e781,0x11bf80,0x15ab000,0x15cc800,0x15ccc00,0x15cd000,0x1f101f0,0xffffffff
.long 0x10e801,0x11c000,0x15cd400,0x15cd800,0x15cdc00,0x15ce000,0xffff01f1,0xffffffff
.long 0x10e881,0x11c080,0x15ef800,0x15efc00,0x15f0000,0x15f0400,0xffff01f2,0xffffffff
.long 0x10e901,0x11c100,0x15f0800,0x15f0c00,0x15f1000,0x1612800,0x1f301f2,0xffffffff
.long 0x10e981,0x11c180,0x1612c00,0x1613000,0x1613400,0x1613800,0xffff01f3,0xffffffff
.long 0x10ea01,0x11c200,0x1613c00,0x1635800,0x1635c00,0x1636000,0x1f401f3,0xffffffff
.long 0x10ea81,0x11c280,0x1636400,0x1636800,0x1636c00,0x1637000,0xffff01f4,0xffffffff
.long 0x10eb01,0x11c300,0x1658800,0x1658c00,0x1659000,0x1659400,0xffff01f5,0xffffffff
.long 0x10eb81,0x11c380,0x1659800,0x1659c00,0x165a000,0x167b800,0x1f601f5,0xffffffff
.long 0x10ec01,0x11c400,0x167bc00,0x167c000,0x167c400,0x167c800,0xffff01f6,0xffffffff
.long 0x10ec81,0x11c480,0x167cc00,0x167d000,0x169e800,0x169ec00,0x1f701f6,0xffffffff
.long 0x10ed01,0x11c500,0x169f000,0x169f400,0x169f800,0x169fc00,0xffff01f7,0xffffffff
.long 0x129001,0x136800,0x1493400,0x1493800,0x1493c00,0x1494000,0xffff01e8,0xffffffff
.long 0x129081,0x136880,0x1494400,0x1494800,0x1494c00,0x14b6400,0x1e901e8,0xffffffff
.long 0x129101,0x136900,0x14b6800,0x14b6c00,0x14b7000,0x14b7400,0xffff01e9,0xffffffff
.long 0x129181,0x136980,0x14b7800,0x14b7c00,0x14d9400,0x14d9800,0x1ea01e9,0xffffffff
.long 0x129201,0x136a00,0x14d9c00,0x14da000,0x14da400,0x14da800,0xffff01ea,0xffffffff
.long 0x129281,0x136a80,0x14dac00,0x14fc400,0x14fc800,0x14fcc00,0x1eb01ea,0xffffffff
.long 0x129301,0x136b00,0x14fd000,0x14fd400,0x14fd800,0x151f400,0x1ec01eb,0xffffffff
.long 0x129381,0x136b80,0x151f800,0x151fc00,0x1520000,0x1520400,0xffff01ec,0xffffffff
.long 0x129401,0x136c00,0x1520800,0x1520c00,0x1542400,0x1542800,0x1ed01ec,0xffffffff
.long 0x129481,0x136c80,0x1542c00,0x1543000,0x1543400,0x1543800,0xffff01ed,0xffffffff
.long 0x129501,0x136d00,0x1543c00,0x1565400,0x1565800,0x1565c00,0x1ee01ed,0xffffffff
.long 0x129581,0x136d80,0x1566000,0x1566400,0x1566800,0x1566c00,0xffff01ee,0xffffffff
.long 0x129601,0x136e00,0x1588400,0x1588800,0x1588c00,0x1589000,0xffff01ef,0xffffffff
.long 0x129681,0x136e80,0x1589400,0x1589800,0x15ab400,0x15ab800,0x1f001ef,0xffffffff
.long 0x129701,0x136f00,0x15abc00,0x15ac000,0x15ac400,0x15ac800,0xffff01f0,0xffffffff
.long 0x129781,0x136f80,0x15acc00,0x15ce400,0x15ce800,0x15cec00,0x1f101f0,0xffffffff
.long 0x129801,0x137000,0x15cf000,0x15cf400,0x15cf800,0x15cfc00,0xffff01f1,0xffffffff
.long 0x129881,0x137080,0x15f1400,0x15f1800,0x15f1c00,0x15f2000,0xffff01f2,0xffffffff
.long 0x129901,0x137100,0x15f2400,0x15f2800,0x15f2c00,0x1614400,0x1f301f2,0xffffffff
.long 0x129981,0x137180,0x1614800,0x1614c00,0x1615000,0x1615400,0xffff01f3,0xffffffff
.long 0x129a01,0x137200,0x1615800,0x1637400,0x1637800,0x1637c00,0x1f401f3,0xffffffff
.long 0x129a81,0x137280,0x1638000,0x1638400,0x1638800,0x1638c00,0xffff01f4,0xffffffff
.long 0x129b01,0x137300,0x165a400,0x165a800,0x165ac00,0x165b000,0xffff01f5,0xffffffff
.long 0x129b81,0x137380,0x165b400,0x165b800,0x165bc00,0x167d400,0x1f601f5,0xffffffff
.long 0x129c01,0x137400,0x167d800,0x167dc00,0x167e000,0x167e400,0xffff01f6,0xffffffff
.long 0x129c81,0x137480,0x167e800,0x167ec00,0x16a0400,0x16a0800,0x1f701f6,0xffffffff
.long 0x129d01,0x137500,0x16a0c00,0x16a1000,0x16a1400,0x16a1800,0xffff01f7,0xffffffff
.long 0x151801,0x15f000,0x1495000,0x1495400,0x1495800,0x1495c00,0xffff01e8,0xffffffff
.long 0x151881,0x15f080,0x1496000,0x1496400,0x1496800,0x14b8000,0x1e901e8,0xffffffff
.long 0x151901,0x15f100,0x14b8400,0x14b8800,0x14b8c00,0x14b9000,0xffff01e9,0xffffffff
.long 0x151981,0x15f180,0x14b9400,0x14b9800,0x14db000,0x14db400,0x1ea01e9,0xffffffff
.long 0x151a01,0x15f200,0x14db800,0x14dbc00,0x14dc000,0x14dc400,0xffff01ea,0xffffffff
.long 0x151a81,0x15f280,0x14dc800,0x14fe000,0x14fe400,0x14fe800,0x1eb01ea,0xffffffff
.long 0x151b01,0x15f300,0x14fec00,0x14ff000,0x14ff400,0x1521000,0x1ec01eb,0xffffffff
.long 0x151b81,0x15f380,0x1521400,0x1521800,0x1521c00,0x1522000,0xffff01ec,0xffffffff
.long 0x151c01,0x15f400,0x1522400,0x1522800,0x1544000,0x1544400,0x1ed01ec,0xffffffff
.long 0x151c81,0x15f480,0x1544800,0x1544c00,0x1545000,0x1545400,0xffff01ed,0xffffffff
.long 0x151d01,0x15f500,0x1545800,0x1567000,0x1567400,0x1567800,0x1ee01ed,0xffffffff
.long 0x151d81,0x15f580,0x1567c00,0x1568000,0x1568400,0x1568800,0xffff01ee,0xffffffff
.long 0x151e01,0x15f600,0x158a000,0x158a400,0x158a800,0x158ac00,0xffff01ef,0xffffffff
.long 0x151e81,0x15f680,0x158b000,0x158b400,0x15ad000,0x15ad400,0x1f001ef,0xffffffff
.long 0x151f01,0x15f700,0x15ad800,0x15adc00,0x15ae000,0x15ae400,0xffff01f0,0xffffffff
.long 0x151f81,0x15f780,0x15ae800,0x15d0000,0x15d0400,0x15d0800,0x1f101f0,0xffffffff
.long 0x152001,0x15f800,0x15d0c00,0x15d1000,0x15d1400,0x15d1800,0xffff01f1,0xffffffff
.long 0x152081,0x15f880,0x15f3000,0x15f3400,0x15f3800,0x15f3c00,0xffff01f2,0xffffffff
.long 0x152101,0x15f900,0x15f4000,0x15f4400,0x15f4800,0x1616000,0x1f301f2,0xffffffff
.long 0x152181,0x15f980,0x1616400,0x1616800,0x1616c00,0x1617000,0xffff01f3,0xffffffff
.long 0x152201,0x15fa00,0x1617400,0x1639000,0x1639400,0x1639800,0x1f401f3,0xffffffff
.long 0x152281,0x15fa80,0x1639c00,0x163a000,0x163a400,0x163a800,0xffff01f4,0xffffffff
.long 0x152301,0x15fb00,0x165c000,0x165c400,0x165c800,0x165cc00,0xffff01f5,0xffffffff
.long 0x152381,0x15fb80,0x165d000,0x165d400,0x165d800,0x167f000,0x1f601f5,0xffffffff
.long 0x152401,0x15fc00,0x167f400,0x167f800,0x167fc00,0x1680000,0xffff01f6,0xffffffff
.long 0x152481,0x15fc80,0x1680400,0x1680800,0x16a2000,0x16a2400,0x1f701f6,0xffffffff
.long 0x152501,0x15fd00,0x16a2800,0x16a2c00,0x16a3000,0x16a3400,0xffff01f7,0xffffffff
.long 0x16c801,0x17a000,0x1496c00,0x1497000,0x1497400,0x1497800,0xffff01e8,0xffffffff
.long 0x16c881,0x17a080,0x1497c00,0x1498000,0x1498400,0x14b9c00,0x1e901e8,0xffffffff
.long 0x16c901,0x17a100,0x14ba000,0x14ba400,0x14ba800,0x14bac00,0xffff01e9,0xffffffff
.long 0x16c981,0x17a180,0x14bb000,0x14bb400,0x14dcc00,0x14dd000,0x1ea01e9,0xffffffff
.long 0x16ca01,0x17a200,0x14dd400,0x14dd800,0x14ddc00,0x14de000,0xffff01ea,0xffffffff
.long 0x16ca81,0x17a280,0x14de400,0x14ffc00,0x1500000,0x1500400,0x1eb01ea,0xffffffff
.long 0x16cb01,0x17a300,0x1500800,0x1500c00,0x1501000,0x1522c00,0x1ec01eb,0xffffffff
.long 0x16cb81,0x17a380,0x1523000,0x1523400,0x1523800,0x1523c00,0xffff01ec,0xffffffff
.long 0x16cc01,0x17a400,0x1524000,0x1524400,0x1545c00,0x1546000,0x1ed01ec,0xffffffff
.long 0x16cc81,0x17a480,0x1546400,0x1546800,0x1546c00,0x1547000,0xffff01ed,0xffffffff
.long 0x16cd01,0x17a500,0x1547400,0x1568c00,0x1569000,0x1569400,0x1ee01ed,0xffffffff
.long 0x16cd81,0x17a580,0x1569800,0x1569c00,0x156a000,0x156a400,0xffff01ee,0xffffffff
.long 0x16ce01,0x17a600,0x158bc00,0x158c000,0x158c400,0x158c800,0xffff01ef,0xffffffff
.long 0x16ce81,0x17a680,0x158cc00,0x158d000,0x15aec00,0x15af000,0x1f001ef,0xffffffff
.long 0x16cf01,0x17a700,0x15af400,0x15af800,0x15afc00,0x15b0000,0xffff01f0,0xffffffff
.long 0x16cf81,0x17a780,0x15b0400,0x15d1c00,0x15d2000,0x15d2400,0x1f101f0,0xffffffff
.long 0x16d001,0x17a800,0x15d2800,0x15d2c00,0x15d3000,0x15d3400,0xffff01f1,0xffffffff
.long 0x16d081,0x17a880,0x15f4c00,0x15f5000,0x15f5400,0x15f5800,0xffff01f2,0xffffffff
.long 0x16d101,0x17a900,0x15f5c00,0x15f6000,0x15f6400,0x1617c00,0x1f301f2,0xffffffff
.long 0x16d181,0x17a980,0x1618000,0x1618400,0x1618800,0x1618c00,0xffff01f3,0xffffffff
.long 0x16d201,0x17aa00,0x1619000,0x163ac00,0x163b000,0x163b400,0x1f401f3,0xffffffff
.long 0x16d281,0x17aa80,0x163b800,0x163bc00,0x163c000,0x163c400,0xffff01f4,0xffffffff
.long 0x16d301,0x17ab00,0x165dc00,0x165e000,0x165e400,0x165e800,0xffff01f5,0xffffffff
.long 0x16d381,0x17ab80,0x165ec00,0x165f000,0x165f400,0x1680c00,0x1f601f5,0xffffffff
.long 0x16d401,0x17ac00,0x1681000,0x1681400,0x1681800,0x1681c00,0xffff01f6,0xffffffff
.long 0x16d481,0x17ac80,0x1682000,0x1682400,0x16a3c00,0x16a4000,0x1f701f6,0xffffffff
.long 0x16d501,0x17ad00,0x16a4400,0x16a4800,0x16a4c00,0x16a5000,0xffff01f7,0xffffffff
.long 0x144001,0x187800,0x1498800,0x1498c00,0x1499000,0x1499400,0xffff01e8,0xffffffff
.long 0x144081,0x187880,0x1499800,0x1499c00,0x149a000,0x14bb800,0x1e901e8,0xffffffff
.long 0x144101,0x187900,0x14bbc00,0x14bc000,0x14bc400,0x14bc800,0xffff01e9,0xffffffff
.long 0x144181,0x187980,0x14bcc00,0x14bd000,0x14de800,0x14dec00,0x1ea01e9,0xffffffff
.long 0x144201,0x187a00,0x14df000,0x14df400,0x14df800,0x14dfc00,0xffff01ea,0xffffffff
.long 0x144281,0x187a80,0x14e0000,0x1501800,0x1501c00,0x1502000,0x1eb01ea,0xffffffff
.long 0x144301,0x187b00,0x1502400,0x1502800,0x1502c00,0x1524800,0x1ec01eb,0xffffffff
.long 0x144381,0x187b80,0x1524c00,0x1525000,0x1525400,0x1525800,0xffff01ec,0xffffffff
.long 0x144401,0x187c00,0x1525c00,0x1526000,0x1547800,0x1547c00,0x1ed01ec,0xffffffff
.long 0x144481,0x187c80,0x1548000,0x1548400,0x1548800,0x1548c00,0xffff01ed,0xffffffff
.long 0x144501,0x187d00,0x1549000,0x156a800,0x156ac00,0x156b000,0x1ee01ed,0xffffffff
.long 0x144581,0x187d80,0x156b400,0x156b800,0x156bc00,0x156c000,0xffff01ee,0xffffffff
.long 0x144601,0x187e00,0x158d800,0x158dc00,0x158e000,0x158e400,0xffff01ef,0xffffffff
.long 0x144681,0x187e80,0x158e800,0x158ec00,0x15b0800,0x15b0c00,0x1f001ef,0xffffffff
.long 0x144701,0x187f00,0x15b1000,0x15b1400,0x15b1800,0x15b1c00,0xffff01f0,0xffffffff
.long 0x144781,0x187f80,0x15b2000,0x15d3800,0x15d3c00,0x15d4000,0x1f101f0,0xffffffff
.long 0x144801,0x188000,0x15d4400,0x15d4800,0x15d4c00,0x15d5000,0xffff01f1,0xffffffff
.long 0x144881,0x188080,0x15f6800,0x15f6c00,0x15f7000,0x15f7400,0xffff01f2,0xffffffff
.long 0x144901,0x188100,0x15f7800,0x15f7c00,0x15f8000,0x1619800,0x1f301f2,0xffffffff
.long 0x144981,0x188180,0x1619c00,0x161a000,0x161a400,0x161a800,0xffff01f3,0xffffffff
.long 0x144a01,0x188200,0x161ac00,0x163c800,0x163cc00,0x163d000,0x1f401f3,0xffffffff
.long 0x144a81,0x188280,0x163d400,0x163d800,0x163dc00,0x163e000,0xffff01f4,0xffffffff
.long 0x144b01,0x188300,0x165f800,0x165fc00,0x1660000,0x1660400,0xffff01f5,0xffffffff
.long 0x144b81,0x188380,0x1660800,0x1660c00,0x1661000,0x1682800,0x1f601f5,0xffffffff
.long 0x144c01,0x188400,0x1682c00,0x1683000,0x1683400,0x1683800,0xffff01f6,0xffffffff
.long 0x144c81,0x188480,0x1683c00,0x1684000,0x16a5800,0x16a5c00,0x1f701f6,0xffffffff
.long 0x144d01,0x188500,0x16a6000,0x16a6400,0x16a6800,0x16a6c00,0xffff01f7,0xffffffff
.long 0x195001,0x1a2800,0x149a400,0x149a800,0x149ac00,0x149b000,0xffff01e8,0xffffffff
.long 0x195081,0x1a2880,0x149b400,0x149b800,0x149bc00,0x14bd400,0x1e901e8,0xffffffff
.long 0x195101,0x1a2900,0x14bd800,0x14bdc00,0x14be000,0x14be400,0xffff01e9,0xffffffff
.long 0x195181,0x1a2980,0x14be800,0x14bec00,0x14e0400,0x14e0800,0x1ea01e9,0xffffffff
.long 0x195201,0x1a2a00,0x14e0c00,0x14e1000,0x14e1400,0x14e1800,0xffff01ea,0xffffffff
.long 0x195281,0x1a2a80,0x14e1c00,0x1503400,0x1503800,0x1503c00,0x1eb01ea,0xffffffff
.long 0x195301,0x1a2b00,0x1504000,0x1504400,0x1504800,0x1526400,0x1ec01eb,0xffffffff
.long 0x195381,0x1a2b80,0x1526800,0x1526c00,0x1527000,0x1527400,0xffff01ec,0xffffffff
.long 0x195401,0x1a2c00,0x1527800,0x1527c00,0x1549400,0x1549800,0x1ed01ec,0xffffffff
.long 0x195481,0x1a2c80,0x1549c00,0x154a000,0x154a400,0x154a800,0xffff01ed,0xffffffff
.long 0x195501,0x1a2d00,0x154ac00,0x156c400,0x156c800,0x156cc00,0x1ee01ed,0xffffffff
.long 0x195581,0x1a2d80,0x156d000,0x156d400,0x156d800,0x156dc00,0xffff01ee,0xffffffff
.long 0x195601,0x1a2e00,0x158f400,0x158f800,0x158fc00,0x1590000,0xffff01ef,0xffffffff
.long 0x195681,0x1a2e80,0x1590400,0x1590800,0x15b2400,0x15b2800,0x1f001ef,0xffffffff
.long 0x195701,0x1a2f00,0x15b2c00,0x15b3000,0x15b3400,0x15b3800,0xffff01f0,0xffffffff
.long 0x195781,0x1a2f80,0x15b3c00,0x15d5400,0x15d5800,0x15d5c00,0x1f101f0,0xffffffff
.long 0x195801,0x1a3000,0x15d6000,0x15d6400,0x15d6800,0x15d6c00,0xffff01f1,0xffffffff
.long 0x195881,0x1a3080,0x15f8400,0x15f8800,0x15f8c00,0x15f9000,0xffff01f2,0xffffffff
.long 0x195901,0x1a3100,0x15f9400,0x15f9800,0x15f9c00,0x161b400,0x1f301f2,0xffffffff
.long 0x195981,0x1a3180,0x161b800,0x161bc00,0x161c000,0x161c400,0xffff01f3,0xffffffff
.long 0x195a01,0x1a3200,0x161c800,0x163e400,0x163e800,0x163ec00,0x1f401f3,0xffffffff
.long 0x195a81,0x1a3280,0x163f000,0x163f400,0x163f800,0x163fc00,0xffff01f4,0xffffffff
.long 0x195b01,0x1a3300,0x1661400,0x1661800,0x1661c00,0x1662000,0xffff01f5,0xffffffff
.long 0x195b81,0x1a3380,0x1662400,0x1662800,0x1662c00,0x1684400,0x1f601f5,0xffffffff
.long 0x195c01,0x1a3400,0x1684800,0x1684c00,0x1685000,0x1685400,0xffff01f6,0xffffffff
.long 0x195c81,0x1a3480,0x1685800,0x1685c00,0x16a7400,0x16a7800,0x1f701f6,0xffffffff
.long 0x195d01,0x1a3500,0x16a7c00,0x16a8000,0x16a8400,0x16a8800,0xffff01f7,0xffffffff
.long 0x1b0001,0x1bd800,0x149c000,0x149c400,0x149c800,0x149cc00,0xffff01e8,0xffffffff
.long 0x1b0081,0x1bd880,0x149d000,0x149d400,0x149d800,0x14bf000,0x1e901e8,0xffffffff
.long 0x1b0101,0x1bd900,0x14bf400,0x14bf800,0x14bfc00,0x14c0000,0xffff01e9,0xffffffff
.long 0x1b0181,0x1bd980,0x14c0400,0x14c0800,0x14e2000,0x14e2400,0x1ea01e9,0xffffffff
.long 0x1b0201,0x1bda00,0x14e2800,0x14e2c00,0x14e3000,0x14e3400,0xffff01ea,0xffffffff
.long 0x1b0281,0x1bda80,0x14e3800,0x1505000,0x1505400,0x1505800,0x1eb01ea,0xffffffff
.long 0x1b0301,0x1bdb00,0x1505c00,0x1506000,0x1506400,0x1528000,0x1ec01eb,0xffffffff
.long 0x1b0381,0x1bdb80,0x1528400,0x1528800,0x1528c00,0x1529000,0xffff01ec,0xffffffff
.long 0x1b0401,0x1bdc00,0x1529400,0x1529800,0x154b000,0x154b400,0x1ed01ec,0xffffffff
.long 0x1b0481,0x1bdc80,0x154b800,0x154bc00,0x154c000,0x154c400,0xffff01ed,0xffffffff
.long 0x1b0501,0x1bdd00,0x154c800,0x156e000,0x156e400,0x156e800,0x1ee01ed,0xffffffff
.long 0x1b0581,0x1bdd80,0x156ec00,0x156f000,0x156f400,0x156f800,0xffff01ee,0xffffffff
.long 0x1b0601,0x1bde00,0x1591000,0x1591400,0x1591800,0x1591c00,0xffff01ef,0xffffffff
.long 0x1b0681,0x1bde80,0x1592000,0x1592400,0x15b4000,0x15b4400,0x1f001ef,0xffffffff
.long 0x1b0701,0x1bdf00,0x15b4800,0x15b4c00,0x15b5000,0x15b5400,0xffff01f0,0xffffffff
.long 0x1b0781,0x1bdf80,0x15b5800,0x15d7000,0x15d7400,0x15d7800,0x1f101f0,0xffffffff
.long 0x1b0801,0x1be000,0x15d7c00,0x15d8000,0x15d8400,0x15d8800,0xffff01f1,0xffffffff
.long 0x1b0881,0x1be080,0x15fa000,0x15fa400,0x15fa800,0x15fac00,0xffff01f2,0xffffffff
.long 0x1b0901,0x1be100,0x15fb000,0x15fb400,0x15fb800,0x161d000,0x1f301f2,0xffffffff
.long 0x1b0981,0x1be180,0x161d400,0x161d800,0x161dc00,0x161e000,0xffff01f3,0xffffffff
.long 0x1b0a01,0x1be200,0x161e400,0x1640000,0x1640400,0x1640800,0x1f401f3,0xffffffff
.long 0x1b0a81,0x1be280,0x1640c00,0x1641000,0x1641400,0x1641800,0xffff01f4,0xffffffff
.long 0x1b0b01,0x1be300,0x1663000,0x1663400,0x1663800,0x1663c00,0xffff01f5,0xffffffff
.long 0x1b0b81,0x1be380,0x1664000,0x1664400,0x1664800,0x1686000,0x1f601f5,0xffffffff
.long 0x1b0c01,0x1be400,0x1686400,0x1686800,0x1686c00,0x1687000,0xffff01f6,0xffffffff
.long 0x1b0c81,0x1be480,0x1687400,0x1687800,0x16a9000,0x16a9400,0x1f701f6,0xffffffff
.long 0x1b0d01,0x1be500,0x16a9800,0x16a9c00,0x16aa000,0x16aa400,0xffff01f7,0xffffffff
.long 0x1d8801,0x1e6000,0x149dc00,0x149e000,0x149e400,0x149e800,0xffff01e8,0xffffffff
.long 0x1d8881,0x1e6080,0x149ec00,0x149f000,0x149f400,0x14c0c00,0x1e901e8,0xffffffff
.long 0x1d8901,0x1e6100,0x14c1000,0x14c1400,0x14c1800,0x14c1c00,0xffff01e9,0xffffffff
.long 0x1d8981,0x1e6180,0x14c2000,0x14c2400,0x14e3c00,0x14e4000,0x1ea01e9,0xffffffff
.long 0x1d8a01,0x1e6200,0x14e4400,0x14e4800,0x14e4c00,0x14e5000,0xffff01ea,0xffffffff
.long 0x1d8a81,0x1e6280,0x14e5400,0x1506c00,0x1507000,0x1507400,0x1eb01ea,0xffffffff
.long 0x1d8b01,0x1e6300,0x1507800,0x1507c00,0x1508000,0x1529c00,0x1ec01eb,0xffffffff
.long 0x1d8b81,0x1e6380,0x152a000,0x152a400,0x152a800,0x152ac00,0xffff01ec,0xffffffff
.long 0x1d8c01,0x1e6400,0x152b000,0x152b400,0x154cc00,0x154d000,0x1ed01ec,0xffffffff
.long 0x1d8c81,0x1e6480,0x154d400,0x154d800,0x154dc00,0x154e000,0xffff01ed,0xffffffff
.long 0x1d8d01,0x1e6500,0x154e400,0x156fc00,0x1570000,0x1570400,0x1ee01ed,0xffffffff
.long 0x1d8d81,0x1e6580,0x1570800,0x1570c00,0x1571000,0x1571400,0xffff01ee,0xffffffff
.long 0x1d8e01,0x1e6600,0x1592c00,0x1593000,0x1593400,0x1593800,0xffff01ef,0xffffffff
.long 0x1d8e81,0x1e6680,0x1593c00,0x1594000,0x15b5c00,0x15b6000,0x1f001ef,0xffffffff
.long 0x1d8f01,0x1e6700,0x15b6400,0x15b6800,0x15b6c00,0x15b7000,0xffff01f0,0xffffffff
.long 0x1d8f81,0x1e6780,0x15b7400,0x15d8c00,0x15d9000,0x15d9400,0x1f101f0,0xffffffff
.long 0x1d9001,0x1e6800,0x15d9800,0x15d9c00,0x15da000,0x15da400,0xffff01f1,0xffffffff
.long 0x1d9081,0x1e6880,0x15fbc00,0x15fc000,0x15fc400,0x15fc800,0xffff01f2,0xffffffff
.long 0x1d9101,0x1e6900,0x15fcc00,0x15fd000,0x15fd400,0x161ec00,0x1f301f2,0xffffffff
.long 0x1d9181,0x1e6980,0x161f000,0x161f400,0x161f800,0x161fc00,0xffff01f3,0xffffffff
.long 0x1d9201,0x1e6a00,0x1620000,0x1641c00,0x1642000,0x1642400,0x1f401f3,0xffffffff
.long 0x1d9281,0x1e6a80,0x1642800,0x1642c00,0x1643000,0x1643400,0xffff01f4,0xffffffff
.long 0x1d9301,0x1e6b00,0x1664c00,0x1665000,0x1665400,0x1665800,0xffff01f5,0xffffffff
.long 0x1d9381,0x1e6b80,0x1665c00,0x1666000,0x1666400,0x1687c00,0x1f601f5,0xffffffff
.long 0x1d9401,0x1e6c00,0x1688000,0x1688400,0x1688800,0x1688c00,0xffff01f6,0xffffffff
.long 0x1d9481,0x1e6c80,0x1689000,0x1689400,0x16aac00,0x16ab000,0x1f701f6,0xffffffff
.long 0x1d9501,0x1e6d00,0x16ab400,0x16ab800,0x16abc00,0x16ac000,0xffff01f7,0xffffffff
.long 0x1f3801,0x201000,0x149f800,0x149fc00,0x14a0000,0x14a0400,0xffff01e8,0xffffffff
.long 0x1f3881,0x201080,0x14a0800,0x14a0c00,0x14a1000,0x14c2800,0x1e901e8,0xffffffff
.long 0x1f3901,0x201100,0x14c2c00,0x14c3000,0x14c3400,0x14c3800,0xffff01e9,0xffffffff
.long 0x1f3981,0x201180,0x14c3c00,0x14c4000,0x14e5800,0x14e5c00,0x1ea01e9,0xffffffff
.long 0x1f3a01,0x201200,0x14e6000,0x14e6400,0x14e6800,0x14e6c00,0xffff01ea,0xffffffff
.long 0x1f3a81,0x201280,0x14e7000,0x1508800,0x1508c00,0x1509000,0x1eb01ea,0xffffffff
.long 0x1f3b01,0x201300,0x1509400,0x1509800,0x1509c00,0x152b800,0x1ec01eb,0xffffffff
.long 0x1f3b81,0x201380,0x152bc00,0x152c000,0x152c400,0x152c800,0xffff01ec,0xffffffff
.long 0x1f3c01,0x201400,0x152cc00,0x152d000,0x154e800,0x154ec00,0x1ed01ec,0xffffffff
.long 0x1f3c81,0x201480,0x154f000,0x154f400,0x154f800,0x154fc00,0xffff01ed,0xffffffff
.long 0x1f3d01,0x201500,0x1550000,0x1571800,0x1571c00,0x1572000,0x1ee01ed,0xffffffff
.long 0x1f3d81,0x201580,0x1572400,0x1572800,0x1572c00,0x1573000,0xffff01ee,0xffffffff
.long 0x1f3e01,0x201600,0x1594800,0x1594c00,0x1595000,0x1595400,0xffff01ef,0xffffffff
.long 0x1f3e81,0x201680,0x1595800,0x1595c00,0x15b7800,0x15b7c00,0x1f001ef,0xffffffff
.long 0x1f3f01,0x201700,0x15b8000,0x15b8400,0x15b8800,0x15b8c00,0xffff01f0,0xffffffff
.long 0x1f3f81,0x201780,0x15b9000,0x15da800,0x15dac00,0x15db000,0x1f101f0,0xffffffff
.long 0x1f4001,0x201800,0x15db400,0x15db800,0x15dbc00,0x15dc000,0xffff01f1,0xffffffff
.long 0x1f4081,0x201880,0x15fd800,0x15fdc00,0x15fe000,0x15fe400,0xffff01f2,0xffffffff
.long 0x1f4101,0x201900,0x15fe800,0x15fec00,0x15ff000,0x1620800,0x1f301f2,0xffffffff
.long 0x1f4181,0x201980,0x1620c00,0x1621000,0x1621400,0x1621800,0xffff01f3,0xffffffff
.long 0x1f4201,0x201a00,0x1621c00,0x1643800,0x1643c00,0x1644000,0x1f401f3,0xffffffff
.long 0x1f4281,0x201a80,0x1644400,0x1644800,0x1644c00,0x1645000,0xffff01f4,0xffffffff
.long 0x1f4301,0x201b00,0x1666800,0x1666c00,0x1667000,0x1667400,0xffff01f5,0xffffffff
.long 0x1f4381,0x201b80,0x1667800,0x1667c00,0x1668000,0x1689800,0x1f601f5,0xffffffff
.long 0x1f4401,0x201c00,0x1689c00,0x168a000,0x168a400,0x168a800,0xffff01f6,0xffffffff
.long 0x1f4481,0x201c80,0x168ac00,0x168b000,0x16ac800,0x16acc00,0x1f701f6,0xffffffff
.long 0x1f4501,0x201d00,0x16ad000,0x16ad400,0x16ad800,0x16adc00,0xffff01f7,0xffffffff
.long 0x1cb001,0x20e800,0x14a1400,0x14a1800,0x14a1c00,0x14a2000,0xffff01e8,0xffffffff
.long 0x1cb081,0x20e880,0x14a2400,0x14a2800,0x14a2c00,0x14c4400,0x1e901e8,0xffffffff
.long 0x1cb101,0x20e900,0x14c4800,0x14c4c00,0x14c5000,0x14c5400,0xffff01e9,0xffffffff
.long 0x1cb181,0x20e980,0x14c5800,0x14c5c00,0x14e7400,0x14e7800,0x1ea01e9,0xffffffff
.long 0x1cb201,0x20ea00,0x14e7c00,0x14e8000,0x14e8400,0x14e8800,0xffff01ea,0xffffffff
.long 0x1cb281,0x20ea80,0x14e8c00,0x150a400,0x150a800,0x150ac00,0x1eb01ea,0xffffffff
.long 0x1cb301,0x20eb00,0x150b000,0x150b400,0x150b800,0x152d400,0x1ec01eb,0xffffffff
.long 0x1cb381,0x20eb80,0x152d800,0x152dc00,0x152e000,0x152e400,0xffff01ec,0xffffffff
.long 0x1cb401,0x20ec00,0x152e800,0x152ec00,0x1550400,0x1550800,0x1ed01ec,0xffffffff
.long 0x1cb481,0x20ec80,0x1550c00,0x1551000,0x1551400,0x1551800,0xffff01ed,0xffffffff
.long 0x1cb501,0x20ed00,0x1551c00,0x1573400,0x1573800,0x1573c00,0x1ee01ed,0xffffffff
.long 0x1cb581,0x20ed80,0x1574000,0x1574400,0x1574800,0x1574c00,0xffff01ee,0xffffffff
.long 0x1cb601,0x20ee00,0x1596400,0x1596800,0x1596c00,0x1597000,0xffff01ef,0xffffffff
.long 0x1cb681,0x20ee80,0x1597400,0x1597800,0x15b9400,0x15b9800,0x1f001ef,0xffffffff
.long 0x1cb701,0x20ef00,0x15b9c00,0x15ba000,0x15ba400,0x15ba800,0xffff01f0,0xffffffff
.long 0x1cb781,0x20ef80,0x15bac00,0x15dc400,0x15dc800,0x15dcc00,0x1f101f0,0xffffffff
.long 0x1cb801,0x20f000,0x15dd000,0x15dd400,0x15dd800,0x15ddc00,0xffff01f1,0xffffffff
.long 0x1cb881,0x20f080,0x15ff400,0x15ff800,0x15ffc00,0x1600000,0xffff01f2,0xffffffff
.long 0x1cb901,0x20f100,0x1600400,0x1600800,0x1600c00,0x1622400,0x1f301f2,0xffffffff
.long 0x1cb981,0x20f180,0x1622800,0x1622c00,0x1623000,0x1623400,0xffff01f3,0xffffffff
.long 0x1cba01,0x20f200,0x1623800,0x1645400,0x1645800,0x1645c00,0x1f401f3,0xffffffff
.long 0x1cba81,0x20f280,0x1646000,0x1646400,0x1646800,0x1646c00,0xffff01f4,0xffffffff
.long 0x1cbb01,0x20f300,0x1668400,0x1668800,0x1668c00,0x1669000,0xffff01f5,0xffffffff
.long 0x1cbb81,0x20f380,0x1669400,0x1669800,0x1669c00,0x168b400,0x1f601f5,0xffffffff
.long 0x1cbc01,0x20f400,0x168b800,0x168bc00,0x168c000,0x168c400,0xffff01f6,0xffffffff
.long 0x1cbc81,0x20f480,0x168c800,0x168cc00,0x16ae400,0x16ae800,0x1f701f6,0xffffffff
.long 0x1cbd01,0x20f500,0x16aec00,0x16af000,0x16af400,0x16af800,0xffff01f7,0xffffffff
.long 0x2,0x5000,0x1160000,0x1160400,0x1160800,0x1160c00,0xffff01a0,0xffffffff
.long 0x82,0x5080,0x1161000,0x11a6000,0x11a6400,0x11a6800,0x1a401a0,0xffffffff
.long 0x102,0x5100,0x11a6c00,0x11a7000,0x11ec000,0x11ec400,0x1a801a4,0xffffffff
.long 0x182,0x5180,0x11ec800,0x11ecc00,0x11ed000,0x1232000,0x1ac01a8,0xffffffff
.long 0x202,0x5200,0x1232400,0x1232800,0x1232c00,0x1233000,0xffff01ac,0xffffffff
.long 0x282,0x5280,0x1278000,0x1278400,0x1278800,0x1278c00,0xffff01b0,0xffffffff
.long 0x302,0x5300,0x1279000,0x12be000,0x12be400,0x12be800,0x1b401b0,0xffffffff
.long 0x382,0x5380,0x12bec00,0x12bf000,0x1304000,0x1304400,0x1b801b4,0xffffffff
.long 0x402,0x5400,0x1304800,0x1304c00,0x1305000,0x134a000,0x1bc01b8,0xffffffff
.long 0x482,0x5480,0x134a400,0x134a800,0x134ac00,0x134b000,0xffff01bc,0xffffffff
.long 0xa002,0xf000,0x1161400,0x1161800,0x1161c00,0x1162000,0xffff01a0,0xffffffff
.long 0xa082,0xf080,0x1162400,0x11a7400,0x11a7800,0x11a7c00,0x1a401a0,0xffffffff
.long 0xa102,0xf100,0x11a8000,0x11a8400,0x11ed400,0x11ed800,0x1a801a4,0xffffffff
.long 0xa182,0xf180,0x11edc00,0x11ee000,0x11ee400,0x1233400,0x1ac01a8,0xffffffff
.long 0xa202,0xf200,0x1233800,0x1233c00,0x1234000,0x1234400,0xffff01ac,0xffffffff
.long 0xa282,0xf280,0x1279400,0x1279800,0x1279c00,0x127a000,0xffff01b0,0xffffffff
.long 0xa302,0xf300,0x127a400,0x12bf400,0x12bf800,0x12bfc00,0x1b401b0,0xffffffff
.long 0xa382,0xf380,0x12c0000,0x12c0400,0x1305400,0x1305800,0x1b801b4,0xffffffff
.long 0xa402,0xf400,0x1305c00,0x1306000,0x1306400,0x134b400,0x1bc01b8,0xffffffff
.long 0xa482,0xf480,0x134b800,0x134bc00,0x134c000,0x134c400,0xffff01bc,0xffffffff
.long 0x14002,0x19000,0x1162800,0x1162c00,0x1163000,0x1163400,0xffff01a0,0xffffffff
.long 0x14082,0x19080,0x1163800,0x11a8800,0x11a8c00,0x11a9000,0x1a401a0,0xffffffff
.long 0x14102,0x19100,0x11a9400,0x11a9800,0x11ee800,0x11eec00,0x1a801a4,0xffffffff
.long 0x14182,0x19180,0x11ef000,0x11ef400,0x11ef800,0x1234800,0x1ac01a8,0xffffffff
.long 0x14202,0x19200,0x1234c00,0x1235000,0x1235400,0x1235800,0xffff01ac,0xffffffff
.long 0x14282,0x19280,0x127a800,0x127ac00,0x127b000,0x127b400,0xffff01b0,0xffffffff
.long 0x14302,0x19300,0x127b800,0x12c0800,0x12c0c00,0x12c1000,0x1b401b0,0xffffffff
.long 0x14382,0x19380,0x12c1400,0x12c1800,0x1306800,0x1306c00,0x1b801b4,0xffffffff
.long 0x14402,0x19400,0x1307000,0x1307400,0x1307800,0x134c800,0x1bc01b8,0xffffffff
.long 0x14482,0x19480,0x134cc00,0x134d000,0x134d400,0x134d800,0xffff01bc,0xffffffff
.long 0x23002,0x28000,0x1163c00,0x1164000,0x1164400,0x1164800,0xffff01a0,0xffffffff
.long 0x23082,0x28080,0x1164c00,0x11a9c00,0x11aa000,0x11aa400,0x1a401a0,0xffffffff
.long 0x23102,0x28100,0x11aa800,0x11aac00,0x11efc00,0x11f0000,0x1a801a4,0xffffffff
.long 0x23182,0x28180,0x11f0400,0x11f0800,0x11f0c00,0x1235c00,0x1ac01a8,0xffffffff
.long 0x23202,0x28200,0x1236000,0x1236400,0x1236800,0x1236c00,0xffff01ac,0xffffffff
.long 0x23282,0x28280,0x127bc00,0x127c000,0x127c400,0x127c800,0xffff01b0,0xffffffff
.long 0x23302,0x28300,0x127cc00,0x12c1c00,0x12c2000,0x12c2400,0x1b401b0,0xffffffff
.long 0x23382,0x28380,0x12c2800,0x12c2c00,0x1307c00,0x1308000,0x1b801b4,0xffffffff
.long 0x23402,0x28400,0x1308400,0x1308800,0x1308c00,0x134dc00,0x1bc01b8,0xffffffff
.long 0x23482,0x28480,0x134e000,0x134e400,0x134e800,0x134ec00,0xffff01bc,0xffffffff
.long 0x2d002,0x32000,0x1165000,0x1165400,0x1165800,0x1165c00,0xffff01a0,0xffffffff
.long 0x2d082,0x32080,0x1166000,0x11ab000,0x11ab400,0x11ab800,0x1a401a0,0xffffffff
.long 0x2d102,0x32100,0x11abc00,0x11ac000,0x11f1000,0x11f1400,0x1a801a4,0xffffffff
.long 0x2d182,0x32180,0x11f1800,0x11f1c00,0x11f2000,0x1237000,0x1ac01a8,0xffffffff
.long 0x2d202,0x32200,0x1237400,0x1237800,0x1237c00,0x1238000,0xffff01ac,0xffffffff
.long 0x2d282,0x32280,0x127d000,0x127d400,0x127d800,0x127dc00,0xffff01b0,0xffffffff
.long 0x2d302,0x32300,0x127e000,0x12c3000,0x12c3400,0x12c3800,0x1b401b0,0xffffffff
.long 0x2d382,0x32380,0x12c3c00,0x12c4000,0x1309000,0x1309400,0x1b801b4,0xffffffff
.long 0x2d402,0x32400,0x1309800,0x1309c00,0x130a000,0x134f000,0x1bc01b8,0xffffffff
.long 0x2d482,0x32480,0x134f400,0x134f800,0x134fc00,0x1350000,0xffff01bc,0xffffffff
.long 0x37002,0x3c000,0x1166400,0x1166800,0x1166c00,0x1167000,0xffff01a0,0xffffffff
.long 0x37082,0x3c080,0x1167400,0x11ac400,0x11ac800,0x11acc00,0x1a401a0,0xffffffff
.long 0x37102,0x3c100,0x11ad000,0x11ad400,0x11f2400,0x11f2800,0x1a801a4,0xffffffff
.long 0x37182,0x3c180,0x11f2c00,0x11f3000,0x11f3400,0x1238400,0x1ac01a8,0xffffffff
.long 0x37202,0x3c200,0x1238800,0x1238c00,0x1239000,0x1239400,0xffff01ac,0xffffffff
.long 0x37282,0x3c280,0x127e400,0x127e800,0x127ec00,0x127f000,0xffff01b0,0xffffffff
.long 0x37302,0x3c300,0x127f400,0x12c4400,0x12c4800,0x12c4c00,0x1b401b0,0xffffffff
.long 0x37382,0x3c380,0x12c5000,0x12c5400,0x130a400,0x130a800,0x1b801b4,0xffffffff
.long 0x37402,0x3c400,0x130ac00,0x130b000,0x130b400,0x1350400,0x1bc01b8,0xffffffff
.long 0x37482,0x3c480,0x1350800,0x1350c00,0x1351000,0x1351400,0xffff01bc,0xffffffff
.long 0x46002,0x4b000,0x1167800,0x1167c00,0x1168000,0x1168400,0xffff01a0,0xffffffff
.long 0x46082,0x4b080,0x1168800,0x11ad800,0x11adc00,0x11ae000,0x1a401a0,0xffffffff
.long 0x46102,0x4b100,0x11ae400,0x11ae800,0x11f3800,0x11f3c00,0x1a801a4,0xffffffff
.long 0x46182,0x4b180,0x11f4000,0x11f4400,0x11f4800,0x1239800,0x1ac01a8,0xffffffff
.long 0x46202,0x4b200,0x1239c00,0x123a000,0x123a400,0x123a800,0xffff01ac,0xffffffff
.long 0x46282,0x4b280,0x127f800,0x127fc00,0x1280000,0x1280400,0xffff01b0,0xffffffff
.long 0x46302,0x4b300,0x1280800,0x12c5800,0x12c5c00,0x12c6000,0x1b401b0,0xffffffff
.long 0x46382,0x4b380,0x12c6400,0x12c6800,0x130b800,0x130bc00,0x1b801b4,0xffffffff
.long 0x46402,0x4b400,0x130c000,0x130c400,0x130c800,0x1351800,0x1bc01b8,0xffffffff
.long 0x46482,0x4b480,0x1351c00,0x1352000,0x1352400,0x1352800,0xffff01bc,0xffffffff
.long 0x50002,0x55000,0x1168c00,0x1169000,0x1169400,0x1169800,0xffff01a0,0xffffffff
.long 0x50082,0x55080,0x1169c00,0x11aec00,0x11af000,0x11af400,0x1a401a0,0xffffffff
.long 0x50102,0x55100,0x11af800,0x11afc00,0x11f4c00,0x11f5000,0x1a801a4,0xffffffff
.long 0x50182,0x55180,0x11f5400,0x11f5800,0x11f5c00,0x123ac00,0x1ac01a8,0xffffffff
.long 0x50202,0x55200,0x123b000,0x123b400,0x123b800,0x123bc00,0xffff01ac,0xffffffff
.long 0x50282,0x55280,0x1280c00,0x1281000,0x1281400,0x1281800,0xffff01b0,0xffffffff
.long 0x50302,0x55300,0x1281c00,0x12c6c00,0x12c7000,0x12c7400,0x1b401b0,0xffffffff
.long 0x50382,0x55380,0x12c7800,0x12c7c00,0x130cc00,0x130d000,0x1b801b4,0xffffffff
.long 0x50402,0x55400,0x130d400,0x130d800,0x130dc00,0x1352c00,0x1bc01b8,0xffffffff
.long 0x50482,0x55480,0x1353000,0x1353400,0x1353800,0x1353c00,0xffff01bc,0xffffffff
.long 0x5a002,0x5f000,0x116a000,0x116a400,0x116a800,0x116ac00,0xffff01a0,0xffffffff
.long 0x5a082,0x5f080,0x116b000,0x11b0000,0x11b0400,0x11b0800,0x1a401a0,0xffffffff
.long 0x5a102,0x5f100,0x11b0c00,0x11b1000,0x11f6000,0x11f6400,0x1a801a4,0xffffffff
.long 0x5a182,0x5f180,0x11f6800,0x11f6c00,0x11f7000,0x123c000,0x1ac01a8,0xffffffff
.long 0x5a202,0x5f200,0x123c400,0x123c800,0x123cc00,0x123d000,0xffff01ac,0xffffffff
.long 0x5a282,0x5f280,0x1282000,0x1282400,0x1282800,0x1282c00,0xffff01b0,0xffffffff
.long 0x5a302,0x5f300,0x1283000,0x12c8000,0x12c8400,0x12c8800,0x1b401b0,0xffffffff
.long 0x5a382,0x5f380,0x12c8c00,0x12c9000,0x130e000,0x130e400,0x1b801b4,0xffffffff
.long 0x5a402,0x5f400,0x130e800,0x130ec00,0x130f000,0x1354000,0x1bc01b8,0xffffffff
.long 0x5a482,0x5f480,0x1354400,0x1354800,0x1354c00,0x1355000,0xffff01bc,0xffffffff
.long 0x69002,0x6e000,0x116b400,0x116b800,0x116bc00,0x116c000,0xffff01a0,0xffffffff
.long 0x69082,0x6e080,0x116c400,0x11b1400,0x11b1800,0x11b1c00,0x1a401a0,0xffffffff
.long 0x69102,0x6e100,0x11b2000,0x11b2400,0x11f7400,0x11f7800,0x1a801a4,0xffffffff
.long 0x69182,0x6e180,0x11f7c00,0x11f8000,0x11f8400,0x123d400,0x1ac01a8,0xffffffff
.long 0x69202,0x6e200,0x123d800,0x123dc00,0x123e000,0x123e400,0xffff01ac,0xffffffff
.long 0x69282,0x6e280,0x1283400,0x1283800,0x1283c00,0x1284000,0xffff01b0,0xffffffff
.long 0x69302,0x6e300,0x1284400,0x12c9400,0x12c9800,0x12c9c00,0x1b401b0,0xffffffff
.long 0x69382,0x6e380,0x12ca000,0x12ca400,0x130f400,0x130f800,0x1b801b4,0xffffffff
.long 0x69402,0x6e400,0x130fc00,0x1310000,0x1310400,0x1355400,0x1bc01b8,0xffffffff
.long 0x69482,0x6e480,0x1355800,0x1355c00,0x1356000,0x1356400,0xffff01bc,0xffffffff
.long 0x73002,0x78000,0x116c800,0x116cc00,0x116d000,0x116d400,0xffff01a0,0xffffffff
.long 0x73082,0x78080,0x116d800,0x11b2800,0x11b2c00,0x11b3000,0x1a401a0,0xffffffff
.long 0x73102,0x78100,0x11b3400,0x11b3800,0x11f8800,0x11f8c00,0x1a801a4,0xffffffff
.long 0x73182,0x78180,0x11f9000,0x11f9400,0x11f9800,0x123e800,0x1ac01a8,0xffffffff
.long 0x73202,0x78200,0x123ec00,0x123f000,0x123f400,0x123f800,0xffff01ac,0xffffffff
.long 0x73282,0x78280,0x1284800,0x1284c00,0x1285000,0x1285400,0xffff01b0,0xffffffff
.long 0x73302,0x78300,0x1285800,0x12ca800,0x12cac00,0x12cb000,0x1b401b0,0xffffffff
.long 0x73382,0x78380,0x12cb400,0x12cb800,0x1310800,0x1310c00,0x1b801b4,0xffffffff
.long 0x73402,0x78400,0x1311000,0x1311400,0x1311800,0x1356800,0x1bc01b8,0xffffffff
.long 0x73482,0x78480,0x1356c00,0x1357000,0x1357400,0x1357800,0xffff01bc,0xffffffff
.long 0x7d002,0x82000,0x116dc00,0x116e000,0x116e400,0x116e800,0xffff01a0,0xffffffff
.long 0x7d082,0x82080,0x116ec00,0x11b3c00,0x11b4000,0x11b4400,0x1a401a0,0xffffffff
.long 0x7d102,0x82100,0x11b4800,0x11b4c00,0x11f9c00,0x11fa000,0x1a801a4,0xffffffff
.long 0x7d182,0x82180,0x11fa400,0x11fa800,0x11fac00,0x123fc00,0x1ac01a8,0xffffffff
.long 0x7d202,0x82200,0x1240000,0x1240400,0x1240800,0x1240c00,0xffff01ac,0xffffffff
.long 0x7d282,0x82280,0x1285c00,0x1286000,0x1286400,0x1286800,0xffff01b0,0xffffffff
.long 0x7d302,0x82300,0x1286c00,0x12cbc00,0x12cc000,0x12cc400,0x1b401b0,0xffffffff
.long 0x7d382,0x82380,0x12cc800,0x12ccc00,0x1311c00,0x1312000,0x1b801b4,0xffffffff
.long 0x7d402,0x82400,0x1312400,0x1312800,0x1312c00,0x1357c00,0x1bc01b8,0xffffffff
.long 0x7d482,0x82480,0x1358000,0x1358400,0x1358800,0x1358c00,0xffff01bc,0xffffffff
.long 0x1e002,0x41000,0x116f000,0x116f400,0x116f800,0x116fc00,0xffff01a0,0xffffffff
.long 0x1e082,0x41080,0x1170000,0x11b5000,0x11b5400,0x11b5800,0x1a401a0,0xffffffff
.long 0x1e102,0x41100,0x11b5c00,0x11b6000,0x11fb000,0x11fb400,0x1a801a4,0xffffffff
.long 0x1e182,0x41180,0x11fb800,0x11fbc00,0x11fc000,0x1241000,0x1ac01a8,0xffffffff
.long 0x1e202,0x41200,0x1241400,0x1241800,0x1241c00,0x1242000,0xffff01ac,0xffffffff
.long 0x1e282,0x41280,0x1287000,0x1287400,0x1287800,0x1287c00,0xffff01b0,0xffffffff
.long 0x1e302,0x41300,0x1288000,0x12cd000,0x12cd400,0x12cd800,0x1b401b0,0xffffffff
.long 0x1e382,0x41380,0x12cdc00,0x12ce000,0x1313000,0x1313400,0x1b801b4,0xffffffff
.long 0x1e402,0x41400,0x1313800,0x1313c00,0x1314000,0x1359000,0x1bc01b8,0xffffffff
.long 0x1e482,0x41480,0x1359400,0x1359800,0x1359c00,0x135a000,0xffff01bc,0xffffffff
.long 0x87002,0x8c000,0x1171800,0x1171c00,0x1172000,0x1172400,0xffff01a1,0xffffffff
.long 0x87082,0x8c080,0x1172800,0x11b7800,0x11b7c00,0x11b8000,0x1a501a1,0xffffffff
.long 0x87102,0x8c100,0x11b8400,0x11b8800,0x11fd800,0x11fdc00,0x1a901a5,0xffffffff
.long 0x87182,0x8c180,0x11fe000,0x11fe400,0x11fe800,0x1243800,0x1ad01a9,0xffffffff
.long 0x87202,0x8c200,0x1243c00,0x1244000,0x1244400,0x1244800,0xffff01ad,0xffffffff
.long 0x87282,0x8c280,0x1289800,0x1289c00,0x128a000,0x128a400,0xffff01b1,0xffffffff
.long 0x87302,0x8c300,0x128a800,0x12cf800,0x12cfc00,0x12d0000,0x1b501b1,0xffffffff
.long 0x87382,0x8c380,0x12d0400,0x12d0800,0x1315800,0x1315c00,0x1b901b5,0xffffffff
.long 0x87402,0x8c400,0x1316000,0x1316400,0x1316800,0x135b800,0x1bd01b9,0xffffffff
.long 0x87482,0x8c480,0x135bc00,0x135c000,0x135c400,0x135c800,0xffff01bd,0xffffffff
.long 0x91002,0x96000,0x1172c00,0x1173000,0x1173400,0x1173800,0xffff01a1,0xffffffff
.long 0x91082,0x96080,0x1173c00,0x11b8c00,0x11b9000,0x11b9400,0x1a501a1,0xffffffff
.long 0x91102,0x96100,0x11b9800,0x11b9c00,0x11fec00,0x11ff000,0x1a901a5,0xffffffff
.long 0x91182,0x96180,0x11ff400,0x11ff800,0x11ffc00,0x1244c00,0x1ad01a9,0xffffffff
.long 0x91202,0x96200,0x1245000,0x1245400,0x1245800,0x1245c00,0xffff01ad,0xffffffff
.long 0x91282,0x96280,0x128ac00,0x128b000,0x128b400,0x128b800,0xffff01b1,0xffffffff
.long 0x91302,0x96300,0x128bc00,0x12d0c00,0x12d1000,0x12d1400,0x1b501b1,0xffffffff
.long 0x91382,0x96380,0x12d1800,0x12d1c00,0x1316c00,0x1317000,0x1b901b5,0xffffffff
.long 0x91402,0x96400,0x1317400,0x1317800,0x1317c00,0x135cc00,0x1bd01b9,0xffffffff
.long 0x91482,0x96480,0x135d000,0x135d400,0x135d800,0x135dc00,0xffff01bd,0xffffffff
.long 0x9b002,0xa0000,0x1174000,0x1174400,0x1174800,0x1174c00,0xffff01a1,0xffffffff
.long 0x9b082,0xa0080,0x1175000,0x11ba000,0x11ba400,0x11ba800,0x1a501a1,0xffffffff
.long 0x9b102,0xa0100,0x11bac00,0x11bb000,0x1200000,0x1200400,0x1a901a5,0xffffffff
.long 0x9b182,0xa0180,0x1200800,0x1200c00,0x1201000,0x1246000,0x1ad01a9,0xffffffff
.long 0x9b202,0xa0200,0x1246400,0x1246800,0x1246c00,0x1247000,0xffff01ad,0xffffffff
.long 0x9b282,0xa0280,0x128c000,0x128c400,0x128c800,0x128cc00,0xffff01b1,0xffffffff
.long 0x9b302,0xa0300,0x128d000,0x12d2000,0x12d2400,0x12d2800,0x1b501b1,0xffffffff
.long 0x9b382,0xa0380,0x12d2c00,0x12d3000,0x1318000,0x1318400,0x1b901b5,0xffffffff
.long 0x9b402,0xa0400,0x1318800,0x1318c00,0x1319000,0x135e000,0x1bd01b9,0xffffffff
.long 0x9b482,0xa0480,0x135e400,0x135e800,0x135ec00,0x135f000,0xffff01bd,0xffffffff
.long 0xaa002,0xaf000,0x1175400,0x1175800,0x1175c00,0x1176000,0xffff01a1,0xffffffff
.long 0xaa082,0xaf080,0x1176400,0x11bb400,0x11bb800,0x11bbc00,0x1a501a1,0xffffffff
.long 0xaa102,0xaf100,0x11bc000,0x11bc400,0x1201400,0x1201800,0x1a901a5,0xffffffff
.long 0xaa182,0xaf180,0x1201c00,0x1202000,0x1202400,0x1247400,0x1ad01a9,0xffffffff
.long 0xaa202,0xaf200,0x1247800,0x1247c00,0x1248000,0x1248400,0xffff01ad,0xffffffff
.long 0xaa282,0xaf280,0x128d400,0x128d800,0x128dc00,0x128e000,0xffff01b1,0xffffffff
.long 0xaa302,0xaf300,0x128e400,0x12d3400,0x12d3800,0x12d3c00,0x1b501b1,0xffffffff
.long 0xaa382,0xaf380,0x12d4000,0x12d4400,0x1319400,0x1319800,0x1b901b5,0xffffffff
.long 0xaa402,0xaf400,0x1319c00,0x131a000,0x131a400,0x135f400,0x1bd01b9,0xffffffff
.long 0xaa482,0xaf480,0x135f800,0x135fc00,0x1360000,0x1360400,0xffff01bd,0xffffffff
.long 0xb4002,0xb9000,0x1176800,0x1176c00,0x1177000,0x1177400,0xffff01a1,0xffffffff
.long 0xb4082,0xb9080,0x1177800,0x11bc800,0x11bcc00,0x11bd000,0x1a501a1,0xffffffff
.long 0xb4102,0xb9100,0x11bd400,0x11bd800,0x1202800,0x1202c00,0x1a901a5,0xffffffff
.long 0xb4182,0xb9180,0x1203000,0x1203400,0x1203800,0x1248800,0x1ad01a9,0xffffffff
.long 0xb4202,0xb9200,0x1248c00,0x1249000,0x1249400,0x1249800,0xffff01ad,0xffffffff
.long 0xb4282,0xb9280,0x128e800,0x128ec00,0x128f000,0x128f400,0xffff01b1,0xffffffff
.long 0xb4302,0xb9300,0x128f800,0x12d4800,0x12d4c00,0x12d5000,0x1b501b1,0xffffffff
.long 0xb4382,0xb9380,0x12d5400,0x12d5800,0x131a800,0x131ac00,0x1b901b5,0xffffffff
.long 0xb4402,0xb9400,0x131b000,0x131b400,0x131b800,0x1360800,0x1bd01b9,0xffffffff
.long 0xb4482,0xb9480,0x1360c00,0x1361000,0x1361400,0x1361800,0xffff01bd,0xffffffff
.long 0xbe002,0xc3000,0x1177c00,0x1178000,0x1178400,0x1178800,0xffff01a1,0xffffffff
.long 0xbe082,0xc3080,0x1178c00,0x11bdc00,0x11be000,0x11be400,0x1a501a1,0xffffffff
.long 0xbe102,0xc3100,0x11be800,0x11bec00,0x1203c00,0x1204000,0x1a901a5,0xffffffff
.long 0xbe182,0xc3180,0x1204400,0x1204800,0x1204c00,0x1249c00,0x1ad01a9,0xffffffff
.long 0xbe202,0xc3200,0x124a000,0x124a400,0x124a800,0x124ac00,0xffff01ad,0xffffffff
.long 0xbe282,0xc3280,0x128fc00,0x1290000,0x1290400,0x1290800,0xffff01b1,0xffffffff
.long 0xbe302,0xc3300,0x1290c00,0x12d5c00,0x12d6000,0x12d6400,0x1b501b1,0xffffffff
.long 0xbe382,0xc3380,0x12d6800,0x12d6c00,0x131bc00,0x131c000,0x1b901b5,0xffffffff
.long 0xbe402,0xc3400,0x131c400,0x131c800,0x131cc00,0x1361c00,0x1bd01b9,0xffffffff
.long 0xbe482,0xc3480,0x1362000,0x1362400,0x1362800,0x1362c00,0xffff01bd,0xffffffff
.long 0xcd002,0xd2000,0x1179000,0x1179400,0x1179800,0x1179c00,0xffff01a1,0xffffffff
.long 0xcd082,0xd2080,0x117a000,0x11bf000,0x11bf400,0x11bf800,0x1a501a1,0xffffffff
.long 0xcd102,0xd2100,0x11bfc00,0x11c0000,0x1205000,0x1205400,0x1a901a5,0xffffffff
.long 0xcd182,0xd2180,0x1205800,0x1205c00,0x1206000,0x124b000,0x1ad01a9,0xffffffff
.long 0xcd202,0xd2200,0x124b400,0x124b800,0x124bc00,0x124c000,0xffff01ad,0xffffffff
.long 0xcd282,0xd2280,0x1291000,0x1291400,0x1291800,0x1291c00,0xffff01b1,0xffffffff
.long 0xcd302,0xd2300,0x1292000,0x12d7000,0x12d7400,0x12d7800,0x1b501b1,0xffffffff
.long 0xcd382,0xd2380,0x12d7c00,0x12d8000,0x131d000,0x131d400,0x1b901b5,0xffffffff
.long 0xcd402,0xd2400,0x131d800,0x131dc00,0x131e000,0x1363000,0x1bd01b9,0xffffffff
.long 0xcd482,0xd2480,0x1363400,0x1363800,0x1363c00,0x1364000,0xffff01bd,0xffffffff
.long 0xd7002,0xdc000,0x117a400,0x117a800,0x117ac00,0x117b000,0xffff01a1,0xffffffff
.long 0xd7082,0xdc080,0x117b400,0x11c0400,0x11c0800,0x11c0c00,0x1a501a1,0xffffffff
.long 0xd7102,0xdc100,0x11c1000,0x11c1400,0x1206400,0x1206800,0x1a901a5,0xffffffff
.long 0xd7182,0xdc180,0x1206c00,0x1207000,0x1207400,0x124c400,0x1ad01a9,0xffffffff
.long 0xd7202,0xdc200,0x124c800,0x124cc00,0x124d000,0x124d400,0xffff01ad,0xffffffff
.long 0xd7282,0xdc280,0x1292400,0x1292800,0x1292c00,0x1293000,0xffff01b1,0xffffffff
.long 0xd7302,0xdc300,0x1293400,0x12d8400,0x12d8800,0x12d8c00,0x1b501b1,0xffffffff
.long 0xd7382,0xdc380,0x12d9000,0x12d9400,0x131e400,0x131e800,0x1b901b5,0xffffffff
.long 0xd7402,0xdc400,0x131ec00,0x131f000,0x131f400,0x1364400,0x1bd01b9,0xffffffff
.long 0xd7482,0xdc480,0x1364800,0x1364c00,0x1365000,0x1365400,0xffff01bd,0xffffffff
.long 0xe1002,0xe6000,0x117b800,0x117bc00,0x117c000,0x117c400,0xffff01a1,0xffffffff
.long 0xe1082,0xe6080,0x117c800,0x11c1800,0x11c1c00,0x11c2000,0x1a501a1,0xffffffff
.long 0xe1102,0xe6100,0x11c2400,0x11c2800,0x1207800,0x1207c00,0x1a901a5,0xffffffff
.long 0xe1182,0xe6180,0x1208000,0x1208400,0x1208800,0x124d800,0x1ad01a9,0xffffffff
.long 0xe1202,0xe6200,0x124dc00,0x124e000,0x124e400,0x124e800,0xffff01ad,0xffffffff
.long 0xe1282,0xe6280,0x1293800,0x1293c00,0x1294000,0x1294400,0xffff01b1,0xffffffff
.long 0xe1302,0xe6300,0x1294800,0x12d9800,0x12d9c00,0x12da000,0x1b501b1,0xffffffff
.long 0xe1382,0xe6380,0x12da400,0x12da800,0x131f800,0x131fc00,0x1b901b5,0xffffffff
.long 0xe1402,0xe6400,0x1320000,0x1320400,0x1320800,0x1365800,0x1bd01b9,0xffffffff
.long 0xe1482,0xe6480,0x1365c00,0x1366000,0x1366400,0x1366800,0xffff01bd,0xffffffff
.long 0xf0002,0xf5000,0x117cc00,0x117d000,0x117d400,0x117d800,0xffff01a1,0xffffffff
.long 0xf0082,0xf5080,0x117dc00,0x11c2c00,0x11c3000,0x11c3400,0x1a501a1,0xffffffff
.long 0xf0102,0xf5100,0x11c3800,0x11c3c00,0x1208c00,0x1209000,0x1a901a5,0xffffffff
.long 0xf0182,0xf5180,0x1209400,0x1209800,0x1209c00,0x124ec00,0x1ad01a9,0xffffffff
.long 0xf0202,0xf5200,0x124f000,0x124f400,0x124f800,0x124fc00,0xffff01ad,0xffffffff
.long 0xf0282,0xf5280,0x1294c00,0x1295000,0x1295400,0x1295800,0xffff01b1,0xffffffff
.long 0xf0302,0xf5300,0x1295c00,0x12dac00,0x12db000,0x12db400,0x1b501b1,0xffffffff
.long 0xf0382,0xf5380,0x12db800,0x12dbc00,0x1320c00,0x1321000,0x1b901b5,0xffffffff
.long 0xf0402,0xf5400,0x1321400,0x1321800,0x1321c00,0x1366c00,0x1bd01b9,0xffffffff
.long 0xf0482,0xf5480,0x1367000,0x1367400,0x1367800,0x1367c00,0xffff01bd,0xffffffff
.long 0xfa002,0xff000,0x117e000,0x117e400,0x117e800,0x117ec00,0xffff01a1,0xffffffff
.long 0xfa082,0xff080,0x117f000,0x11c4000,0x11c4400,0x11c4800,0x1a501a1,0xffffffff
.long 0xfa102,0xff100,0x11c4c00,0x11c5000,0x120a000,0x120a400,0x1a901a5,0xffffffff
.long 0xfa182,0xff180,0x120a800,0x120ac00,0x120b000,0x1250000,0x1ad01a9,0xffffffff
.long 0xfa202,0xff200,0x1250400,0x1250800,0x1250c00,0x1251000,0xffff01ad,0xffffffff
.long 0xfa282,0xff280,0x1296000,0x1296400,0x1296800,0x1296c00,0xffff01b1,0xffffffff
.long 0xfa302,0xff300,0x1297000,0x12dc000,0x12dc400,0x12dc800,0x1b501b1,0xffffffff
.long 0xfa382,0xff380,0x12dcc00,0x12dd000,0x1322000,0x1322400,0x1b901b5,0xffffffff
.long 0xfa402,0xff400,0x1322800,0x1322c00,0x1323000,0x1368000,0x1bd01b9,0xffffffff
.long 0xfa482,0xff480,0x1368400,0x1368800,0x1368c00,0x1369000,0xffff01bd,0xffffffff
.long 0x104002,0x109000,0x117f400,0x117f800,0x117fc00,0x1180000,0xffff01a1,0xffffffff
.long 0x104082,0x109080,0x1180400,0x11c5400,0x11c5800,0x11c5c00,0x1a501a1,0xffffffff
.long 0x104102,0x109100,0x11c6000,0x11c6400,0x120b400,0x120b800,0x1a901a5,0xffffffff
.long 0x104182,0x109180,0x120bc00,0x120c000,0x120c400,0x1251400,0x1ad01a9,0xffffffff
.long 0x104202,0x109200,0x1251800,0x1251c00,0x1252000,0x1252400,0xffff01ad,0xffffffff
.long 0x104282,0x109280,0x1297400,0x1297800,0x1297c00,0x1298000,0xffff01b1,0xffffffff
.long 0x104302,0x109300,0x1298400,0x12dd400,0x12dd800,0x12ddc00,0x1b501b1,0xffffffff
.long 0x104382,0x109380,0x12de000,0x12de400,0x1323400,0x1323800,0x1b901b5,0xffffffff
.long 0x104402,0x109400,0x1323c00,0x1324000,0x1324400,0x1369400,0x1bd01b9,0xffffffff
.long 0x104482,0x109480,0x1369800,0x1369c00,0x136a000,0x136a400,0xffff01bd,0xffffffff
.long 0xa5002,0xc8000,0x1180800,0x1180c00,0x1181000,0x1181400,0xffff01a1,0xffffffff
.long 0xa5082,0xc8080,0x1181800,0x11c6800,0x11c6c00,0x11c7000,0x1a501a1,0xffffffff
.long 0xa5102,0xc8100,0x11c7400,0x11c7800,0x120c800,0x120cc00,0x1a901a5,0xffffffff
.long 0xa5182,0xc8180,0x120d000,0x120d400,0x120d800,0x1252800,0x1ad01a9,0xffffffff
.long 0xa5202,0xc8200,0x1252c00,0x1253000,0x1253400,0x1253800,0xffff01ad,0xffffffff
.long 0xa5282,0xc8280,0x1298800,0x1298c00,0x1299000,0x1299400,0xffff01b1,0xffffffff
.long 0xa5302,0xc8300,0x1299800,0x12de800,0x12dec00,0x12df000,0x1b501b1,0xffffffff
.long 0xa5382,0xc8380,0x12df400,0x12df800,0x1324800,0x1324c00,0x1b901b5,0xffffffff
.long 0xa5402,0xc8400,0x1325000,0x1325400,0x1325800,0x136a800,0x1bd01b9,0xffffffff
.long 0xa5482,0xc8480,0x136ac00,0x136b000,0x136b400,0x136b800,0xffff01bd,0xffffffff
.long 0x10e002,0x113000,0x1183000,0x1183400,0x1183800,0x1183c00,0xffff01a2,0xffffffff
.long 0x10e082,0x113080,0x1184000,0x11c9000,0x11c9400,0x11c9800,0x1a601a2,0xffffffff
.long 0x10e102,0x113100,0x11c9c00,0x11ca000,0x120f000,0x120f400,0x1aa01a6,0xffffffff
.long 0x10e182,0x113180,0x120f800,0x120fc00,0x1210000,0x1255000,0x1ae01aa,0xffffffff
.long 0x10e202,0x113200,0x1255400,0x1255800,0x1255c00,0x1256000,0xffff01ae,0xffffffff
.long 0x10e282,0x113280,0x129b000,0x129b400,0x129b800,0x129bc00,0xffff01b2,0xffffffff
.long 0x10e302,0x113300,0x129c000,0x12e1000,0x12e1400,0x12e1800,0x1b601b2,0xffffffff
.long 0x10e382,0x113380,0x12e1c00,0x12e2000,0x1327000,0x1327400,0x1ba01b6,0xffffffff
.long 0x10e402,0x113400,0x1327800,0x1327c00,0x1328000,0x136d000,0x1be01ba,0xffffffff
.long 0x10e482,0x113480,0x136d400,0x136d800,0x136dc00,0x136e000,0xffff01be,0xffffffff
.long 0x118002,0x11d000,0x1184400,0x1184800,0x1184c00,0x1185000,0xffff01a2,0xffffffff
.long 0x118082,0x11d080,0x1185400,0x11ca400,0x11ca800,0x11cac00,0x1a601a2,0xffffffff
.long 0x118102,0x11d100,0x11cb000,0x11cb400,0x1210400,0x1210800,0x1aa01a6,0xffffffff
.long 0x118182,0x11d180,0x1210c00,0x1211000,0x1211400,0x1256400,0x1ae01aa,0xffffffff
.long 0x118202,0x11d200,0x1256800,0x1256c00,0x1257000,0x1257400,0xffff01ae,0xffffffff
.long 0x118282,0x11d280,0x129c400,0x129c800,0x129cc00,0x129d000,0xffff01b2,0xffffffff
.long 0x118302,0x11d300,0x129d400,0x12e2400,0x12e2800,0x12e2c00,0x1b601b2,0xffffffff
.long 0x118382,0x11d380,0x12e3000,0x12e3400,0x1328400,0x1328800,0x1ba01b6,0xffffffff
.long 0x118402,0x11d400,0x1328c00,0x1329000,0x1329400,0x136e400,0x1be01ba,0xffffffff
.long 0x118482,0x11d480,0x136e800,0x136ec00,0x136f000,0x136f400,0xffff01be,0xffffffff
.long 0x122002,0x127000,0x1185800,0x1185c00,0x1186000,0x1186400,0xffff01a2,0xffffffff
.long 0x122082,0x127080,0x1186800,0x11cb800,0x11cbc00,0x11cc000,0x1a601a2,0xffffffff
.long 0x122102,0x127100,0x11cc400,0x11cc800,0x1211800,0x1211c00,0x1aa01a6,0xffffffff
.long 0x122182,0x127180,0x1212000,0x1212400,0x1212800,0x1257800,0x1ae01aa,0xffffffff
.long 0x122202,0x127200,0x1257c00,0x1258000,0x1258400,0x1258800,0xffff01ae,0xffffffff
.long 0x122282,0x127280,0x129d800,0x129dc00,0x129e000,0x129e400,0xffff01b2,0xffffffff
.long 0x122302,0x127300,0x129e800,0x12e3800,0x12e3c00,0x12e4000,0x1b601b2,0xffffffff
.long 0x122382,0x127380,0x12e4400,0x12e4800,0x1329800,0x1329c00,0x1ba01b6,0xffffffff
.long 0x122402,0x127400,0x132a000,0x132a400,0x132a800,0x136f800,0x1be01ba,0xffffffff
.long 0x122482,0x127480,0x136fc00,0x1370000,0x1370400,0x1370800,0xffff01be,0xffffffff
.long 0x131002,0x136000,0x1186c00,0x1187000,0x1187400,0x1187800,0xffff01a2,0xffffffff
.long 0x131082,0x136080,0x1187c00,0x11ccc00,0x11cd000,0x11cd400,0x1a601a2,0xffffffff
.long 0x131102,0x136100,0x11cd800,0x11cdc00,0x1212c00,0x1213000,0x1aa01a6,0xffffffff
.long 0x131182,0x136180,0x1213400,0x1213800,0x1213c00,0x1258c00,0x1ae01aa,0xffffffff
.long 0x131202,0x136200,0x1259000,0x1259400,0x1259800,0x1259c00,0xffff01ae,0xffffffff
.long 0x131282,0x136280,0x129ec00,0x129f000,0x129f400,0x129f800,0xffff01b2,0xffffffff
.long 0x131302,0x136300,0x129fc00,0x12e4c00,0x12e5000,0x12e5400,0x1b601b2,0xffffffff
.long 0x131382,0x136380,0x12e5800,0x12e5c00,0x132ac00,0x132b000,0x1ba01b6,0xffffffff
.long 0x131402,0x136400,0x132b400,0x132b800,0x132bc00,0x1370c00,0x1be01ba,0xffffffff
.long 0x131482,0x136480,0x1371000,0x1371400,0x1371800,0x1371c00,0xffff01be,0xffffffff
.long 0x13b002,0x140000,0x1188000,0x1188400,0x1188800,0x1188c00,0xffff01a2,0xffffffff
.long 0x13b082,0x140080,0x1189000,0x11ce000,0x11ce400,0x11ce800,0x1a601a2,0xffffffff
.long 0x13b102,0x140100,0x11cec00,0x11cf000,0x1214000,0x1214400,0x1aa01a6,0xffffffff
.long 0x13b182,0x140180,0x1214800,0x1214c00,0x1215000,0x125a000,0x1ae01aa,0xffffffff
.long 0x13b202,0x140200,0x125a400,0x125a800,0x125ac00,0x125b000,0xffff01ae,0xffffffff
.long 0x13b282,0x140280,0x12a0000,0x12a0400,0x12a0800,0x12a0c00,0xffff01b2,0xffffffff
.long 0x13b302,0x140300,0x12a1000,0x12e6000,0x12e6400,0x12e6800,0x1b601b2,0xffffffff
.long 0x13b382,0x140380,0x12e6c00,0x12e7000,0x132c000,0x132c400,0x1ba01b6,0xffffffff
.long 0x13b402,0x140400,0x132c800,0x132cc00,0x132d000,0x1372000,0x1be01ba,0xffffffff
.long 0x13b482,0x140480,0x1372400,0x1372800,0x1372c00,0x1373000,0xffff01be,0xffffffff
.long 0x145002,0x14a000,0x1189400,0x1189800,0x1189c00,0x118a000,0xffff01a2,0xffffffff
.long 0x145082,0x14a080,0x118a400,0x11cf400,0x11cf800,0x11cfc00,0x1a601a2,0xffffffff
.long 0x145102,0x14a100,0x11d0000,0x11d0400,0x1215400,0x1215800,0x1aa01a6,0xffffffff
.long 0x145182,0x14a180,0x1215c00,0x1216000,0x1216400,0x125b400,0x1ae01aa,0xffffffff
.long 0x145202,0x14a200,0x125b800,0x125bc00,0x125c000,0x125c400,0xffff01ae,0xffffffff
.long 0x145282,0x14a280,0x12a1400,0x12a1800,0x12a1c00,0x12a2000,0xffff01b2,0xffffffff
.long 0x145302,0x14a300,0x12a2400,0x12e7400,0x12e7800,0x12e7c00,0x1b601b2,0xffffffff
.long 0x145382,0x14a380,0x12e8000,0x12e8400,0x132d400,0x132d800,0x1ba01b6,0xffffffff
.long 0x145402,0x14a400,0x132dc00,0x132e000,0x132e400,0x1373400,0x1be01ba,0xffffffff
.long 0x145482,0x14a480,0x1373800,0x1373c00,0x1374000,0x1374400,0xffff01be,0xffffffff
.long 0x154002,0x159000,0x118a800,0x118ac00,0x118b000,0x118b400,0xffff01a2,0xffffffff
.long 0x154082,0x159080,0x118b800,0x11d0800,0x11d0c00,0x11d1000,0x1a601a2,0xffffffff
.long 0x154102,0x159100,0x11d1400,0x11d1800,0x1216800,0x1216c00,0x1aa01a6,0xffffffff
.long 0x154182,0x159180,0x1217000,0x1217400,0x1217800,0x125c800,0x1ae01aa,0xffffffff
.long 0x154202,0x159200,0x125cc00,0x125d000,0x125d400,0x125d800,0xffff01ae,0xffffffff
.long 0x154282,0x159280,0x12a2800,0x12a2c00,0x12a3000,0x12a3400,0xffff01b2,0xffffffff
.long 0x154302,0x159300,0x12a3800,0x12e8800,0x12e8c00,0x12e9000,0x1b601b2,0xffffffff
.long 0x154382,0x159380,0x12e9400,0x12e9800,0x132e800,0x132ec00,0x1ba01b6,0xffffffff
.long 0x154402,0x159400,0x132f000,0x132f400,0x132f800,0x1374800,0x1be01ba,0xffffffff
.long 0x154482,0x159480,0x1374c00,0x1375000,0x1375400,0x1375800,0xffff01be,0xffffffff
.long 0x15e002,0x163000,0x118bc00,0x118c000,0x118c400,0x118c800,0xffff01a2,0xffffffff
.long 0x15e082,0x163080,0x118cc00,0x11d1c00,0x11d2000,0x11d2400,0x1a601a2,0xffffffff
.long 0x15e102,0x163100,0x11d2800,0x11d2c00,0x1217c00,0x1218000,0x1aa01a6,0xffffffff
.long 0x15e182,0x163180,0x1218400,0x1218800,0x1218c00,0x125dc00,0x1ae01aa,0xffffffff
.long 0x15e202,0x163200,0x125e000,0x125e400,0x125e800,0x125ec00,0xffff01ae,0xffffffff
.long 0x15e282,0x163280,0x12a3c00,0x12a4000,0x12a4400,0x12a4800,0xffff01b2,0xffffffff
.long 0x15e302,0x163300,0x12a4c00,0x12e9c00,0x12ea000,0x12ea400,0x1b601b2,0xffffffff
.long 0x15e382,0x163380,0x12ea800,0x12eac00,0x132fc00,0x1330000,0x1ba01b6,0xffffffff
.long 0x15e402,0x163400,0x1330400,0x1330800,0x1330c00,0x1375c00,0x1be01ba,0xffffffff
.long 0x15e482,0x163480,0x1376000,0x1376400,0x1376800,0x1376c00,0xffff01be,0xffffffff
.long 0x168002,0x16d000,0x118d000,0x118d400,0x118d800,0x118dc00,0xffff01a2,0xffffffff
.long 0x168082,0x16d080,0x118e000,0x11d3000,0x11d3400,0x11d3800,0x1a601a2,0xffffffff
.long 0x168102,0x16d100,0x11d3c00,0x11d4000,0x1219000,0x1219400,0x1aa01a6,0xffffffff
.long 0x168182,0x16d180,0x1219800,0x1219c00,0x121a000,0x125f000,0x1ae01aa,0xffffffff
.long 0x168202,0x16d200,0x125f400,0x125f800,0x125fc00,0x1260000,0xffff01ae,0xffffffff
.long 0x168282,0x16d280,0x12a5000,0x12a5400,0x12a5800,0x12a5c00,0xffff01b2,0xffffffff
.long 0x168302,0x16d300,0x12a6000,0x12eb000,0x12eb400,0x12eb800,0x1b601b2,0xffffffff
.long 0x168382,0x16d380,0x12ebc00,0x12ec000,0x1331000,0x1331400,0x1ba01b6,0xffffffff
.long 0x168402,0x16d400,0x1331800,0x1331c00,0x1332000,0x1377000,0x1be01ba,0xffffffff
.long 0x168482,0x16d480,0x1377400,0x1377800,0x1377c00,0x1378000,0xffff01be,0xffffffff
.long 0x177002,0x17c000,0x118e400,0x118e800,0x118ec00,0x118f000,0xffff01a2,0xffffffff
.long 0x177082,0x17c080,0x118f400,0x11d4400,0x11d4800,0x11d4c00,0x1a601a2,0xffffffff
.long 0x177102,0x17c100,0x11d5000,0x11d5400,0x121a400,0x121a800,0x1aa01a6,0xffffffff
.long 0x177182,0x17c180,0x121ac00,0x121b000,0x121b400,0x1260400,0x1ae01aa,0xffffffff
.long 0x177202,0x17c200,0x1260800,0x1260c00,0x1261000,0x1261400,0xffff01ae,0xffffffff
.long 0x177282,0x17c280,0x12a6400,0x12a6800,0x12a6c00,0x12a7000,0xffff01b2,0xffffffff
.long 0x177302,0x17c300,0x12a7400,0x12ec400,0x12ec800,0x12ecc00,0x1b601b2,0xffffffff
.long 0x177382,0x17c380,0x12ed000,0x12ed400,0x1332400,0x1332800,0x1ba01b6,0xffffffff
.long 0x177402,0x17c400,0x1332c00,0x1333000,0x1333400,0x1378400,0x1be01ba,0xffffffff
.long 0x177482,0x17c480,0x1378800,0x1378c00,0x1379000,0x1379400,0xffff01be,0xffffffff
.long 0x181002,0x186000,0x118f800,0x118fc00,0x1190000,0x1190400,0xffff01a2,0xffffffff
.long 0x181082,0x186080,0x1190800,0x11d5800,0x11d5c00,0x11d6000,0x1a601a2,0xffffffff
.long 0x181102,0x186100,0x11d6400,0x11d6800,0x121b800,0x121bc00,0x1aa01a6,0xffffffff
.long 0x181182,0x186180,0x121c000,0x121c400,0x121c800,0x1261800,0x1ae01aa,0xffffffff
.long 0x181202,0x186200,0x1261c00,0x1262000,0x1262400,0x1262800,0xffff01ae,0xffffffff
.long 0x181282,0x186280,0x12a7800,0x12a7c00,0x12a8000,0x12a8400,0xffff01b2,0xffffffff
.long 0x181302,0x186300,0x12a8800,0x12ed800,0x12edc00,0x12ee000,0x1b601b2,0xffffffff
.long 0x181382,0x186380,0x12ee400,0x12ee800,0x1333800,0x1333c00,0x1ba01b6,0xffffffff
.long 0x181402,0x186400,0x1334000,0x1334400,0x1334800,0x1379800,0x1be01ba,0xffffffff
.long 0x181482,0x186480,0x1379c00,0x137a000,0x137a400,0x137a800,0xffff01be,0xffffffff
.long 0x18b002,0x190000,0x1190c00,0x1191000,0x1191400,0x1191800,0xffff01a2,0xffffffff
.long 0x18b082,0x190080,0x1191c00,0x11d6c00,0x11d7000,0x11d7400,0x1a601a2,0xffffffff
.long 0x18b102,0x190100,0x11d7800,0x11d7c00,0x121cc00,0x121d000,0x1aa01a6,0xffffffff
.long 0x18b182,0x190180,0x121d400,0x121d800,0x121dc00,0x1262c00,0x1ae01aa,0xffffffff
.long 0x18b202,0x190200,0x1263000,0x1263400,0x1263800,0x1263c00,0xffff01ae,0xffffffff
.long 0x18b282,0x190280,0x12a8c00,0x12a9000,0x12a9400,0x12a9800,0xffff01b2,0xffffffff
.long 0x18b302,0x190300,0x12a9c00,0x12eec00,0x12ef000,0x12ef400,0x1b601b2,0xffffffff
.long 0x18b382,0x190380,0x12ef800,0x12efc00,0x1334c00,0x1335000,0x1ba01b6,0xffffffff
.long 0x18b402,0x190400,0x1335400,0x1335800,0x1335c00,0x137ac00,0x1be01ba,0xffffffff
.long 0x18b482,0x190480,0x137b000,0x137b400,0x137b800,0x137bc00,0xffff01be,0xffffffff
.long 0x12c002,0x14f000,0x1192000,0x1192400,0x1192800,0x1192c00,0xffff01a2,0xffffffff
.long 0x12c082,0x14f080,0x1193000,0x11d8000,0x11d8400,0x11d8800,0x1a601a2,0xffffffff
.long 0x12c102,0x14f100,0x11d8c00,0x11d9000,0x121e000,0x121e400,0x1aa01a6,0xffffffff
.long 0x12c182,0x14f180,0x121e800,0x121ec00,0x121f000,0x1264000,0x1ae01aa,0xffffffff
.long 0x12c202,0x14f200,0x1264400,0x1264800,0x1264c00,0x1265000,0xffff01ae,0xffffffff
.long 0x12c282,0x14f280,0x12aa000,0x12aa400,0x12aa800,0x12aac00,0xffff01b2,0xffffffff
.long 0x12c302,0x14f300,0x12ab000,0x12f0000,0x12f0400,0x12f0800,0x1b601b2,0xffffffff
.long 0x12c382,0x14f380,0x12f0c00,0x12f1000,0x1336000,0x1336400,0x1ba01b6,0xffffffff
.long 0x12c402,0x14f400,0x1336800,0x1336c00,0x1337000,0x137c000,0x1be01ba,0xffffffff
.long 0x12c482,0x14f480,0x137c400,0x137c800,0x137cc00,0x137d000,0xffff01be,0xffffffff
.long 0x195002,0x19a000,0x1194800,0x1194c00,0x1195000,0x1195400,0xffff01a3,0xffffffff
.long 0x195082,0x19a080,0x1195800,0x11da800,0x11dac00,0x11db000,0x1a701a3,0xffffffff
.long 0x195102,0x19a100,0x11db400,0x11db800,0x1220800,0x1220c00,0x1ab01a7,0xffffffff
.long 0x195182,0x19a180,0x1221000,0x1221400,0x1221800,0x1266800,0x1af01ab,0xffffffff
.long 0x195202,0x19a200,0x1266c00,0x1267000,0x1267400,0x1267800,0xffff01af,0xffffffff
.long 0x195282,0x19a280,0x12ac800,0x12acc00,0x12ad000,0x12ad400,0xffff01b3,0xffffffff
.long 0x195302,0x19a300,0x12ad800,0x12f2800,0x12f2c00,0x12f3000,0x1b701b3,0xffffffff
.long 0x195382,0x19a380,0x12f3400,0x12f3800,0x1338800,0x1338c00,0x1bb01b7,0xffffffff
.long 0x195402,0x19a400,0x1339000,0x1339400,0x1339800,0x137e800,0x1bf01bb,0xffffffff
.long 0x195482,0x19a480,0x137ec00,0x137f000,0x137f400,0x137f800,0xffff01bf,0xffffffff
.long 0x19f002,0x1a4000,0x1195c00,0x1196000,0x1196400,0x1196800,0xffff01a3,0xffffffff
.long 0x19f082,0x1a4080,0x1196c00,0x11dbc00,0x11dc000,0x11dc400,0x1a701a3,0xffffffff
.long 0x19f102,0x1a4100,0x11dc800,0x11dcc00,0x1221c00,0x1222000,0x1ab01a7,0xffffffff
.long 0x19f182,0x1a4180,0x1222400,0x1222800,0x1222c00,0x1267c00,0x1af01ab,0xffffffff
.long 0x19f202,0x1a4200,0x1268000,0x1268400,0x1268800,0x1268c00,0xffff01af,0xffffffff
.long 0x19f282,0x1a4280,0x12adc00,0x12ae000,0x12ae400,0x12ae800,0xffff01b3,0xffffffff
.long 0x19f302,0x1a4300,0x12aec00,0x12f3c00,0x12f4000,0x12f4400,0x1b701b3,0xffffffff
.long 0x19f382,0x1a4380,0x12f4800,0x12f4c00,0x1339c00,0x133a000,0x1bb01b7,0xffffffff
.long 0x19f402,0x1a4400,0x133a400,0x133a800,0x133ac00,0x137fc00,0x1bf01bb,0xffffffff
.long 0x19f482,0x1a4480,0x1380000,0x1380400,0x1380800,0x1380c00,0xffff01bf,0xffffffff
.long 0x1a9002,0x1ae000,0x1197000,0x1197400,0x1197800,0x1197c00,0xffff01a3,0xffffffff
.long 0x1a9082,0x1ae080,0x1198000,0x11dd000,0x11dd400,0x11dd800,0x1a701a3,0xffffffff
.long 0x1a9102,0x1ae100,0x11ddc00,0x11de000,0x1223000,0x1223400,0x1ab01a7,0xffffffff
.long 0x1a9182,0x1ae180,0x1223800,0x1223c00,0x1224000,0x1269000,0x1af01ab,0xffffffff
.long 0x1a9202,0x1ae200,0x1269400,0x1269800,0x1269c00,0x126a000,0xffff01af,0xffffffff
.long 0x1a9282,0x1ae280,0x12af000,0x12af400,0x12af800,0x12afc00,0xffff01b3,0xffffffff
.long 0x1a9302,0x1ae300,0x12b0000,0x12f5000,0x12f5400,0x12f5800,0x1b701b3,0xffffffff
.long 0x1a9382,0x1ae380,0x12f5c00,0x12f6000,0x133b000,0x133b400,0x1bb01b7,0xffffffff
.long 0x1a9402,0x1ae400,0x133b800,0x133bc00,0x133c000,0x1381000,0x1bf01bb,0xffffffff
.long 0x1a9482,0x1ae480,0x1381400,0x1381800,0x1381c00,0x1382000,0xffff01bf,0xffffffff
.long 0x1b8002,0x1bd000,0x1198400,0x1198800,0x1198c00,0x1199000,0xffff01a3,0xffffffff
.long 0x1b8082,0x1bd080,0x1199400,0x11de400,0x11de800,0x11dec00,0x1a701a3,0xffffffff
.long 0x1b8102,0x1bd100,0x11df000,0x11df400,0x1224400,0x1224800,0x1ab01a7,0xffffffff
.long 0x1b8182,0x1bd180,0x1224c00,0x1225000,0x1225400,0x126a400,0x1af01ab,0xffffffff
.long 0x1b8202,0x1bd200,0x126a800,0x126ac00,0x126b000,0x126b400,0xffff01af,0xffffffff
.long 0x1b8282,0x1bd280,0x12b0400,0x12b0800,0x12b0c00,0x12b1000,0xffff01b3,0xffffffff
.long 0x1b8302,0x1bd300,0x12b1400,0x12f6400,0x12f6800,0x12f6c00,0x1b701b3,0xffffffff
.long 0x1b8382,0x1bd380,0x12f7000,0x12f7400,0x133c400,0x133c800,0x1bb01b7,0xffffffff
.long 0x1b8402,0x1bd400,0x133cc00,0x133d000,0x133d400,0x1382400,0x1bf01bb,0xffffffff
.long 0x1b8482,0x1bd480,0x1382800,0x1382c00,0x1383000,0x1383400,0xffff01bf,0xffffffff
.long 0x1c2002,0x1c7000,0x1199800,0x1199c00,0x119a000,0x119a400,0xffff01a3,0xffffffff
.long 0x1c2082,0x1c7080,0x119a800,0x11df800,0x11dfc00,0x11e0000,0x1a701a3,0xffffffff
.long 0x1c2102,0x1c7100,0x11e0400,0x11e0800,0x1225800,0x1225c00,0x1ab01a7,0xffffffff
.long 0x1c2182,0x1c7180,0x1226000,0x1226400,0x1226800,0x126b800,0x1af01ab,0xffffffff
.long 0x1c2202,0x1c7200,0x126bc00,0x126c000,0x126c400,0x126c800,0xffff01af,0xffffffff
.long 0x1c2282,0x1c7280,0x12b1800,0x12b1c00,0x12b2000,0x12b2400,0xffff01b3,0xffffffff
.long 0x1c2302,0x1c7300,0x12b2800,0x12f7800,0x12f7c00,0x12f8000,0x1b701b3,0xffffffff
.long 0x1c2382,0x1c7380,0x12f8400,0x12f8800,0x133d800,0x133dc00,0x1bb01b7,0xffffffff
.long 0x1c2402,0x1c7400,0x133e000,0x133e400,0x133e800,0x1383800,0x1bf01bb,0xffffffff
.long 0x1c2482,0x1c7480,0x1383c00,0x1384000,0x1384400,0x1384800,0xffff01bf,0xffffffff
.long 0x1cc002,0x1d1000,0x119ac00,0x119b000,0x119b400,0x119b800,0xffff01a3,0xffffffff
.long 0x1cc082,0x1d1080,0x119bc00,0x11e0c00,0x11e1000,0x11e1400,0x1a701a3,0xffffffff
.long 0x1cc102,0x1d1100,0x11e1800,0x11e1c00,0x1226c00,0x1227000,0x1ab01a7,0xffffffff
.long 0x1cc182,0x1d1180,0x1227400,0x1227800,0x1227c00,0x126cc00,0x1af01ab,0xffffffff
.long 0x1cc202,0x1d1200,0x126d000,0x126d400,0x126d800,0x126dc00,0xffff01af,0xffffffff
.long 0x1cc282,0x1d1280,0x12b2c00,0x12b3000,0x12b3400,0x12b3800,0xffff01b3,0xffffffff
.long 0x1cc302,0x1d1300,0x12b3c00,0x12f8c00,0x12f9000,0x12f9400,0x1b701b3,0xffffffff
.long 0x1cc382,0x1d1380,0x12f9800,0x12f9c00,0x133ec00,0x133f000,0x1bb01b7,0xffffffff
.long 0x1cc402,0x1d1400,0x133f400,0x133f800,0x133fc00,0x1384c00,0x1bf01bb,0xffffffff
.long 0x1cc482,0x1d1480,0x1385000,0x1385400,0x1385800,0x1385c00,0xffff01bf,0xffffffff
.long 0x1db002,0x1e0000,0x119c000,0x119c400,0x119c800,0x119cc00,0xffff01a3,0xffffffff
.long 0x1db082,0x1e0080,0x119d000,0x11e2000,0x11e2400,0x11e2800,0x1a701a3,0xffffffff
.long 0x1db102,0x1e0100,0x11e2c00,0x11e3000,0x1228000,0x1228400,0x1ab01a7,0xffffffff
.long 0x1db182,0x1e0180,0x1228800,0x1228c00,0x1229000,0x126e000,0x1af01ab,0xffffffff
.long 0x1db202,0x1e0200,0x126e400,0x126e800,0x126ec00,0x126f000,0xffff01af,0xffffffff
.long 0x1db282,0x1e0280,0x12b4000,0x12b4400,0x12b4800,0x12b4c00,0xffff01b3,0xffffffff
.long 0x1db302,0x1e0300,0x12b5000,0x12fa000,0x12fa400,0x12fa800,0x1b701b3,0xffffffff
.long 0x1db382,0x1e0380,0x12fac00,0x12fb000,0x1340000,0x1340400,0x1bb01b7,0xffffffff
.long 0x1db402,0x1e0400,0x1340800,0x1340c00,0x1341000,0x1386000,0x1bf01bb,0xffffffff
.long 0x1db482,0x1e0480,0x1386400,0x1386800,0x1386c00,0x1387000,0xffff01bf,0xffffffff
.long 0x1e5002,0x1ea000,0x119d400,0x119d800,0x119dc00,0x119e000,0xffff01a3,0xffffffff
.long 0x1e5082,0x1ea080,0x119e400,0x11e3400,0x11e3800,0x11e3c00,0x1a701a3,0xffffffff
.long 0x1e5102,0x1ea100,0x11e4000,0x11e4400,0x1229400,0x1229800,0x1ab01a7,0xffffffff
.long 0x1e5182,0x1ea180,0x1229c00,0x122a000,0x122a400,0x126f400,0x1af01ab,0xffffffff
.long 0x1e5202,0x1ea200,0x126f800,0x126fc00,0x1270000,0x1270400,0xffff01af,0xffffffff
.long 0x1e5282,0x1ea280,0x12b5400,0x12b5800,0x12b5c00,0x12b6000,0xffff01b3,0xffffffff
.long 0x1e5302,0x1ea300,0x12b6400,0x12fb400,0x12fb800,0x12fbc00,0x1b701b3,0xffffffff
.long 0x1e5382,0x1ea380,0x12fc000,0x12fc400,0x1341400,0x1341800,0x1bb01b7,0xffffffff
.long 0x1e5402,0x1ea400,0x1341c00,0x1342000,0x1342400,0x1387400,0x1bf01bb,0xffffffff
.long 0x1e5482,0x1ea480,0x1387800,0x1387c00,0x1388000,0x1388400,0xffff01bf,0xffffffff
.long 0x1ef002,0x1f4000,0x119e800,0x119ec00,0x119f000,0x119f400,0xffff01a3,0xffffffff
.long 0x1ef082,0x1f4080,0x119f800,0x11e4800,0x11e4c00,0x11e5000,0x1a701a3,0xffffffff
.long 0x1ef102,0x1f4100,0x11e5400,0x11e5800,0x122a800,0x122ac00,0x1ab01a7,0xffffffff
.long 0x1ef182,0x1f4180,0x122b000,0x122b400,0x122b800,0x1270800,0x1af01ab,0xffffffff
.long 0x1ef202,0x1f4200,0x1270c00,0x1271000,0x1271400,0x1271800,0xffff01af,0xffffffff
.long 0x1ef282,0x1f4280,0x12b6800,0x12b6c00,0x12b7000,0x12b7400,0xffff01b3,0xffffffff
.long 0x1ef302,0x1f4300,0x12b7800,0x12fc800,0x12fcc00,0x12fd000,0x1b701b3,0xffffffff
.long 0x1ef382,0x1f4380,0x12fd400,0x12fd800,0x1342800,0x1342c00,0x1bb01b7,0xffffffff
.long 0x1ef402,0x1f4400,0x1343000,0x1343400,0x1343800,0x1388800,0x1bf01bb,0xffffffff
.long 0x1ef482,0x1f4480,0x1388c00,0x1389000,0x1389400,0x1389800,0xffff01bf,0xffffffff
.long 0x1fe002,0x203000,0x119fc00,0x11a0000,0x11a0400,0x11a0800,0xffff01a3,0xffffffff
.long 0x1fe082,0x203080,0x11a0c00,0x11e5c00,0x11e6000,0x11e6400,0x1a701a3,0xffffffff
.long 0x1fe102,0x203100,0x11e6800,0x11e6c00,0x122bc00,0x122c000,0x1ab01a7,0xffffffff
.long 0x1fe182,0x203180,0x122c400,0x122c800,0x122cc00,0x1271c00,0x1af01ab,0xffffffff
.long 0x0,0x5000,0x13b0000,0x13b0400,0x13b0800,0x13b0c00,0xffff01e0,0xffffffff
.long 0x80,0x5080,0x13b1000,0x13c9000,0x13c9400,0x13c9800,0x1e101e0,0xffffffff
.long 0x100,0x5100,0x13c9c00,0x13ca000,0x13e2000,0x13e2400,0x1e201e1,0xffffffff
.long 0x180,0x5180,0x13e2800,0x13e2c00,0x13e3000,0x13fb000,0x1e301e2,0xffffffff
.long 0x200,0x5200,0x13fb400,0x13fb800,0x13fbc00,0x13fc000,0xffff01e3,0xffffffff
.long 0x280,0x5280,0x1414000,0x1414400,0x1414800,0x1414c00,0xffff01e4,0xffffffff
.long 0x300,0x5300,0x1415000,0x142d000,0x142d400,0x142d800,0x1e501e4,0xffffffff
.long 0x380,0x5380,0x142dc00,0x142e000,0x1446000,0x1446400,0x1e601e5,0xffffffff
.long 0x400,0x5400,0x1446800,0x1446c00,0x1447000,0x145f000,0x1e701e6,0xffffffff
.long 0x480,0x5480,0x145f400,0x145f800,0x145fc00,0x1460000,0xffff01e7,0xffffffff
.long 0xa000,0xf000,0x13b1400,0x13b1800,0x13b1c00,0x13b2000,0xffff01e0,0xffffffff
.long 0xa080,0xf080,0x13b2400,0x13ca400,0x13ca800,0x13cac00,0x1e101e0,0xffffffff
.long 0xa100,0xf100,0x13cb000,0x13cb400,0x13e3400,0x13e3800,0x1e201e1,0xffffffff
.long 0xa180,0xf180,0x13e3c00,0x13e4000,0x13e4400,0x13fc400,0x1e301e2,0xffffffff
.long 0xa200,0xf200,0x13fc800,0x13fcc00,0x13fd000,0x13fd400,0xffff01e3,0xffffffff
.long 0xa280,0xf280,0x1415400,0x1415800,0x1415c00,0x1416000,0xffff01e4,0xffffffff
.long 0xa300,0xf300,0x1416400,0x142e400,0x142e800,0x142ec00,0x1e501e4,0xffffffff
.long 0xa380,0xf380,0x142f000,0x142f400,0x1447400,0x1447800,0x1e601e5,0xffffffff
.long 0xa400,0xf400,0x1447c00,0x1448000,0x1448400,0x1460400,0x1e701e6,0xffffffff
.long 0xa480,0xf480,0x1460800,0x1460c00,0x1461000,0x1461400,0xffff01e7,0xffffffff
.long 0x19000,0x1e000,0x13b2800,0x13b2c00,0x13b3000,0x13b3400,0xffff01e0,0xffffffff
.long 0x19080,0x1e080,0x13b3800,0x13cb800,0x13cbc00,0x13cc000,0x1e101e0,0xffffffff
.long 0x19100,0x1e100,0x13cc400,0x13cc800,0x13e4800,0x13e4c00,0x1e201e1,0xffffffff
.long 0x19180,0x1e180,0x13e5000,0x13e5400,0x13e5800,0x13fd800,0x1e301e2,0xffffffff
.long 0x19200,0x1e200,0x13fdc00,0x13fe000,0x13fe400,0x13fe800,0xffff01e3,0xffffffff
.long 0x19280,0x1e280,0x1416800,0x1416c00,0x1417000,0x1417400,0xffff01e4,0xffffffff
.long 0x19300,0x1e300,0x1417800,0x142f800,0x142fc00,0x1430000,0x1e501e4,0xffffffff
.long 0x19380,0x1e380,0x1430400,0x1430800,0x1448800,0x1448c00,0x1e601e5,0xffffffff
.long 0x19400,0x1e400,0x1449000,0x1449400,0x1449800,0x1461800,0x1e701e6,0xffffffff
.long 0x19480,0x1e480,0x1461c00,0x1462000,0x1462400,0x1462800,0xffff01e7,0xffffffff
.long 0x23000,0x28000,0x13b3c00,0x13b4000,0x13b4400,0x13b4800,0xffff01e0,0xffffffff
.long 0x23080,0x28080,0x13b4c00,0x13ccc00,0x13cd000,0x13cd400,0x1e101e0,0xffffffff
.long 0x23100,0x28100,0x13cd800,0x13cdc00,0x13e5c00,0x13e6000,0x1e201e1,0xffffffff
.long 0x23180,0x28180,0x13e6400,0x13e6800,0x13e6c00,0x13fec00,0x1e301e2,0xffffffff
.long 0x23200,0x28200,0x13ff000,0x13ff400,0x13ff800,0x13ffc00,0xffff01e3,0xffffffff
.long 0x23280,0x28280,0x1417c00,0x1418000,0x1418400,0x1418800,0xffff01e4,0xffffffff
.long 0x23300,0x28300,0x1418c00,0x1430c00,0x1431000,0x1431400,0x1e501e4,0xffffffff
.long 0x23380,0x28380,0x1431800,0x1431c00,0x1449c00,0x144a000,0x1e601e5,0xffffffff
.long 0x23400,0x28400,0x144a400,0x144a800,0x144ac00,0x1462c00,0x1e701e6,0xffffffff
.long 0x23480,0x28480,0x1463000,0x1463400,0x1463800,0x1463c00,0xffff01e7,0xffffffff
.long 0x14000,0x2d000,0x13b5000,0x13b5400,0x13b5800,0x13b5c00,0xffff01e0,0xffffffff
.long 0x14080,0x2d080,0x13b6000,0x13ce000,0x13ce400,0x13ce800,0x1e101e0,0xffffffff
.long 0x14100,0x2d100,0x13cec00,0x13cf000,0x13e7000,0x13e7400,0x1e201e1,0xffffffff
.long 0x14180,0x2d180,0x13e7800,0x13e7c00,0x13e8000,0x1400000,0x1e301e2,0xffffffff
.long 0x14200,0x2d200,0x1400400,0x1400800,0x1400c00,0x1401000,0xffff01e3,0xffffffff
.long 0x14280,0x2d280,0x1419000,0x1419400,0x1419800,0x1419c00,0xffff01e4,0xffffffff
.long 0x14300,0x2d300,0x141a000,0x1432000,0x1432400,0x1432800,0x1e501e4,0xffffffff
.long 0x14380,0x2d380,0x1432c00,0x1433000,0x144b000,0x144b400,0x1e601e5,0xffffffff
.long 0x14400,0x2d400,0x144b800,0x144bc00,0x144c000,0x1464000,0x1e701e6,0xffffffff
.long 0x14480,0x2d480,0x1464400,0x1464800,0x1464c00,0x1465000,0xffff01e7,0xffffffff
.long 0x32000,0x37000,0x13b6400,0x13b6800,0x13b6c00,0x13b7000,0xffff01e0,0xffffffff
.long 0x32080,0x37080,0x13b7400,0x13cf400,0x13cf800,0x13cfc00,0x1e101e0,0xffffffff
.long 0x32100,0x37100,0x13d0000,0x13d0400,0x13e8400,0x13e8800,0x1e201e1,0xffffffff
.long 0x32180,0x37180,0x13e8c00,0x13e9000,0x13e9400,0x1401400,0x1e301e2,0xffffffff
.long 0x32200,0x37200,0x1401800,0x1401c00,0x1402000,0x1402400,0xffff01e3,0xffffffff
.long 0x32280,0x37280,0x141a400,0x141a800,0x141ac00,0x141b000,0xffff01e4,0xffffffff
.long 0x32300,0x37300,0x141b400,0x1433400,0x1433800,0x1433c00,0x1e501e4,0xffffffff
.long 0x32380,0x37380,0x1434000,0x1434400,0x144c400,0x144c800,0x1e601e5,0xffffffff
.long 0x32400,0x37400,0x144cc00,0x144d000,0x144d400,0x1465400,0x1e701e6,0xffffffff
.long 0x32480,0x37480,0x1465800,0x1465c00,0x1466000,0x1466400,0xffff01e7,0xffffffff
.long 0x3c000,0x41000,0x13b7800,0x13b7c00,0x13b8000,0x13b8400,0xffff01e0,0xffffffff
.long 0x3c080,0x41080,0x13b8800,0x13d0800,0x13d0c00,0x13d1000,0x1e101e0,0xffffffff
.long 0x3c100,0x41100,0x13d1400,0x13d1800,0x13e9800,0x13e9c00,0x1e201e1,0xffffffff
.long 0x3c180,0x41180,0x13ea000,0x13ea400,0x13ea800,0x1402800,0x1e301e2,0xffffffff
.long 0x3c200,0x41200,0x1402c00,0x1403000,0x1403400,0x1403800,0xffff01e3,0xffffffff
.long 0x3c280,0x41280,0x141b800,0x141bc00,0x141c000,0x141c400,0xffff01e4,0xffffffff
.long 0x3c300,0x41300,0x141c800,0x1434800,0x1434c00,0x1435000,0x1e501e4,0xffffffff
.long 0x3c380,0x41380,0x1435400,0x1435800,0x144d800,0x144dc00,0x1e601e5,0xffffffff
.long 0x3c400,0x41400,0x144e000,0x144e400,0x144e800,0x1466800,0x1e701e6,0xffffffff
.long 0x3c480,0x41480,0x1466c00,0x1467000,0x1467400,0x1467800,0xffff01e7,0xffffffff
.long 0x4b000,0x50000,0x13b8c00,0x13b9000,0x13b9400,0x13b9800,0xffff01e0,0xffffffff
.long 0x4b080,0x50080,0x13b9c00,0x13d1c00,0x13d2000,0x13d2400,0x1e101e0,0xffffffff
.long 0x4b100,0x50100,0x13d2800,0x13d2c00,0x13eac00,0x13eb000,0x1e201e1,0xffffffff
.long 0x4b180,0x50180,0x13eb400,0x13eb800,0x13ebc00,0x1403c00,0x1e301e2,0xffffffff
.long 0x4b200,0x50200,0x1404000,0x1404400,0x1404800,0x1404c00,0xffff01e3,0xffffffff
.long 0x4b280,0x50280,0x141cc00,0x141d000,0x141d400,0x141d800,0xffff01e4,0xffffffff
.long 0x4b300,0x50300,0x141dc00,0x1435c00,0x1436000,0x1436400,0x1e501e4,0xffffffff
.long 0x4b380,0x50380,0x1436800,0x1436c00,0x144ec00,0x144f000,0x1e601e5,0xffffffff
.long 0x4b400,0x50400,0x144f400,0x144f800,0x144fc00,0x1467c00,0x1e701e6,0xffffffff
.long 0x4b480,0x50480,0x1468000,0x1468400,0x1468800,0x1468c00,0xffff01e7,0xffffffff
.long 0x55000,0x5a000,0x13ba000,0x13ba400,0x13ba800,0x13bac00,0xffff01e0,0xffffffff
.long 0x55080,0x5a080,0x13bb000,0x13d3000,0x13d3400,0x13d3800,0x1e101e0,0xffffffff
.long 0x55100,0x5a100,0x13d3c00,0x13d4000,0x13ec000,0x13ec400,0x1e201e1,0xffffffff
.long 0x55180,0x5a180,0x13ec800,0x13ecc00,0x13ed000,0x1405000,0x1e301e2,0xffffffff
.long 0x55200,0x5a200,0x1405400,0x1405800,0x1405c00,0x1406000,0xffff01e3,0xffffffff
.long 0x55280,0x5a280,0x141e000,0x141e400,0x141e800,0x141ec00,0xffff01e4,0xffffffff
.long 0x55300,0x5a300,0x141f000,0x1437000,0x1437400,0x1437800,0x1e501e4,0xffffffff
.long 0x55380,0x5a380,0x1437c00,0x1438000,0x1450000,0x1450400,0x1e601e5,0xffffffff
.long 0x55400,0x5a400,0x1450800,0x1450c00,0x1451000,0x1469000,0x1e701e6,0xffffffff
.long 0x55480,0x5a480,0x1469400,0x1469800,0x1469c00,0x146a000,0xffff01e7,0xffffffff
.long 0x46000,0x5f000,0x13bb400,0x13bb800,0x13bbc00,0x13bc000,0xffff01e0,0xffffffff
.long 0x46080,0x5f080,0x13bc400,0x13d4400,0x13d4800,0x13d4c00,0x1e101e0,0xffffffff
.long 0x46100,0x5f100,0x13d5000,0x13d5400,0x13ed400,0x13ed800,0x1e201e1,0xffffffff
.long 0x46180,0x5f180,0x13edc00,0x13ee000,0x13ee400,0x1406400,0x1e301e2,0xffffffff
.long 0x46200,0x5f200,0x1406800,0x1406c00,0x1407000,0x1407400,0xffff01e3,0xffffffff
.long 0x46280,0x5f280,0x141f400,0x141f800,0x141fc00,0x1420000,0xffff01e4,0xffffffff
.long 0x46300,0x5f300,0x1420400,0x1438400,0x1438800,0x1438c00,0x1e501e4,0xffffffff
.long 0x46380,0x5f380,0x1439000,0x1439400,0x1451400,0x1451800,0x1e601e5,0xffffffff
.long 0x46400,0x5f400,0x1451c00,0x1452000,0x1452400,0x146a400,0x1e701e6,0xffffffff
.long 0x46480,0x5f480,0x146a800,0x146ac00,0x146b000,0x146b400,0xffff01e7,0xffffffff
.long 0x64000,0x69000,0x13bc800,0x13bcc00,0x13bd000,0x13bd400,0xffff01e0,0xffffffff
.long 0x64080,0x69080,0x13bd800,0x13d5800,0x13d5c00,0x13d6000,0x1e101e0,0xffffffff
.long 0x64100,0x69100,0x13d6400,0x13d6800,0x13ee800,0x13eec00,0x1e201e1,0xffffffff
.long 0x64180,0x69180,0x13ef000,0x13ef400,0x13ef800,0x1407800,0x1e301e2,0xffffffff
.long 0x64200,0x69200,0x1407c00,0x1408000,0x1408400,0x1408800,0xffff01e3,0xffffffff
.long 0x64280,0x69280,0x1420800,0x1420c00,0x1421000,0x1421400,0xffff01e4,0xffffffff
.long 0x64300,0x69300,0x1421800,0x1439800,0x1439c00,0x143a000,0x1e501e4,0xffffffff
.long 0x64380,0x69380,0x143a400,0x143a800,0x1452800,0x1452c00,0x1e601e5,0xffffffff
.long 0x64400,0x69400,0x1453000,0x1453400,0x1453800,0x146b800,0x1e701e6,0xffffffff
.long 0x64480,0x69480,0x146bc00,0x146c000,0x146c400,0x146c800,0xffff01e7,0xffffffff
.long 0x6e000,0x73000,0x13bdc00,0x13be000,0x13be400,0x13be800,0xffff01e0,0xffffffff
.long 0x6e080,0x73080,0x13bec00,0x13d6c00,0x13d7000,0x13d7400,0x1e101e0,0xffffffff
.long 0x6e100,0x73100,0x13d7800,0x13d7c00,0x13efc00,0x13f0000,0x1e201e1,0xffffffff
.long 0x6e180,0x73180,0x13f0400,0x13f0800,0x13f0c00,0x1408c00,0x1e301e2,0xffffffff
.long 0x6e200,0x73200,0x1409000,0x1409400,0x1409800,0x1409c00,0xffff01e3,0xffffffff
.long 0x6e280,0x73280,0x1421c00,0x1422000,0x1422400,0x1422800,0xffff01e4,0xffffffff
.long 0x6e300,0x73300,0x1422c00,0x143ac00,0x143b000,0x143b400,0x1e501e4,0xffffffff
.long 0x6e380,0x73380,0x143b800,0x143bc00,0x1453c00,0x1454000,0x1e601e5,0xffffffff
.long 0x6e400,0x73400,0x1454400,0x1454800,0x1454c00,0x146cc00,0x1e701e6,0xffffffff
.long 0x6e480,0x73480,0x146d000,0x146d400,0x146d800,0x146dc00,0xffff01e7,0xffffffff
.long 0x7d000,0x82000,0x13bf000,0x13bf400,0x13bf800,0x13bfc00,0xffff01e0,0xffffffff
.long 0x7d080,0x82080,0x13c0000,0x13d8000,0x13d8400,0x13d8800,0x1e101e0,0xffffffff
.long 0x7d100,0x82100,0x13d8c00,0x13d9000,0x13f1000,0x13f1400,0x1e201e1,0xffffffff
.long 0x7d180,0x82180,0x13f1800,0x13f1c00,0x13f2000,0x140a000,0x1e301e2,0xffffffff
.long 0x7d200,0x82200,0x140a400,0x140a800,0x140ac00,0x140b000,0xffff01e3,0xffffffff
.long 0x7d280,0x82280,0x1423000,0x1423400,0x1423800,0x1423c00,0xffff01e4,0xffffffff
.long 0x7d300,0x82300,0x1424000,0x143c000,0x143c400,0x143c800,0x1e501e4,0xffffffff
.long 0x7d380,0x82380,0x143cc00,0x143d000,0x1455000,0x1455400,0x1e601e5,0xffffffff
.long 0x7d400,0x82400,0x1455800,0x1455c00,0x1456000,0x146e000,0x1e701e6,0xffffffff
.long 0x7d480,0x82480,0x146e400,0x146e800,0x146ec00,0x146f000,0xffff01e7,0xffffffff
.long 0x87000,0x8c000,0x13c0400,0x13c0800,0x13c0c00,0x13c1000,0xffff01e0,0xffffffff
.long 0x87080,0x8c080,0x13c1400,0x13d9400,0x13d9800,0x13d9c00,0x1e101e0,0xffffffff
.long 0x87100,0x8c100,0x13da000,0x13da400,0x13f2400,0x13f2800,0x1e201e1,0xffffffff
.long 0x87180,0x8c180,0x13f2c00,0x13f3000,0x13f3400,0x140b400,0x1e301e2,0xffffffff
.long 0x87200,0x8c200,0x140b800,0x140bc00,0x140c000,0x140c400,0xffff01e3,0xffffffff
.long 0x87280,0x8c280,0x1424400,0x1424800,0x1424c00,0x1425000,0xffff01e4,0xffffffff
.long 0x87300,0x8c300,0x1425400,0x143d400,0x143d800,0x143dc00,0x1e501e4,0xffffffff
.long 0x87380,0x8c380,0x143e000,0x143e400,0x1456400,0x1456800,0x1e601e5,0xffffffff
.long 0x87400,0x8c400,0x1456c00,0x1457000,0x1457400,0x146f400,0x1e701e6,0xffffffff
.long 0x87480,0x8c480,0x146f800,0x146fc00,0x1470000,0x1470400,0xffff01e7,0xffffffff
.long 0x78000,0x91000,0x13c1800,0x13c1c00,0x13c2000,0x13c2400,0xffff01e0,0xffffffff
.long 0x78080,0x91080,0x13c2800,0x13da800,0x13dac00,0x13db000,0x1e101e0,0xffffffff
.long 0x78100,0x91100,0x13db400,0x13db800,0x13f3800,0x13f3c00,0x1e201e1,0xffffffff
.long 0x78180,0x91180,0x13f4000,0x13f4400,0x13f4800,0x140c800,0x1e301e2,0xffffffff
.long 0x78200,0x91200,0x140cc00,0x140d000,0x140d400,0x140d800,0xffff01e3,0xffffffff
.long 0x78280,0x91280,0x1425800,0x1425c00,0x1426000,0x1426400,0xffff01e4,0xffffffff
.long 0x78300,0x91300,0x1426800,0x143e800,0x143ec00,0x143f000,0x1e501e4,0xffffffff
.long 0x78380,0x91380,0x143f400,0x143f800,0x1457800,0x1457c00,0x1e601e5,0xffffffff
.long 0x78400,0x91400,0x1458000,0x1458400,0x1458800,0x1470800,0x1e701e6,0xffffffff
.long 0x78480,0x91480,0x1470c00,0x1471000,0x1471400,0x1471800,0xffff01e7,0xffffffff
.long 0x96000,0x9b000,0x13c2c00,0x13c3000,0x13c3400,0x13c3800,0xffff01e0,0xffffffff
.long 0x96080,0x9b080,0x13c3c00,0x13dbc00,0x13dc000,0x13dc400,0x1e101e0,0xffffffff
.long 0x96100,0x9b100,0x13dc800,0x13dcc00,0x13f4c00,0x13f5000,0x1e201e1,0xffffffff
.long 0x96180,0x9b180,0x13f5400,0x13f5800,0x13f5c00,0x140dc00,0x1e301e2,0xffffffff
.long 0x96200,0x9b200,0x140e000,0x140e400,0x140e800,0x140ec00,0xffff01e3,0xffffffff
.long 0x96280,0x9b280,0x1426c00,0x1427000,0x1427400,0x1427800,0xffff01e4,0xffffffff
.long 0x96300,0x9b300,0x1427c00,0x143fc00,0x1440000,0x1440400,0x1e501e4,0xffffffff
.long 0x96380,0x9b380,0x1440800,0x1440c00,0x1458c00,0x1459000,0x1e601e5,0xffffffff
.long 0x96400,0x9b400,0x1459400,0x1459800,0x1459c00,0x1471c00,0x1e701e6,0xffffffff
.long 0x96480,0x9b480,0x1472000,0x1472400,0x1472800,0x1472c00,0xffff01e7,0xffffffff
.long 0xa0000,0xa5000,0x13c4000,0x13c4400,0x13c4800,0x13c4c00,0xffff01e0,0xffffffff
.long 0xa0080,0xa5080,0x13c5000,0x13dd000,0x13dd400,0x13dd800,0x1e101e0,0xffffffff
.long 0xa0100,0xa5100,0x13ddc00,0x13de000,0x13f6000,0x13f6400,0x1e201e1,0xffffffff
.long 0xa0180,0xa5180,0x13f6800,0x13f6c00,0x13f7000,0x140f000,0x1e301e2,0xffffffff
.long 0xa0200,0xa5200,0x140f400,0x140f800,0x140fc00,0x1410000,0xffff01e3,0xffffffff
.long 0xa0280,0xa5280,0x1428000,0x1428400,0x1428800,0x1428c00,0xffff01e4,0xffffffff
.long 0xa0300,0xa5300,0x1429000,0x1441000,0x1441400,0x1441800,0x1e501e4,0xffffffff
.long 0xa0380,0xa5380,0x1441c00,0x1442000,0x145a000,0x145a400,0x1e601e5,0xffffffff
.long 0xa0400,0xa5400,0x145a800,0x145ac00,0x145b000,0x1473000,0x1e701e6,0xffffffff
.long 0xa0480,0xa5480,0x1473400,0x1473800,0x1473c00,0x1474000,0xffff01e7,0xffffffff
.long 0xaf000,0xb4000,0x13c5400,0x13c5800,0x13c5c00,0x13c6000,0xffff01e0,0xffffffff
.long 0xaf080,0xb4080,0x13c6400,0x13de400,0x13de800,0x13dec00,0x1e101e0,0xffffffff
.long 0xaf100,0xb4100,0x13df000,0x13df400,0x13f7400,0x13f7800,0x1e201e1,0xffffffff
.long 0xaf180,0xb4180,0x13f7c00,0x13f8000,0x13f8400,0x1410400,0x1e301e2,0xffffffff
.long 0xaf200,0xb4200,0x1410800,0x1410c00,0x1411000,0x1411400,0xffff01e3,0xffffffff
.long 0xaf280,0xb4280,0x1429400,0x1429800,0x1429c00,0x142a000,0xffff01e4,0xffffffff
.long 0xaf300,0xb4300,0x142a400,0x1442400,0x1442800,0x1442c00,0x1e501e4,0xffffffff
.long 0xaf380,0xb4380,0x1443000,0x1443400,0x145b400,0x145b800,0x1e601e5,0xffffffff
.long 0xaf400,0xb4400,0x145bc00,0x145c000,0x145c400,0x1474400,0x1e701e6,0xffffffff
.long 0xaf480,0xb4480,0x1474800,0x1474c00,0x1475000,0x1475400,0xffff01e7,0xffffffff
.long 0xb9000,0xbe000,0x13c6800,0x13c6c00,0x13c7000,0x13c7400,0xffff01e0,0xffffffff
.long 0xb9080,0xbe080,0x13c7800,0x13df800,0x13dfc00,0x13e0000,0x1e101e0,0xffffffff
.long 0xb9100,0xbe100,0x13e0400,0x13e0800,0x13f8800,0x13f8c00,0x1e201e1,0xffffffff
.long 0xb9180,0xbe180,0x13f9000,0x13f9400,0x13f9800,0x1411800,0x1e301e2,0xffffffff
.long 0xb9200,0xbe200,0x1411c00,0x1412000,0x1412400,0x1412800,0xffff01e3,0xffffffff
.long 0xb9280,0xbe280,0x142a800,0x142ac00,0x142b000,0x142b400,0xffff01e4,0xffffffff
.long 0xb9300,0xbe300,0x142b800,0x1443800,0x1443c00,0x1444000,0x1e501e4,0xffffffff
.long 0xb9380,0xbe380,0x1444400,0x1444800,0x145c800,0x145cc00,0x1e601e5,0xffffffff
.long 0xb9400,0xbe400,0x145d000,0x145d400,0x145d800,0x1475800,0x1e701e6,0xffffffff
.long 0xb9480,0xbe480,0x1475c00,0x1476000,0x1476400,0x1476800,0xffff01e7,0xffffffff
.long 0xaa000,0xc3000,0x13c7c00,0x13c8000,0x13c8400,0x13c8800,0xffff01e0,0xffffffff
.long 0xaa080,0xc3080,0x13c8c00,0x13e0c00,0x13e1000,0x13e1400,0x1e101e0,0xffffffff
.long 0xaa100,0xc3100,0x13e1800,0x13e1c00,0x13f9c00,0x13fa000,0x1e201e1,0xffffffff
.long 0xaa180,0xc3180,0x13fa400,0x13fa800,0x13fac00,0x1412c00,0x1e301e2,0xffffffff
.long 0xaa200,0xc3200,0x1413000,0x1413400,0x1413800,0x1413c00,0xffff01e3,0xffffffff
.long 0xaa280,0xc3280,0x142bc00,0x142c000,0x142c400,0x142c800,0xffff01e4,0xffffffff
.long 0xaa300,0xc3300,0x142cc00,0x1444c00,0x1445000,0x1445400,0x1e501e4,0xffffffff
.long 0xaa380,0xc3380,0x1445800,0x1445c00,0x145dc00,0x145e000,0x1e601e5,0xffffffff
.long 0xaa400,0xc3400,0x145e400,0x145e800,0x145ec00,0x1476c00,0x1e701e6,0xffffffff
.long 0xaa480,0xc3480,0x1477000,0x1477400,0x1477800,0x1477c00,0xffff01e7,0xffffffff
.long 0x1fe202,0x203200,0x1272000,0x1272400,0x1272800,0x1272c00,0xffff01af,0xffffffff
.long 0x1fe282,0x203280,0x12b7c00,0x12b8000,0x12b8400,0x12b8800,0xffff01b3,0xffffffff
.long 0x1fe302,0x203300,0x12b8c00,0x12fdc00,0x12fe000,0x12fe400,0x1b701b3,0xffffffff
.long 0x1fe382,0x203380,0x12fe800,0x12fec00,0x1343c00,0x1344000,0x1bb01b7,0xffffffff
.long 0x1fe402,0x203400,0x1344400,0x1344800,0x1344c00,0x1389c00,0x1bf01bb,0xffffffff
.long 0x1fe482,0x203480,0x138a000,0x138a400,0x138a800,0x138ac00,0xffff01bf,0xffffffff
.long 0x208002,0x20d000,0x11a1000,0x11a1400,0x11a1800,0x11a1c00,0xffff01a3,0xffffffff
.long 0x208082,0x20d080,0x11a2000,0x11e7000,0x11e7400,0x11e7800,0x1a701a3,0xffffffff
.long 0x208102,0x20d100,0x11e7c00,0x11e8000,0x122d000,0x122d400,0x1ab01a7,0xffffffff
.long 0x208182,0x20d180,0x122d800,0x122dc00,0x122e000,0x1273000,0x1af01ab,0xffffffff
.long 0x208202,0x20d200,0x1273400,0x1273800,0x1273c00,0x1274000,0xffff01af,0xffffffff
.long 0x208282,0x20d280,0x12b9000,0x12b9400,0x12b9800,0x12b9c00,0xffff01b3,0xffffffff
.long 0x208302,0x20d300,0x12ba000,0x12ff000,0x12ff400,0x12ff800,0x1b701b3,0xffffffff
.long 0x208382,0x20d380,0x12ffc00,0x1300000,0x1345000,0x1345400,0x1bb01b7,0xffffffff
.long 0x208402,0x20d400,0x1345800,0x1345c00,0x1346000,0x138b000,0x1bf01bb,0xffffffff
.long 0x208482,0x20d480,0x138b400,0x138b800,0x138bc00,0x138c000,0xffff01bf,0xffffffff
.long 0x212002,0x217000,0x11a2400,0x11a2800,0x11a2c00,0x11a3000,0xffff01a3,0xffffffff
.long 0x212082,0x217080,0x11a3400,0x11e8400,0x11e8800,0x11e8c00,0x1a701a3,0xffffffff
.long 0x212102,0x217100,0x11e9000,0x11e9400,0x122e400,0x122e800,0x1ab01a7,0xffffffff
.long 0x212182,0x217180,0x122ec00,0x122f000,0x122f400,0x1274400,0x1af01ab,0xffffffff
.long 0x212202,0x217200,0x1274800,0x1274c00,0x1275000,0x1275400,0xffff01af,0xffffffff
.long 0x212282,0x217280,0x12ba400,0x12ba800,0x12bac00,0x12bb000,0xffff01b3,0xffffffff
.long 0x212302,0x217300,0x12bb400,0x1300400,0x1300800,0x1300c00,0x1b701b3,0xffffffff
.long 0x212382,0x217380,0x1301000,0x1301400,0x1346400,0x1346800,0x1bb01b7,0xffffffff
.long 0x212402,0x217400,0x1346c00,0x1347000,0x1347400,0x138c400,0x1bf01bb,0xffffffff
.long 0x212482,0x217480,0x138c800,0x138cc00,0x138d000,0x138d400,0xffff01bf,0xffffffff
.long 0x1b3002,0x1d6000,0x11a3800,0x11a3c00,0x11a4000,0x11a4400,0xffff01a3,0xffffffff
.long 0x1b3082,0x1d6080,0x11a4800,0x11e9800,0x11e9c00,0x11ea000,0x1a701a3,0xffffffff
.long 0x1b3102,0x1d6100,0x11ea400,0x11ea800,0x122f800,0x122fc00,0x1ab01a7,0xffffffff
.long 0x1b3182,0x1d6180,0x1230000,0x1230400,0x1230800,0x1275800,0x1af01ab,0xffffffff
.long 0x1b3202,0x1d6200,0x1275c00,0x1276000,0x1276400,0x1276800,0xffff01af,0xffffffff
.long 0x1b3282,0x1d6280,0x12bb800,0x12bbc00,0x12bc000,0x12bc400,0xffff01b3,0xffffffff
.long 0x1b3302,0x1d6300,0x12bc800,0x1301800,0x1301c00,0x1302000,0x1b701b3,0xffffffff
.long 0x1b3382,0x1d6380,0x1302400,0x1302800,0x1347800,0x1347c00,0x1bb01b7,0xffffffff
.long 0x1b3402,0x1d6400,0x1348000,0x1348400,0x1348800,0x138d800,0x1bf01bb,0xffffffff
.long 0x1b3482,0x1d6480,0x138dc00,0x138e000,0x138e400,0x138e800,0xffff01bf,0xffffffff
.long 0x64002,0xeb000,0x1390000,0x1390400,0x1390800,0x1390c00,0x1a101a0,0xffffffff
.long 0x64082,0xeb080,0x1391000,0x1392800,0x1392c00,0x1393000,0x1a101a0,0x1a501a4
.long 0x64102,0xeb100,0x1393400,0x1393800,0x1395000,0x1395400,0x1a501a4,0x1a901a8
.long 0x64182,0xeb180,0x1395800,0x1395c00,0x1396000,0x1397800,0x1a901a8,0x1ad01ac
.long 0x64202,0xeb200,0x1397c00,0x1398000,0x1398400,0x1398800,0x1ad01ac,0xffffffff
.long 0x64282,0xeb280,0x139a000,0x139a400,0x139a800,0x139ac00,0x1b101b0,0xffffffff
.long 0x64302,0xeb300,0x139b000,0x139c800,0x139cc00,0x139d000,0x1b101b0,0x1b501b4
.long 0x64382,0xeb380,0x139d400,0x139d800,0x139f000,0x139f400,0x1b501b4,0x1b901b8
.long 0x64402,0xeb400,0x139f800,0x139fc00,0x13a0000,0x13a1800,0x1b901b8,0x1bd01bc
.long 0x64482,0xeb480,0x13a1c00,0x13a2000,0x13a2400,0x13a2800,0x1bd01bc,0xffffffff
.long 0x172002,0x1f9000,0x1391400,0x1391800,0x1391c00,0x1392000,0x1a301a2,0xffffffff
.long 0x172082,0x1f9080,0x1392400,0x1393c00,0x1394000,0x1394400,0x1a301a2,0x1a701a6
.long 0x172102,0x1f9100,0x1394800,0x1394c00,0x1396400,0x1396800,0x1a701a6,0x1ab01aa
.long 0x172182,0x1f9180,0x1396c00,0x1397000,0x1397400,0x1398c00,0x1ab01aa,0x1af01ae
.long 0x172202,0x1f9200,0x1399000,0x1399400,0x1399800,0x1399c00,0x1af01ae,0xffffffff
.long 0x172282,0x1f9280,0x139b400,0x139b800,0x139bc00,0x139c000,0x1b301b2,0xffffffff
.long 0x172302,0x1f9300,0x139c400,0x139dc00,0x139e000,0x139e400,0x1b301b2,0x1b701b6
.long 0x172382,0x1f9380,0x139e800,0x139ec00,0x13a0400,0x13a0800,0x1b701b6,0x1bb01ba
.long 0x172402,0x1f9400,0x13a0c00,0x13a1000,0x13a1400,0x13a2c00,0x1bb01ba,0x1bf01be
.long 0x172482,0x1f9480,0x13a3000,0x13a3400,0x13a3800,0x13a3c00,0x1bf01be,0xffffffff
.size pp_table, 40960
.section .rodata,"a"
.p2align 6
.amdhsa_kernel recurrent_scan__ssm_conv_h3__mixer_s_mlp__prompt_kernel
  .amdhsa_next_free_vgpr 512
  .amdhsa_next_free_sgpr 102
  .amdhsa_accum_offset 256
  .amdhsa_group_segment_fixed_size 0
  .amdhsa_kernarg_size 112
  .amdhsa_user_sgpr_count 2
  .amdhsa_user_sgpr_kernarg_segment_ptr 1
  .amdhsa_system_sgpr_workgroup_id_x 1
  .amdhsa_float_denorm_mode_32 3
.end_amdhsa_kernel
```
